```python
import torch

def _softmax(x, axis=-1):
    return torch.softmax(x, dim=axis)
def _gelu(x):
    return torch.nn.functional.gelu(x, approximate="tanh")
def _silu(x):
    return torch.nn.functional.silu(x)
def _sigmoid(x):
    return torch.sigmoid(x)
def _layernorm(x, axis=-1, eps=1e-5):
    m = x.mean(dim=axis, keepdim=True)
    v = x.var(dim=axis, keepdim=True, unbiased=False)
    return (x - m) / torch.sqrt(v + eps)
def _scatter_add(tgt, idx, src, axis=0):
    return tgt.clone().index_add_(axis, idx, src)
def _segment_sum(src, seg, n):
    out = torch.zeros((n,) + src.shape[1:], dtype=src.dtype)
    return out.index_add_(0, seg, src)
def _pad(x, pw):
    flat = tuple(v for pair in reversed(pw) for v in pair)
    return torch.nn.functional.pad(x, flat)

kernel_name = 'interleave_layers__linear_attn_block__linear_kernel_hedgehog__prompt'

def setup_inputs():

    _w = (lambda a: (lambda t: t.to(torch.bfloat16) if t.is_floating_point() else t)(torch.as_tensor(a)))
    def _A_setup():
        B, S, D = 1, 2048, 512
        return {
            "x": _w((lambda *s: torch.randn(*s, dtype=torch.bfloat16) * 0.1)(B, S, D)),
            "wqkv": _w((lambda *s: torch.randn(*s, dtype=torch.bfloat16) * 0.2)(D, 3 * D)),
            "wo": _w((lambda *s: torch.randn(*s, dtype=torch.bfloat16) * 0.2)(D, D)),
        }
    _A_in = _A_setup()

    def _B_setup():
        B, S, D, H = 1, 2048, 512, 32
        Dh = D // H
        return {
            "x": _w((lambda *s: torch.randn(*s, dtype=torch.bfloat16) * 0.1)(B, S, D)),
            "wqkv": _w((lambda *s: torch.randn(*s, dtype=torch.bfloat16) * 0.8)(D, 3 * D)),
            "w_phi": _w((lambda *s: torch.randn(*s, dtype=torch.bfloat16) * 0.8)(H, Dh, Dh) * (Dh ** -0.5)),
            "wo": _w((lambda *s: torch.randn(*s, dtype=torch.bfloat16) * 0.1)(D, D)),
        }
    _B_in = _B_setup()

    return {
        "A_x": _A_in["x"],
        "A_wqkv": _A_in["wqkv"],
        "A_wo": _A_in["wo"],
        "B_x": _B_in["x"],
        "B_wqkv": _B_in["wqkv"],
        "B_w_phi": _B_in["w_phi"],
        "B_wo": _B_in["wo"],
    }

def reference(A_x, A_wqkv, A_wo, B_x, B_wqkv, B_w_phi, B_wo):
    def _A_ref(x, wqkv, wo):
        B, S, D = x.shape
        H = 32; Dh = D // H
        qkv = (lambda x, *d: x.permute(*d))((x @ wqkv).reshape(B, S, 3, H, Dh), 2, 0, 3, 1, 4)
        q, k, v = qkv[0], qkv[1], qkv[2]
        phi = lambda t: torch.where(t > 0, t + 1, torch.exp(t)) + 1e-6
        pq, pk = phi(q), phi(k)
        kv = torch.einsum("bhsd,bhse->bhde", pk, v)
        z = torch.einsum("bhsd->bhd", pk)
        num = torch.einsum("bhqd,bhde->bhqe", pq, kv)
        den = torch.einsum("bhqd,bhd->bhq", pq, z)[..., None] + 1e-6
        o = num / den
        return (lambda x, *d: x.permute(*d))(o, 0, 2, 1, 3).reshape(B, S, D) @ wo

    def _B_ref(x, wqkv, w_phi, wo):
        B, S, D = x.shape
        H = 32; Dh = D // H
        qkv = (lambda x, *d: x.permute(*d))((x @ wqkv).reshape(B, S, 3, H, Dh), 2, 0, 3, 1, 4)
        q, k, v = qkv[0], qkv[1], qkv[2]
        pq = torch.einsum("bhsd,hdf->bhsf", q, w_phi)
        pk = torch.einsum("bhsd,hdf->bhsf", k, w_phi)
        phi_q = torch.concatenate([_softmax(pq, axis=-1), _softmax(-pq, axis=-1)], axis=-1)
        phi_k = torch.concatenate([_softmax(pk, axis=-1), _softmax(-pk, axis=-1)], axis=-1)
        kv = torch.einsum("bhsf,bhsd->bhfd", phi_k, v)
        z  = torch.einsum("bhsf->bhf", phi_k)
        num = torch.einsum("bhqf,bhfd->bhqd", phi_q, kv)
        den = torch.einsum("bhqf,bhf->bhq", phi_q, z)[..., None] + 1e-6
        o = num / den
        return (lambda x, *d: x.permute(*d))(o, 0, 2, 1, 3).reshape(B, S, D) @ wo

    x = A_x
    x = x + _A_ref(_layernorm(x, axis=-1), A_wqkv, A_wo)
    x = x + _B_ref(_layernorm(x, axis=-1), B_wqkv, B_w_phi, B_wo)
    x = x + _A_ref(_layernorm(x, axis=-1), A_wqkv, A_wo)
    x = x + _B_ref(_layernorm(x, axis=-1), B_wqkv, B_w_phi, B_wo)
    return x
```

```asm
; @launch grid=(256,1,1) block=(256,1,1) lds=163840
.amdgcn_target "amdgcn-amd-amdhsa--gfx950"
.text
.globl interleave_layers__linear_attn_block__linear_kernel_hedgehog__prompt_kernel
.p2align 8
.type interleave_layers__linear_attn_block__linear_kernel_hedgehog__prompt_kernel,@function
interleave_layers__linear_attn_block__linear_kernel_hedgehog__prompt_kernel:
    s_cmp_ge_u32 s2, 256
    s_cbranch_scc1 L_fail
    s_load_dwordx2 s[4:5], s[0:1], 0
    s_load_dwordx2 s[8:9], s[0:1], 8
    s_load_dwordx2 s[36:37], s[0:1], 72
    s_load_dwordx2 s[12:13], s[0:1], 16
    s_load_dwordx2 s[16:17], s[0:1], 32
    s_load_dwordx2 s[20:21], s[0:1], 40
    s_load_dwordx2 s[24:25], s[0:1], 48
    s_load_dwordx2 s[28:29], s[0:1], 56
    s_load_dwordx2 s[32:33], s[0:1], 64
    s_getpc_b64 s[40:41]
    v_and_b32 v1, 63, v0
    v_lshrrev_b32 v120, 6, v0
    s_mov_b32 s42, L_code_end-interleave_layers__linear_attn_block__linear_kernel_hedgehog__prompt_kernel-128
    s_mov_b32 s43, 0x20000
    v_readfirstlane_b32 s44, v120
    v_lshlrev_b32 v2, 4, v1
    s_lshr_b32 s46, s2, 3
    s_lshl2_add_u32 s88, s46, s44
    s_and_b32 s88, s88, 63
    s_lshl_b32 s88, s88, 10
    s_min_u32 s55, s88, L_code_end-interleave_layers__linear_attn_block__linear_kernel_hedgehog__prompt_kernel-128-1024
    buffer_load_dword a255, v2, s[40:43], s55 offen
    v_lshlrev_b32 v126, 7, v1
    s_mov_b32 s6, 2097152
    s_mov_b32 s7, 0x20000
    s_mov_b32 s10, 1572864
    s_mov_b32 s11, 0x20000
    s_mov_b32 s38, 67108864
    s_mov_b32 s39, 0x20000
    s_and_b32 s45, s2, 7
    s_lshl_b32 s45, s45, 1
    s_lshr_b32 s88, s2, 7
    s_add_u32 s45, s45, s88
    s_and_b32 s46, s46, 15
    s_lshl_b32 s47, s45, 2
    s_add_u32 s47, s47, s44
    s_and_b32 s78, s46, 1
    s_lshl1_add_u32 s78, s78, s88
    s_lshl_b32 s78, s78, 1
    s_and_b32 s78, s78, 6
    s_lshr_b32 s89, s46, 1
    s_xor_b32 s78, s78, s89
    s_xor_b32 s78, s78, s2
    s_cmp_eq_u32 s89, 9
    s_cselect_b32 s89, 6, 7
    s_and_b32 s78, s78, s89
    s_lshl_b32 s50, s47, 8
    s_add_u32 s50, s50, s78
    s_lshl_b32 s50, s50, 7
    s_lshl_b32 s52, s44, 12
    s_add_u32 s52, s52, 98304
    s_lshl_b32 s82, s44, 10
    s_lshl2_add_u32 s81, s78, s44
    s_lshl_b32 s81, s81, 10
    s_lshl_b32 s90, s46, 6
    v_lshrrev_b32 v48, 2, v1
    v_mul_u32_u24 v48, 3072, v48
    v_and_b32 v125, 3, v1
    v_lshl_add_u32 v48, v125, 4, v48
    v_add_u32 v48, s90, v48
    v_lshrrev_b32 v124, 4, v1
    v_and_b32 v82, 7, v1
    v_xor_b32 v81, v82, v124
    v_lshlrev_b32 v81, 4, v81
    v_lshrrev_b32 v80, 3, v1
    v_lshl_add_u32 v12, v80, 10, v81
    v_xor_b32 v13, 64, v12
    v_add_u32 v13, 7168, v13
    v_add_u32 v14, 14336, v12
    v_add_u32 v15, 14336, v13
    v_and_b32 v120, 31, v1
    v_lshrrev_b32 v121, 5, v1
    v_lshlrev_b32 v3, 2, v1
    s_lshl_b32 s91, s46, 2
    s_add_u32 s91, s91, s44
    s_lshl_b32 s67, s91, 13
    s_add_u32 s67, s67, 1048576
    s_lshl_b32 s70, s91, 10
    s_add_u32 s70, s70, 65536
    s_lshl_b32 s92, s45, 9
    s_add_u32 s68, s67, s92
    s_lshl_b32 s93, s45, 6
    s_add_u32 s71, s70, s93
    v_and_b32 v62, 60, v3
    v_lshlrev_b32 v80, 2, v62
    v_lshl_add_u32 v80, v121, 8, v80
    v_and_b32 v81, 1, v124
    v_lshl_add_u32 v59, v81, 3, v80
    v_lshl_add_u32 v60, v124, 26, v62
    s_lshr_b32 s72, s45, 3
    s_lshr_b32 s89, s44, 1
    s_xor_b32 s72, s72, s89
    s_lshl_b32 s72, s72, 28
    v_mov_b32 v68, 0
    s_lshr_b32 s63, s46, 1
    s_lshl_b32 s63, s63, 13
    s_add_u32 s63, s63, s92
    s_and_b32 s62, s46, 1
    s_lshl_b32 s62, s62, 8
    s_add_u32 s63, s63, s62
    v_lshrrev_b32 v80, 2, v1
    v_lshl_add_u32 v31, v80, 26, v126
    v_lshl_add_u32 v30, v124, 26, v126
    s_mov_b32 s14, 524288
    s_mov_b32 s15, 0x20000
    s_mov_b32 s18, 1572864
    s_mov_b32 s19, 0x20000
    s_mov_b32 s26, 524288
    s_mov_b32 s27, 0x20000
    s_waitcnt lgkmcnt(0)
    s_add_u32 m0, s52, 0
    s_xor_b32 s88, s50, 0
    buffer_load_dwordx4 v12, s[4:7], s88 offen offset:0  lds
    buffer_load_dwordx4 v13, s[4:7], s88 offen offset:1024  lds
    s_add_u32 m0, s82, 31744
    s_xor_b32 s89, s81, 0
    s_mul_i32 s89, s89, 48
    s_add_u32 s89, s89, 1024
    buffer_load_dwordx4 v48, s[8:11], s89 offen offset:1024 lds
    s_add_u32 m0, s52, 0
    s_nop 0
    buffer_load_dwordx4 v14, s[4:7], s88 offen offset:2048  lds
    s_add_u32 m0, s82, 0
    s_nop 0
    buffer_load_dwordx4 v48, s[8:11], s89 offen offset:0 lds
    s_add_u32 m0, s52, 0
    s_nop 0
    buffer_load_dwordx4 v15, s[4:7], s88 offen offset:3072  lds
    s_add_u32 m0, s52, 16384
    s_xor_b32 s88, s50, 128
    buffer_load_dwordx4 v12, s[4:7], s88 offen offset:0  lds
    buffer_load_dwordx4 v13, s[4:7], s88 offen offset:1024  lds
    s_and_b32 s62, s91, 0x33
    s_cbranch_scc1 L_noclr
    buffer_store_dword v68, v3, s[36:39], s63 offen sc1
L_noclr:
    v_add_u32 v70, s72, v59
    v_add_u32 v71, s72, v60
    v_mov_b32 v122, -1
    v_mov_b32 v123, -1
    s_add_u32 s92, s68, 0
    s_add_u32 s93, s71, 0
    buffer_store_dwordx2 v[122:123], v70, s[36:39], s92 offen sc1
    buffer_store_dword v122, v71, s[36:39], s93 offen sc1
    s_mov_b32 s22, 16384
    s_mov_b32 s23, 0x20000
    s_mov_b32 s30, 2097152
    s_mov_b32 s31, 0x20000
    s_mov_b32 s34, 256
    s_mov_b32 s35, 0x20000
    s_and_b32 s88, s44, 1
    s_lshr_b32 s89, s44, 1
    s_lshl_b32 s48, s45, 2
    s_lshr_b32 s92, s46, 3
    s_lshl_b32 s92, s92, 1
    s_add_u32 s92, s92, s88
    s_add_u32 s48, s48, s92
    s_lshl_b32 s91, s92, 12
    s_add_u32 s91, s91, 98304
    s_and_b32 s49, s46, 7
    s_xor_b32 s79, s49, s78
    s_lshl_b32 s49, s49, 1
    s_add_u32 s49, s49, s89
    s_lshl_b32 s73, s48, 15
    s_lshl_b32 s90, s89, 14
    s_add_u32 s73, s73, s90
    s_and_b32 s90, s46, 7
    s_lshl_b32 s90, s90, 7
    s_add_u32 s73, s73, s90
    s_and_b32 s92, s46, 1
    s_and_b32 s93, s45, 1
    s_lshl1_add_u32 s92, s92, s93
    s_and_b32 s92, s92, 3
    s_lshl2_add_u32 s92, s92, s44
    s_lshl_b32 s53, s92, 11
    s_lshr_b32 s92, s46, 3
    s_lshl1_add_u32 s92, s92, s93
    s_and_b32 s92, s92, 3
    s_lshl2_add_u32 s92, s92, s44
    s_lshl_b32 s54, s92, 11
    s_lshl_b32 s92, s89, 12
    s_add_u32 s66, s67, s92
    s_lshl_b32 s92, s89, 9
    s_add_u32 s69, s70, s92
    s_lshl_b32 s92, s47, 15
    s_add_u32 s56, s92, 6291456
    s_lshl_b32 s93, s46, 11
    s_add_u32 s61, s92, s93
    s_add_u32 s61, s61, 4194304
    s_lshl_b32 s92, s48, 15
    s_lshl_b32 s93, s90, 5
    s_add_u32 s57, s92, s93
    s_lshl_b32 s93, s89, 8
    s_add_u32 s57, s57, s93
    s_add_u32 s57, s57, 6291456
    s_lshl_b32 s93, s89, 10
    s_add_u32 s60, s92, s93
    s_add_u32 s60, s60, 4194304
    s_lshl_b32 s58, s47, 11
    s_add_u32 s58, s58, 8388608
    s_lshl_b32 s59, s48, 11
    s_and_b32 s92, s46, 6
    s_add_u32 s92, s92, s89
    s_lshl_b32 s93, s92, 8
    s_add_u32 s59, s59, s93
    s_and_b32 s93, s46, 1
    s_lshl3_add_u32 s59, s93, s59
    s_add_u32 s59, s59, 8388608
    s_lshl_b32 s64, s47, 7
    s_lshl_b32 s93, s46, 2
    s_add_u32 s63, s64, s93
    s_add_u32 s64, s64, 8192
    s_lshl_b32 s62, s48, 7
    s_lshl_b32 s93, s49, 2
    s_add_u32 s65, s62, s93
    s_add_u32 s65, s65, 8192
    s_mov_b32 s74, 0x3f803f80
    s_mov_b32 s75, 0x07060302
    s_mov_b32 s76, 0xffff0000
    s_mov_b32 s84, 0x3fb8aa3b
    s_mov_b32 s85, 0x3fb8aa3b
    s_mov_b32 s86, 0x358637bd
    s_mov_b32 s87, 0x358637bd
    s_getreg_b32 s77, hwreg(HW_REG_XCC_ID, 0, 3)
    s_lshl_b32 s77, s77, 2
    s_mov_b32 s51, 400000
    v_add_lshl_u32 v61, v62, v121, 2
    v_lshrrev_b32 v80, 3, v1
    v_lshlrev_b32 v81, 1, v124
    v_xor_b32 v81, v81, v82
    v_lshlrev_b32 v81, 4, v81
    v_lshl_add_u32 v49, v80, 10, v81
    v_add_u32 v49, s90, v49
    v_bfe_u32 v80, v1, 2, 2
    v_lshl_add_u32 v80, v121, 2, v80
    v_lshlrev_b32 v80, 6, v80
    v_and_b32 v81, 1, v124
    v_lshl_add_u32 v80, v81, 5, v80
    v_and_b32 v81, 1, v1
    v_lshl_add_u32 v80, v81, 4, v80
    v_bfe_u32 v81, v1, 1, 1
    v_lshl_add_u32 v80, v81, 3, v80
    v_bfe_u32 v81, v1, 1, 3
    v_lshlrev_b32 v82, 1, v121
    v_xor_b32 v81, v81, v82
    v_lshlrev_b32 v81, 4, v81
    v_lshl_add_u32 v81, v120, 7, v81
    s_lshl_b32 s92, s89, 11
    s_add_u32 s92, s92, s91
    v_bfe_u32 v82, v1, 1, 3
    v_xor_b32 v82, v82, v121
    v_lshl_add_u32 v82, v82, 4, s92
    v_lshl_add_u32 v82, v62, 5, v82
    v_and_b32 v69, 1, v124
    v_lshl_add_u32 v69, v69, 3, v82
    v_add_u32 v81, s52, v81
    s_lshl_b32 s92, s44, 13
    v_add_u32 v41, s92, v80
    s_lshl2_add_u32 s93, s44, 159360
    v_lshl_add_u32 v43, v120, 4, s93
    s_xor_b32 s92, s44, 0
    s_lshr_b32 s93, s92, 1
    s_lshl_b32 s93, s93, 2
    s_and_b32 s92, s92, 1
    s_add_u32 s92, s92, s93
    s_lshl_b32 s93, s92, 9
    v_add_u32 v44, s93, v80
    s_lshl_b32 s93, s92, 4
    v_xor_b32 v16, s93, v81
    s_xor_b32 s92, s44, 1
    s_lshr_b32 s93, s92, 1
    s_lshl_b32 s93, s93, 2
    s_and_b32 s92, s92, 1
    s_add_u32 s92, s92, s93
    s_lshl_b32 s93, s92, 9
    v_add_u32 v45, s93, v80
    s_lshl_b32 s93, s92, 4
    v_xor_b32 v17, s93, v81
    s_xor_b32 s92, s44, 2
    s_lshr_b32 s93, s92, 1
    s_lshl_b32 s93, s93, 2
    s_and_b32 s92, s92, 1
    s_add_u32 s92, s92, s93
    s_lshl_b32 s93, s92, 9
    v_add_u32 v46, s93, v80
    s_lshl_b32 s93, s92, 4
    v_xor_b32 v18, s93, v81
    s_xor_b32 s92, s44, 3
    s_lshr_b32 s93, s92, 1
    s_lshl_b32 s93, s93, 2
    s_and_b32 s92, s92, 1
    s_add_u32 s92, s92, s93
    s_lshl_b32 s93, s92, 9
    v_add_u32 v47, s93, v80
    s_lshl_b32 s93, s92, 4
    v_xor_b32 v19, s93, v81
    s_lshl_b32 s92, s44, 9
    s_add_u32 s92, s92, 131072
    v_lshl_add_u32 v80, v120, 4, s92
    v_mul_u32_u24 v81, 2176, v121
    v_add_u32 v50, v80, v81
    v_lshl_add_u32 v51, v81, 2, v80
    v_bfe_u32 v80, v1, 1, 1
    v_mul_u32_u24 v80, 2176, v80
    v_lshrrev_b32 v81, 2, v1
    v_lshl_add_u32 v80, v81, 4, v80
    v_and_b32 v81, 1, v1
    v_lshl_add_u32 v80, v81, 3, v80
    s_mul_i32 s92, s44, 4352
    s_add_u32 s92, s92, 131072
    v_add_u32 v53, s92, v80
    s_mul_i32 s92, s88, 4352
    s_add_u32 s92, s92, 131072
    v_add_u32 v52, s92, v80
    s_mul_i32 s92, s44, 544
    s_add_u32 s92, s92, 157184
    v_lshl_add_u32 v80, v62, 3, s92
    v_lshl_add_u32 v54, v124, 3, v80
    v_lshrrev_b32 v80, 1, v62
    v_add_u32 v55, s92, v80
    v_min_u32 v80, 16, v120
    v_lshlrev_b32 v80, 5, v80
    v_add_u32 v80, 157184, v80
    v_lshl_add_u32 v56, v121, 4, v80
    v_mul_u32_u24 v81, 1088, v121
    v_add_u32 v57, v80, v81
    v_bfe_u32 v80, v1, 2, 3
    v_lshlrev_b32 v80, 7, v80
    v_lshl_add_u32 v80, v125, 3, v80
    v_bfe_u32 v81, v1, 3, 2
    v_lshl_add_u32 v80, v81, 5, v80
    v_lshl_add_u32 v63, v121, 11, v80
    v_lshlrev_b32 v81, 5, v121
    v_xor_b32 v80, v80, v81
    s_lshl_b32 s93, s44, 11
    v_add_u32 v42, s93, v80
    v_and_b32 v80, 1, v1
    v_lshlrev_b32 v80, 4, v80
    v_mov_b32 v81, 0x3f80
    v_lshlrev_b32 v80, v80, v81
    v_lshrrev_b32 v81, 1, v1
    v_xor_b32 v81, v81, v1
    v_and_b32 v81, 8, v81
    v_bfe_u32 v82, v1, 1, 2
    v_or_b32 v81, v81, v82
    v_cmp_eq_u32 vcc, 0, v81
    s_nop 1
    v_cndmask_b32 v20, 0, v80, vcc
    v_cmp_eq_u32 vcc, 1, v81
    s_nop 1
    v_cndmask_b32 v21, 0, v80, vcc
    v_cmp_eq_u32 vcc, 2, v81
    s_nop 1
    v_cndmask_b32 v22, 0, v80, vcc
    v_cmp_eq_u32 vcc, 3, v81
    s_nop 1
    v_cndmask_b32 v23, 0, v80, vcc
    v_mov_b32 v124, v69
    s_mov_b64 exec, 0
    s_cmp_eq_u32 s44, 0
    s_cbranch_scc1 L_pad0
    s_cmp_eq_u32 s44, 1
    s_cbranch_scc1 L_pad1
    s_cmp_eq_u32 s44, 2
    s_cbranch_scc1 L_pad2
    s_branch L_pad3
L_warm_done:
    s_mov_b64 exec, -1
    s_nop 3
    s_add_u32 m0, s82, 35840
    s_xor_b32 s89, s81, 4096
    s_mul_i32 s89, s89, 48
    s_add_u32 s89, s89, 1024
    buffer_load_dwordx4 v48, s[8:11], s89 offen offset:1024 lds
    s_add_u32 m0, s52, 16384
    s_xor_b32 s88, s50, 128
    buffer_load_dwordx4 v14, s[4:7], s88 offen offset:2048  lds
    s_add_u32 m0, s82, 4096
    s_nop 0
    buffer_load_dwordx4 v48, s[8:11], s89 offen offset:0 lds
    s_add_u32 m0, s52, 16384
    s_nop 0
    buffer_load_dwordx4 v15, s[4:7], s88 offen offset:3072  lds
    s_branch L_main
    .p2align 12
L_main:
L_pad0:
    s_cbranch_execz L_pad4
    s_mov_b32 vcc_lo, 0xf0f00f0f
    s_mov_b32 vcc_hi, 0xf0f00f0f
    v_mov_b32 v33, s74
    v_cndmask_b32 v32, 0, v33, vcc
    v_mov_b32 v33, v32
    v_mov_b32 v34, v32
    v_mov_b32 v35, v32
    s_waitcnt vmcnt(8)
    s_barrier
    ds_read_b128 v[128:131], v16 offset:0
    ds_read_b128 v[132:135], v17 offset:0
    ds_read_b128 v[136:139], v18 offset:0
    ds_read_b128 v[140:143], v19 offset:0
    ds_read_b64_tr_b16 a[0:1], v44 offset:0
    ds_read_b64_tr_b16 a[2:3], v44 offset:1024
    ds_read_b64_tr_b16 a[32:33], v44 offset:32768
    ds_read_b64_tr_b16 a[34:35], v44 offset:33792
    s_cmp_lg_u32 s79, 0
    s_cbranch_scc1 L_nores0
    ds_read_b64 v[4:5], v124 offset:0
    v_xor_b32 v124, 32, v124
    ds_read_b64 v[6:7], v124 offset:0
    v_xor_b32 v124, 96, v124
    ds_read_b64 v[8:9], v124 offset:0
    v_xor_b32 v124, 32, v124
    ds_read_b64 v[10:11], v124 offset:0
L_nores0:
    s_add_u32 m0, s52, 32768
    s_xor_b32 s88, s50, 256
    buffer_load_dwordx4 v12, s[4:7], s88 offen offset:0  lds
    buffer_load_dwordx4 v13, s[4:7], s88 offen offset:1024  lds
    ds_read_b64_tr_b16 v[104:105], v45 offset:0
    ds_read_b64_tr_b16 v[106:107], v45 offset:1024
    s_waitcnt lgkmcnt(9)
    v_mfma_f32_16x16x32_bf16 a[240:243], v[32:35], v[128:131], 0
    v_permlane32_swap_b32 v128, v130
    v_permlane32_swap_b32 v129, v131
    ds_read_b64_tr_b16 v[108:109], v45 offset:32768
    ds_read_b64_tr_b16 v[110:111], v45 offset:33792
    s_add_u32 m0, s82, 39936
    s_xor_b32 s89, s81, 8192
    s_mul_i32 s89, s89, 48
    s_add_u32 s89, s89, 1024
    buffer_load_dwordx4 v48, s[8:11], s89 offen offset:1024 lds
    s_waitcnt lgkmcnt(8)
    v_dot2_f32_bf16 v120, v128, v128, 0
    v_dot2_f32_bf16 v121, v129, v129, 0
    v_dot2_f32_bf16 v120, v130, v130, v120
    v_dot2_f32_bf16 v121, v131, v131, v121
    v_dot2_f32_bf16 v120, v132, v132, v120
    v_dot2_f32_bf16 v121, v133, v133, v121
    v_dot2_f32_bf16 v120, v134, v134, v120
    v_dot2_f32_bf16 v121, v135, v135, v121
    v_dot2_f32_bf16 v120, v136, v136, v120
    v_dot2_f32_bf16 v121, v137, v137, v121
    v_dot2_f32_bf16 v120, v138, v138, v120
    v_dot2_f32_bf16 v121, v139, v139, v121
    v_dot2_f32_bf16 v120, v140, v140, v120
    v_dot2_f32_bf16 v121, v141, v141, v121
    v_dot2_f32_bf16 v120, v142, v142, v120
    v_dot2_f32_bf16 v121, v143, v143, v121
    s_waitcnt lgkmcnt(4)
    v_mfma_f32_16x16x32_bf16 a[244:247], v[32:35], a[0:3], 0
    v_mfma_f32_16x16x32_bf16 a[248:251], v[32:35], a[32:35], 0
    v_mfma_f32_32x32x16_bf16 v[64:79], a[0:3], v[128:131], 0
    s_add_u32 m0, s52, 32768
    s_nop 0
    buffer_load_dwordx4 v14, s[4:7], s88 offen offset:2048  lds
    ds_read_b64_tr_b16 v[112:113], v46 offset:0
    ds_read_b64_tr_b16 v[114:115], v46 offset:1024
    v_mfma_f32_16x16x32_bf16 a[240:243], v[32:35], v[132:135], a[240:243]
    v_mfma_f32_32x32x16_bf16 v[80:95], a[32:35], v[128:131], 0
    v_permlane32_swap_b32 v132, v134
    v_permlane32_swap_b32 v133, v135
    ds_read_b64_tr_b16 v[116:117], v46 offset:32768
    ds_read_b64_tr_b16 v[118:119], v46 offset:33792
    s_add_u32 m0, s82, 8192
    s_nop 0
    buffer_load_dwordx4 v48, s[8:11], s89 offen offset:0 lds
    s_waitcnt lgkmcnt(4)
    v_mfma_f32_32x32x16_bf16 v[64:79], v[104:107], v[132:135], v[64:79]
    s_add_u32 m0, s52, 32768
    s_nop 0
    buffer_load_dwordx4 v15, s[4:7], s88 offen offset:3072  lds
    ds_read_b64_tr_b16 v[96:97], v47 offset:0
    ds_read_b64_tr_b16 v[98:99], v47 offset:1024
    v_mfma_f32_16x16x32_bf16 a[240:243], v[32:35], v[136:139], a[240:243]
    v_mfma_f32_32x32x16_bf16 v[80:95], v[108:111], v[132:135], v[80:95]
    v_permlane32_swap_b32 v136, v138
    v_permlane32_swap_b32 v137, v139
    ds_read_b64_tr_b16 v[100:101], v47 offset:32768
    ds_read_b64_tr_b16 v[102:103], v47 offset:33792
    s_xor_b32 s80, s81, 0
    s_add_u32 m0, s82, 65536
    s_mul_i32 s80, s80, 48
    buffer_load_dwordx4 v48, s[8:11], s80 offen lds
    s_waitcnt lgkmcnt(4)
    v_mfma_f32_32x32x16_bf16 v[64:79], v[112:115], v[136:139], v[64:79]
    s_xor_b32 s80, s81, 4096
    s_add_u32 m0, s82, 69632
    s_mul_i32 s80, s80, 48
    buffer_load_dwordx4 v48, s[8:11], s80 offen lds
    s_waitcnt vmcnt(8)
    s_barrier
    ds_read_b128 v[144:147], v16 offset:16384
    ds_read_b128 v[148:151], v17 offset:16384
    ds_read_b128 v[152:155], v18 offset:16384
    ds_read_b128 v[156:159], v19 offset:16384
    ds_read_b64_tr_b16 a[4:5], v44 offset:4096
    ds_read_b64_tr_b16 a[6:7], v44 offset:5120
    v_mfma_f32_16x16x32_bf16 a[240:243], v[32:35], v[140:143], a[240:243]
    v_mfma_f32_32x32x16_bf16 v[80:95], v[116:119], v[136:139], v[80:95]
    v_permlane32_swap_b32 v140, v142
    v_permlane32_swap_b32 v141, v143
    ds_read_b64_tr_b16 a[36:37], v44 offset:36864
    ds_read_b64_tr_b16 a[38:39], v44 offset:37888
    s_cmp_lg_u32 s79, 1
    s_cbranch_scc1 L_nores1
    ds_read_b64 v[4:5], v124 offset:16384
    v_xor_b32 v124, 32, v124
    ds_read_b64 v[6:7], v124 offset:16384
    v_xor_b32 v124, 96, v124
    ds_read_b64 v[8:9], v124 offset:16384
    v_xor_b32 v124, 32, v124
    ds_read_b64 v[10:11], v124 offset:16384
L_nores1:
    s_add_u32 m0, s52, 0
    s_xor_b32 s88, s50, 384
    buffer_load_dwordx4 v12, s[4:7], s88 offen offset:0  lds
    s_waitcnt lgkmcnt(8)
    v_mfma_f32_32x32x16_bf16 v[64:79], v[96:99], v[140:143], v[64:79]
    buffer_load_dwordx4 v13, s[4:7], s88 offen offset:1024  lds
    ds_read_b64_tr_b16 v[112:113], v45 offset:4096
    ds_read_b64_tr_b16 v[114:115], v45 offset:5120
    s_waitcnt lgkmcnt(9)
    v_mfma_f32_16x16x32_bf16 a[240:243], v[32:35], v[144:147], a[240:243]
    v_mfma_f32_32x32x16_bf16 v[80:95], v[100:103], v[140:143], v[80:95]
    v_permlane32_swap_b32 v144, v146
    v_permlane32_swap_b32 v145, v147
    ds_read_b64_tr_b16 v[116:117], v45 offset:36864
    ds_read_b64_tr_b16 v[118:119], v45 offset:37888
    s_add_u32 m0, s82, 44032
    s_xor_b32 s89, s81, 12288
    s_mul_i32 s89, s89, 48
    s_add_u32 s89, s89, 1024
    buffer_load_dwordx4 v48, s[8:11], s89 offen offset:1024 lds
    s_waitcnt lgkmcnt(8)
    v_dot2_f32_bf16 v120, v144, v144, v120
    v_dot2_f32_bf16 v121, v145, v145, v121
    v_dot2_f32_bf16 v120, v146, v146, v120
    v_dot2_f32_bf16 v121, v147, v147, v121
    v_dot2_f32_bf16 v120, v148, v148, v120
    v_dot2_f32_bf16 v121, v149, v149, v121
    v_dot2_f32_bf16 v120, v150, v150, v120
    v_dot2_f32_bf16 v121, v151, v151, v121
    v_dot2_f32_bf16 v120, v152, v152, v120
    v_dot2_f32_bf16 v121, v153, v153, v121
    v_dot2_f32_bf16 v120, v154, v154, v120
    v_dot2_f32_bf16 v121, v155, v155, v121
    v_dot2_f32_bf16 v120, v156, v156, v120
    v_dot2_f32_bf16 v121, v157, v157, v121
    v_dot2_f32_bf16 v120, v158, v158, v120
    v_dot2_f32_bf16 v121, v159, v159, v121
    s_cmp_lg_u32 s44, 0
    s_cbranch_scc1 L_noat
    s_lshr_b32 s93, s46, 3
    s_lshl1_add_u32 s93, s45, s93
    s_lshl_b32 s93, s93, 2
    s_lshl_b32 s3, 1, s77
    s_atomic_add s3, s[32:33], s93
L_noat:
    s_waitcnt lgkmcnt(4)
    v_mfma_f32_16x16x32_bf16 a[244:247], v[32:35], a[4:7], a[244:247]
    v_mfma_f32_16x16x32_bf16 a[248:251], v[32:35], a[36:39], a[248:251]
    v_mfma_f32_32x32x16_bf16 v[64:79], a[4:7], v[144:147], v[64:79]
    s_add_u32 m0, s52, 0
    s_nop 0
    buffer_load_dwordx4 v14, s[4:7], s88 offen offset:2048  lds
    ds_read_b64_tr_b16 v[96:97], v46 offset:4096
    ds_read_b64_tr_b16 v[98:99], v46 offset:5120
    v_mfma_f32_16x16x32_bf16 a[240:243], v[32:35], v[148:151], a[240:243]
    v_mfma_f32_32x32x16_bf16 v[80:95], a[36:39], v[144:147], v[80:95]
    v_permlane32_swap_b32 v148, v150
    v_permlane32_swap_b32 v149, v151
    ds_read_b64_tr_b16 v[100:101], v46 offset:36864
    ds_read_b64_tr_b16 v[102:103], v46 offset:37888
    s_add_u32 m0, s82, 12288
    s_nop 0
    buffer_load_dwordx4 v48, s[8:11], s89 offen offset:0 lds
    s_waitcnt lgkmcnt(4)
    v_mfma_f32_32x32x16_bf16 v[64:79], v[112:115], v[148:151], v[64:79]
    s_add_u32 m0, s52, 0
    s_nop 0
    buffer_load_dwordx4 v15, s[4:7], s88 offen offset:3072  lds
    ds_read_b64_tr_b16 v[104:105], v47 offset:4096
    ds_read_b64_tr_b16 v[106:107], v47 offset:5120
    v_mfma_f32_16x16x32_bf16 a[240:243], v[32:35], v[152:155], a[240:243]
    v_mfma_f32_32x32x16_bf16 v[80:95], v[116:119], v[148:151], v[80:95]
    v_permlane32_swap_b32 v152, v154
    v_permlane32_swap_b32 v153, v155
    ds_read_b64_tr_b16 v[108:109], v47 offset:36864
    ds_read_b64_tr_b16 v[110:111], v47 offset:37888
    s_xor_b32 s80, s81, 8192
    s_add_u32 m0, s82, 73728
    s_mul_i32 s80, s80, 48
    buffer_load_dwordx4 v48, s[8:11], s80 offen lds
    s_waitcnt lgkmcnt(4)
    v_mfma_f32_32x32x16_bf16 v[64:79], v[96:99], v[152:155], v[64:79]
    s_waitcnt vmcnt(9)
    s_barrier
    ds_read_b128 v[160:163], v16 offset:32768
    ds_read_b128 v[164:167], v17 offset:32768
    ds_read_b128 v[168:171], v18 offset:32768
    ds_read_b128 v[172:175], v19 offset:32768
    ds_read_b64_tr_b16 a[8:9], v44 offset:8192
    ds_read_b64_tr_b16 a[10:11], v44 offset:9216
    v_mfma_f32_16x16x32_bf16 a[240:243], v[32:35], v[156:159], a[240:243]
    v_mfma_f32_32x32x16_bf16 v[80:95], v[100:103], v[152:155], v[80:95]
    v_permlane32_swap_b32 v156, v158
    v_permlane32_swap_b32 v157, v159
    ds_read_b64_tr_b16 a[40:41], v44 offset:40960
    ds_read_b64_tr_b16 a[42:43], v44 offset:41984
    s_cmp_lg_u32 s79, 2
    s_cbranch_scc1 L_nores2
    ds_read_b64 v[4:5], v124 offset:32768
    v_xor_b32 v124, 32, v124
    ds_read_b64 v[6:7], v124 offset:32768
    v_xor_b32 v124, 96, v124
    ds_read_b64 v[8:9], v124 offset:32768
    v_xor_b32 v124, 32, v124
    ds_read_b64 v[10:11], v124 offset:32768
L_nores2:
    s_add_u32 m0, s52, 16384
    s_xor_b32 s88, s50, 512
    buffer_load_dwordx4 v12, s[4:7], s88 offen offset:0  lds
    s_waitcnt lgkmcnt(8)
    v_mfma_f32_32x32x16_bf16 v[64:79], v[104:107], v[156:159], v[64:79]
    buffer_load_dwordx4 v13, s[4:7], s88 offen offset:1024  lds
    ds_read_b64_tr_b16 v[96:97], v45 offset:8192
    ds_read_b64_tr_b16 v[98:99], v45 offset:9216
    s_waitcnt lgkmcnt(9)
    v_mfma_f32_16x16x32_bf16 a[240:243], v[32:35], v[160:163], a[240:243]
    v_mfma_f32_32x32x16_bf16 v[80:95], v[108:111], v[156:159], v[80:95]
    v_permlane32_swap_b32 v160, v162
    v_permlane32_swap_b32 v161, v163
    ds_read_b64_tr_b16 v[100:101], v45 offset:40960
    ds_read_b64_tr_b16 v[102:103], v45 offset:41984
    s_add_u32 m0, s82, 48128
    s_xor_b32 s89, s81, 16384
    s_mul_i32 s89, s89, 48
    s_add_u32 s89, s89, 1024
    buffer_load_dwordx4 v48, s[8:11], s89 offen offset:1024 lds
    s_waitcnt lgkmcnt(8)
    v_dot2_f32_bf16 v120, v160, v160, v120
    v_dot2_f32_bf16 v121, v161, v161, v121
    v_dot2_f32_bf16 v120, v162, v162, v120
    v_dot2_f32_bf16 v121, v163, v163, v121
    v_dot2_f32_bf16 v120, v164, v164, v120
    v_dot2_f32_bf16 v121, v165, v165, v121
    v_dot2_f32_bf16 v120, v166, v166, v120
    v_dot2_f32_bf16 v121, v167, v167, v121
    v_dot2_f32_bf16 v120, v168, v168, v120
    v_dot2_f32_bf16 v121, v169, v169, v121
    v_dot2_f32_bf16 v120, v170, v170, v120
    v_dot2_f32_bf16 v121, v171, v171, v121
    v_dot2_f32_bf16 v120, v172, v172, v120
    v_dot2_f32_bf16 v121, v173, v173, v121
    v_dot2_f32_bf16 v120, v174, v174, v120
    v_dot2_f32_bf16 v121, v175, v175, v121
    s_waitcnt lgkmcnt(4)
    v_mfma_f32_16x16x32_bf16 a[244:247], v[32:35], a[8:11], a[244:247]
    v_mfma_f32_16x16x32_bf16 a[248:251], v[32:35], a[40:43], a[248:251]
    v_mfma_f32_32x32x16_bf16 v[64:79], a[8:11], v[160:163], v[64:79]
    s_add_u32 m0, s52, 16384
    s_nop 0
    buffer_load_dwordx4 v14, s[4:7], s88 offen offset:2048  lds
    ds_read_b64_tr_b16 v[104:105], v46 offset:8192
    ds_read_b64_tr_b16 v[106:107], v46 offset:9216
    v_mfma_f32_16x16x32_bf16 a[240:243], v[32:35], v[164:167], a[240:243]
    v_mfma_f32_32x32x16_bf16 v[80:95], a[40:43], v[160:163], v[80:95]
    v_permlane32_swap_b32 v164, v166
    v_permlane32_swap_b32 v165, v167
    ds_read_b64_tr_b16 v[108:109], v46 offset:40960
    ds_read_b64_tr_b16 v[110:111], v46 offset:41984
    s_add_u32 m0, s82, 16384
    s_nop 0
    buffer_load_dwordx4 v48, s[8:11], s89 offen offset:0 lds
    s_waitcnt lgkmcnt(4)
    v_mfma_f32_32x32x16_bf16 v[64:79], v[96:99], v[164:167], v[64:79]
    s_add_u32 m0, s52, 16384
    s_nop 0
    buffer_load_dwordx4 v15, s[4:7], s88 offen offset:3072  lds
    ds_read_b64_tr_b16 v[112:113], v47 offset:8192
    ds_read_b64_tr_b16 v[114:115], v47 offset:9216
    v_mfma_f32_16x16x32_bf16 a[240:243], v[32:35], v[168:171], a[240:243]
    v_mfma_f32_32x32x16_bf16 v[80:95], v[100:103], v[164:167], v[80:95]
    v_permlane32_swap_b32 v168, v170
    v_permlane32_swap_b32 v169, v171
    ds_read_b64_tr_b16 v[116:117], v47 offset:40960
    ds_read_b64_tr_b16 v[118:119], v47 offset:41984
    s_xor_b32 s80, s81, 12288
    s_add_u32 m0, s82, 77824
    s_mul_i32 s80, s80, 48
    buffer_load_dwordx4 v48, s[8:11], s80 offen lds
    s_waitcnt lgkmcnt(4)
    v_mfma_f32_32x32x16_bf16 v[64:79], v[104:107], v[168:171], v[64:79]
    s_waitcnt vmcnt(8)
    s_barrier
    ds_read_b128 v[176:179], v16 offset:0
    ds_read_b128 v[180:183], v17 offset:0
    ds_read_b128 v[184:187], v18 offset:0
    ds_read_b128 v[188:191], v19 offset:0
    ds_read_b64_tr_b16 a[12:13], v44 offset:12288
    ds_read_b64_tr_b16 a[14:15], v44 offset:13312
    v_mfma_f32_16x16x32_bf16 a[240:243], v[32:35], v[172:175], a[240:243]
    v_mfma_f32_32x32x16_bf16 v[80:95], v[108:111], v[168:171], v[80:95]
    v_permlane32_swap_b32 v172, v174
    v_permlane32_swap_b32 v173, v175
    ds_read_b64_tr_b16 a[44:45], v44 offset:45056
    ds_read_b64_tr_b16 a[46:47], v44 offset:46080
    s_cmp_lg_u32 s79, 3
    s_cbranch_scc1 L_nores3
    ds_read_b64 v[4:5], v124 offset:0
    v_xor_b32 v124, 32, v124
    ds_read_b64 v[6:7], v124 offset:0
    v_xor_b32 v124, 96, v124
    ds_read_b64 v[8:9], v124 offset:0
    v_xor_b32 v124, 32, v124
    ds_read_b64 v[10:11], v124 offset:0
L_nores3:
    s_add_u32 m0, s52, 32768
    s_xor_b32 s88, s50, 640
    buffer_load_dwordx4 v12, s[4:7], s88 offen offset:0  lds
    s_waitcnt lgkmcnt(8)
    v_mfma_f32_32x32x16_bf16 v[64:79], v[112:115], v[172:175], v[64:79]
    buffer_load_dwordx4 v13, s[4:7], s88 offen offset:1024  lds
    ds_read_b64_tr_b16 v[104:105], v45 offset:12288
    ds_read_b64_tr_b16 v[106:107], v45 offset:13312
    s_waitcnt lgkmcnt(9)
    v_mfma_f32_16x16x32_bf16 a[240:243], v[32:35], v[176:179], a[240:243]
    v_mfma_f32_32x32x16_bf16 v[80:95], v[116:119], v[172:175], v[80:95]
    v_permlane32_swap_b32 v176, v178
    v_permlane32_swap_b32 v177, v179
    ds_read_b64_tr_b16 v[108:109], v45 offset:45056
    ds_read_b64_tr_b16 v[110:111], v45 offset:46080
    s_add_u32 m0, s82, 52224
    s_xor_b32 s89, s81, 20480
    s_mul_i32 s89, s89, 48
    s_add_u32 s89, s89, 1024
    buffer_load_dwordx4 v48, s[8:11], s89 offen offset:1024 lds
    s_waitcnt lgkmcnt(8)
    v_dot2_f32_bf16 v120, v176, v176, v120
    v_dot2_f32_bf16 v121, v177, v177, v121
    v_dot2_f32_bf16 v120, v178, v178, v120
    v_dot2_f32_bf16 v121, v179, v179, v121
    v_dot2_f32_bf16 v120, v180, v180, v120
    v_dot2_f32_bf16 v121, v181, v181, v121
    v_dot2_f32_bf16 v120, v182, v182, v120
    v_dot2_f32_bf16 v121, v183, v183, v121
    v_dot2_f32_bf16 v120, v184, v184, v120
    v_dot2_f32_bf16 v121, v185, v185, v121
    v_dot2_f32_bf16 v120, v186, v186, v120
    v_dot2_f32_bf16 v121, v187, v187, v121
    v_dot2_f32_bf16 v120, v188, v188, v120
    v_dot2_f32_bf16 v121, v189, v189, v121
    v_dot2_f32_bf16 v120, v190, v190, v120
    v_dot2_f32_bf16 v121, v191, v191, v121
    s_waitcnt lgkmcnt(4)
    v_mfma_f32_16x16x32_bf16 a[244:247], v[32:35], a[12:15], a[244:247]
    v_mfma_f32_16x16x32_bf16 a[248:251], v[32:35], a[44:47], a[248:251]
    v_mfma_f32_32x32x16_bf16 v[64:79], a[12:15], v[176:179], v[64:79]
    s_add_u32 m0, s52, 32768
    s_nop 0
    buffer_load_dwordx4 v14, s[4:7], s88 offen offset:2048  lds
    ds_read_b64_tr_b16 v[112:113], v46 offset:12288
    ds_read_b64_tr_b16 v[114:115], v46 offset:13312
    v_mfma_f32_16x16x32_bf16 a[240:243], v[32:35], v[180:183], a[240:243]
    v_mfma_f32_32x32x16_bf16 v[80:95], a[44:47], v[176:179], v[80:95]
    v_permlane32_swap_b32 v180, v182
    v_permlane32_swap_b32 v181, v183
    ds_read_b64_tr_b16 v[116:117], v46 offset:45056
    ds_read_b64_tr_b16 v[118:119], v46 offset:46080
    s_add_u32 m0, s82, 20480
    s_nop 0
    buffer_load_dwordx4 v48, s[8:11], s89 offen offset:0 lds
    s_waitcnt lgkmcnt(4)
    v_mfma_f32_32x32x16_bf16 v[64:79], v[104:107], v[180:183], v[64:79]
    s_add_u32 m0, s52, 32768
    s_nop 0
    buffer_load_dwordx4 v15, s[4:7], s88 offen offset:3072  lds
    ds_read_b64_tr_b16 v[96:97], v47 offset:12288
    ds_read_b64_tr_b16 v[98:99], v47 offset:13312
    v_mfma_f32_16x16x32_bf16 a[240:243], v[32:35], v[184:187], a[240:243]
    v_mfma_f32_32x32x16_bf16 v[80:95], v[108:111], v[180:183], v[80:95]
    v_permlane32_swap_b32 v184, v186
    v_permlane32_swap_b32 v185, v187
    ds_read_b64_tr_b16 v[100:101], v47 offset:45056
    ds_read_b64_tr_b16 v[102:103], v47 offset:46080
    s_xor_b32 s80, s81, 16384
    s_add_u32 m0, s82, 81920
    s_mul_i32 s80, s80, 48
    buffer_load_dwordx4 v48, s[8:11], s80 offen lds
    s_waitcnt lgkmcnt(4)
    v_mfma_f32_32x32x16_bf16 v[64:79], v[112:115], v[184:187], v[64:79]
    s_waitcnt vmcnt(8)
    s_barrier
    ds_read_b128 v[192:195], v16 offset:16384
    ds_read_b128 v[196:199], v17 offset:16384
    ds_read_b128 v[200:203], v18 offset:16384
    ds_read_b128 v[204:207], v19 offset:16384
    ds_read_b64_tr_b16 a[16:17], v44 offset:16384
    ds_read_b64_tr_b16 a[18:19], v44 offset:17408
    v_mfma_f32_16x16x32_bf16 a[240:243], v[32:35], v[188:191], a[240:243]
    v_mfma_f32_32x32x16_bf16 v[80:95], v[116:119], v[184:187], v[80:95]
    v_permlane32_swap_b32 v188, v190
    v_permlane32_swap_b32 v189, v191
    ds_read_b64_tr_b16 a[48:49], v44 offset:49152
    ds_read_b64_tr_b16 a[50:51], v44 offset:50176
    s_cmp_lg_u32 s79, 4
    s_cbranch_scc1 L_nores4
    ds_read_b64 v[4:5], v124 offset:16384
    v_xor_b32 v124, 32, v124
    ds_read_b64 v[6:7], v124 offset:16384
    v_xor_b32 v124, 96, v124
    ds_read_b64 v[8:9], v124 offset:16384
    v_xor_b32 v124, 32, v124
    ds_read_b64 v[10:11], v124 offset:16384
L_nores4:
    s_add_u32 m0, s52, 0
    s_xor_b32 s88, s50, 768
    buffer_load_dwordx4 v12, s[4:7], s88 offen offset:0  lds
    s_waitcnt lgkmcnt(8)
    v_mfma_f32_32x32x16_bf16 v[64:79], v[96:99], v[188:191], v[64:79]
    buffer_load_dwordx4 v13, s[4:7], s88 offen offset:1024  lds
    ds_read_b64_tr_b16 v[112:113], v45 offset:16384
    ds_read_b64_tr_b16 v[114:115], v45 offset:17408
    s_waitcnt lgkmcnt(9)
    v_mfma_f32_16x16x32_bf16 a[240:243], v[32:35], v[192:195], a[240:243]
    v_mfma_f32_32x32x16_bf16 v[80:95], v[100:103], v[188:191], v[80:95]
    v_permlane32_swap_b32 v192, v194
    v_permlane32_swap_b32 v193, v195
    ds_read_b64_tr_b16 v[116:117], v45 offset:49152
    ds_read_b64_tr_b16 v[118:119], v45 offset:50176
    s_add_u32 m0, s82, 56320
    s_xor_b32 s89, s81, 24576
    s_mul_i32 s89, s89, 48
    s_add_u32 s89, s89, 1024
    buffer_load_dwordx4 v48, s[8:11], s89 offen offset:1024 lds
    s_waitcnt lgkmcnt(8)
    v_dot2_f32_bf16 v120, v192, v192, v120
    v_dot2_f32_bf16 v121, v193, v193, v121
    v_dot2_f32_bf16 v120, v194, v194, v120
    v_dot2_f32_bf16 v121, v195, v195, v121
    v_dot2_f32_bf16 v120, v196, v196, v120
    v_dot2_f32_bf16 v121, v197, v197, v121
    v_dot2_f32_bf16 v120, v198, v198, v120
    v_dot2_f32_bf16 v121, v199, v199, v121
    v_dot2_f32_bf16 v120, v200, v200, v120
    v_dot2_f32_bf16 v121, v201, v201, v121
    v_dot2_f32_bf16 v120, v202, v202, v120
    v_dot2_f32_bf16 v121, v203, v203, v121
    v_dot2_f32_bf16 v120, v204, v204, v120
    v_dot2_f32_bf16 v121, v205, v205, v121
    v_dot2_f32_bf16 v120, v206, v206, v120
    v_dot2_f32_bf16 v121, v207, v207, v121
    s_waitcnt lgkmcnt(4)
    v_mfma_f32_16x16x32_bf16 a[244:247], v[32:35], a[16:19], a[244:247]
    v_mfma_f32_16x16x32_bf16 a[248:251], v[32:35], a[48:51], a[248:251]
    v_mfma_f32_32x32x16_bf16 v[64:79], a[16:19], v[192:195], v[64:79]
    s_add_u32 m0, s52, 0
    s_nop 0
    buffer_load_dwordx4 v14, s[4:7], s88 offen offset:2048  lds
    ds_read_b64_tr_b16 v[96:97], v46 offset:16384
    ds_read_b64_tr_b16 v[98:99], v46 offset:17408
    v_mfma_f32_16x16x32_bf16 a[240:243], v[32:35], v[196:199], a[240:243]
    v_mfma_f32_32x32x16_bf16 v[80:95], a[48:51], v[192:195], v[80:95]
    v_permlane32_swap_b32 v196, v198
    v_permlane32_swap_b32 v197, v199
    ds_read_b64_tr_b16 v[100:101], v46 offset:49152
    ds_read_b64_tr_b16 v[102:103], v46 offset:50176
    s_add_u32 m0, s82, 24576
    s_nop 0
    buffer_load_dwordx4 v48, s[8:11], s89 offen offset:0 lds
    s_waitcnt lgkmcnt(4)
    v_mfma_f32_32x32x16_bf16 v[64:79], v[112:115], v[196:199], v[64:79]
    s_add_u32 m0, s52, 0
    s_nop 0
    buffer_load_dwordx4 v15, s[4:7], s88 offen offset:3072  lds
    ds_read_b64_tr_b16 v[104:105], v47 offset:16384
    ds_read_b64_tr_b16 v[106:107], v47 offset:17408
    v_mfma_f32_16x16x32_bf16 a[240:243], v[32:35], v[200:203], a[240:243]
    v_mfma_f32_32x32x16_bf16 v[80:95], v[116:119], v[196:199], v[80:95]
    v_permlane32_swap_b32 v200, v202
    v_permlane32_swap_b32 v201, v203
    ds_read_b64_tr_b16 v[108:109], v47 offset:49152
    ds_read_b64_tr_b16 v[110:111], v47 offset:50176
    s_xor_b32 s80, s81, 20480
    s_add_u32 m0, s82, 86016
    s_mul_i32 s80, s80, 48
    buffer_load_dwordx4 v48, s[8:11], s80 offen lds
    s_waitcnt lgkmcnt(4)
    v_mfma_f32_32x32x16_bf16 v[64:79], v[96:99], v[200:203], v[64:79]
    s_waitcnt vmcnt(8)
    s_barrier
    ds_read_b128 v[208:211], v16 offset:32768
    ds_read_b128 v[212:215], v17 offset:32768
    ds_read_b128 v[216:219], v18 offset:32768
    ds_read_b128 v[220:223], v19 offset:32768
    ds_read_b64_tr_b16 a[20:21], v44 offset:20480
    ds_read_b64_tr_b16 a[22:23], v44 offset:21504
    v_mfma_f32_16x16x32_bf16 a[240:243], v[32:35], v[204:207], a[240:243]
    v_mfma_f32_32x32x16_bf16 v[80:95], v[100:103], v[200:203], v[80:95]
    v_permlane32_swap_b32 v204, v206
    v_permlane32_swap_b32 v205, v207
    ds_read_b64_tr_b16 a[52:53], v44 offset:53248
    ds_read_b64_tr_b16 a[54:55], v44 offset:54272
    s_cmp_lg_u32 s79, 5
    s_cbranch_scc1 L_nores5
    ds_read_b64 v[4:5], v124 offset:32768
    v_xor_b32 v124, 32, v124
    ds_read_b64 v[6:7], v124 offset:32768
    v_xor_b32 v124, 96, v124
    ds_read_b64 v[8:9], v124 offset:32768
    v_xor_b32 v124, 32, v124
    ds_read_b64 v[10:11], v124 offset:32768
L_nores5:
    s_add_u32 m0, s52, 16384
    s_xor_b32 s88, s50, 896
    buffer_load_dwordx4 v12, s[4:7], s88 offen offset:0  lds
    s_waitcnt lgkmcnt(8)
    v_mfma_f32_32x32x16_bf16 v[64:79], v[104:107], v[204:207], v[64:79]
    buffer_load_dwordx4 v13, s[4:7], s88 offen offset:1024  lds
    ds_read_b64_tr_b16 v[96:97], v45 offset:20480
    ds_read_b64_tr_b16 v[98:99], v45 offset:21504
    s_waitcnt lgkmcnt(9)
    v_mfma_f32_16x16x32_bf16 a[240:243], v[32:35], v[208:211], a[240:243]
    v_mfma_f32_32x32x16_bf16 v[80:95], v[108:111], v[204:207], v[80:95]
    v_permlane32_swap_b32 v208, v210
    v_permlane32_swap_b32 v209, v211
    ds_read_b64_tr_b16 v[100:101], v45 offset:53248
    ds_read_b64_tr_b16 v[102:103], v45 offset:54272
    s_add_u32 m0, s82, 60416
    s_xor_b32 s89, s81, 28672
    s_mul_i32 s89, s89, 48
    s_add_u32 s89, s89, 1024
    buffer_load_dwordx4 v48, s[8:11], s89 offen offset:1024 lds
    s_waitcnt lgkmcnt(8)
    v_dot2_f32_bf16 v120, v208, v208, v120
    v_dot2_f32_bf16 v121, v209, v209, v121
    v_dot2_f32_bf16 v120, v210, v210, v120
    v_dot2_f32_bf16 v121, v211, v211, v121
    v_dot2_f32_bf16 v120, v212, v212, v120
    v_dot2_f32_bf16 v121, v213, v213, v121
    v_dot2_f32_bf16 v120, v214, v214, v120
    v_dot2_f32_bf16 v121, v215, v215, v121
    v_dot2_f32_bf16 v120, v216, v216, v120
    v_dot2_f32_bf16 v121, v217, v217, v121
    v_dot2_f32_bf16 v120, v218, v218, v120
    v_dot2_f32_bf16 v121, v219, v219, v121
    v_dot2_f32_bf16 v120, v220, v220, v120
    v_dot2_f32_bf16 v121, v221, v221, v121
    v_dot2_f32_bf16 v120, v222, v222, v120
    v_dot2_f32_bf16 v121, v223, v223, v121
    s_waitcnt lgkmcnt(4)
    v_mfma_f32_16x16x32_bf16 a[244:247], v[32:35], a[20:23], a[244:247]
    v_mfma_f32_16x16x32_bf16 a[248:251], v[32:35], a[52:55], a[248:251]
    v_mfma_f32_32x32x16_bf16 v[64:79], a[20:23], v[208:211], v[64:79]
    s_add_u32 m0, s52, 16384
    s_nop 0
    buffer_load_dwordx4 v14, s[4:7], s88 offen offset:2048  lds
    ds_read_b64_tr_b16 v[104:105], v46 offset:20480
    ds_read_b64_tr_b16 v[106:107], v46 offset:21504
    v_mfma_f32_16x16x32_bf16 a[240:243], v[32:35], v[212:215], a[240:243]
    v_mfma_f32_32x32x16_bf16 v[80:95], a[52:55], v[208:211], v[80:95]
    v_permlane32_swap_b32 v212, v214
    v_permlane32_swap_b32 v213, v215
    ds_read_b64_tr_b16 v[108:109], v46 offset:53248
    ds_read_b64_tr_b16 v[110:111], v46 offset:54272
    s_add_u32 m0, s82, 28672
    s_nop 0
    buffer_load_dwordx4 v48, s[8:11], s89 offen offset:0 lds
    s_waitcnt lgkmcnt(4)
    v_mfma_f32_32x32x16_bf16 v[64:79], v[96:99], v[212:215], v[64:79]
    s_add_u32 m0, s52, 16384
    s_nop 0
    buffer_load_dwordx4 v15, s[4:7], s88 offen offset:3072  lds
    ds_read_b64_tr_b16 v[112:113], v47 offset:20480
    ds_read_b64_tr_b16 v[114:115], v47 offset:21504
    v_mfma_f32_16x16x32_bf16 a[240:243], v[32:35], v[216:219], a[240:243]
    v_mfma_f32_32x32x16_bf16 v[80:95], v[100:103], v[212:215], v[80:95]
    v_permlane32_swap_b32 v216, v218
    v_permlane32_swap_b32 v217, v219
    ds_read_b64_tr_b16 v[116:117], v47 offset:53248
    ds_read_b64_tr_b16 v[118:119], v47 offset:54272
    s_xor_b32 s80, s81, 24576
    s_add_u32 m0, s82, 90112
    s_mul_i32 s80, s80, 48
    buffer_load_dwordx4 v48, s[8:11], s80 offen lds
    s_waitcnt lgkmcnt(4)
    v_mfma_f32_32x32x16_bf16 v[64:79], v[104:107], v[216:219], v[64:79]
    s_waitcnt vmcnt(8)
    s_barrier
    ds_read_b128 v[224:227], v16 offset:0
L_pad1:
    s_cbranch_execz L_pad5
    ds_read_b128 v[228:231], v17 offset:0
    ds_read_b128 v[232:235], v18 offset:0
    ds_read_b128 v[236:239], v19 offset:0
    ds_read_b64_tr_b16 a[24:25], v44 offset:24576
    ds_read_b64_tr_b16 a[26:27], v44 offset:25600
    v_mfma_f32_16x16x32_bf16 a[240:243], v[32:35], v[220:223], a[240:243]
    v_mfma_f32_32x32x16_bf16 v[80:95], v[108:111], v[216:219], v[80:95]
    v_permlane32_swap_b32 v220, v222
    v_permlane32_swap_b32 v221, v223
    ds_read_b64_tr_b16 a[56:57], v44 offset:57344
    ds_read_b64_tr_b16 a[58:59], v44 offset:58368
    s_cmp_lg_u32 s79, 6
    s_cbranch_scc1 L_nores6
    ds_read_b64 v[4:5], v124 offset:0
    v_xor_b32 v124, 32, v124
    ds_read_b64 v[6:7], v124 offset:0
    v_xor_b32 v124, 96, v124
    ds_read_b64 v[8:9], v124 offset:0
    v_xor_b32 v124, 32, v124
    ds_read_b64 v[10:11], v124 offset:0
L_nores6:
    v_mov_b32 v122, -1
    v_mov_b32 v123, -1
    s_add_u32 s92, s68, 524288
    s_add_u32 s93, s71, 65536
    buffer_store_dwordx2 v[122:123], v59, s[36:39], s92 offen sc1
    buffer_store_dword v122, v60, s[36:39], s93 offen sc1
    s_waitcnt lgkmcnt(8)
    v_mfma_f32_32x32x16_bf16 v[64:79], v[112:115], v[220:223], v[64:79]
    s_xor_b32 s80, s81, 28672
    s_add_u32 m0, s82, 94208
    s_mul_i32 s80, s80, 48
    buffer_load_dwordx4 v48, s[8:11], s80 offen lds
    ds_read_b64_tr_b16 v[104:105], v45 offset:24576
    ds_read_b64_tr_b16 v[106:107], v45 offset:25600
    s_waitcnt lgkmcnt(9)
    v_mfma_f32_16x16x32_bf16 a[240:243], v[32:35], v[224:227], a[240:243]
    v_mfma_f32_32x32x16_bf16 v[80:95], v[116:119], v[220:223], v[80:95]
    v_permlane32_swap_b32 v224, v226
    v_permlane32_swap_b32 v225, v227
    ds_read_b64_tr_b16 v[108:109], v45 offset:57344
    ds_read_b64_tr_b16 v[110:111], v45 offset:58368
    s_lshl2_add_u32 s93, s2, s44
    s_lshl_b32 s93, s93, 9
    buffer_load_dword a255, v31, s[12:15], s93 offen
    s_waitcnt lgkmcnt(8)
    v_dot2_f32_bf16 v120, v224, v224, v120
    v_dot2_f32_bf16 v121, v225, v225, v121
    v_dot2_f32_bf16 v120, v226, v226, v120
    v_dot2_f32_bf16 v121, v227, v227, v121
    v_dot2_f32_bf16 v120, v228, v228, v120
    v_dot2_f32_bf16 v121, v229, v229, v121
    v_dot2_f32_bf16 v120, v230, v230, v120
    v_dot2_f32_bf16 v121, v231, v231, v121
    v_dot2_f32_bf16 v120, v232, v232, v120
    v_dot2_f32_bf16 v121, v233, v233, v121
    v_dot2_f32_bf16 v120, v234, v234, v120
    v_dot2_f32_bf16 v121, v235, v235, v121
    v_dot2_f32_bf16 v120, v236, v236, v120
    v_dot2_f32_bf16 v121, v237, v237, v121
    v_dot2_f32_bf16 v120, v238, v238, v120
    v_dot2_f32_bf16 v121, v239, v239, v121
    s_waitcnt lgkmcnt(4)
    v_mfma_f32_16x16x32_bf16 a[244:247], v[32:35], a[24:27], a[244:247]
    v_mfma_f32_16x16x32_bf16 a[248:251], v[32:35], a[56:59], a[248:251]
    v_mfma_f32_32x32x16_bf16 v[64:79], a[24:27], v[224:227], v[64:79]
    s_lshl_b32 s93, s44, 8
    s_add_u32 s93, s93, s2
    s_min_u32 s93, s93, 767
    s_lshl_b32 s93, s93, 11
    buffer_load_dword a255, v30, s[16:19], s93 offen
    ds_read_b64_tr_b16 v[112:113], v46 offset:24576
    ds_read_b64_tr_b16 v[114:115], v46 offset:25600
    v_mfma_f32_16x16x32_bf16 a[240:243], v[32:35], v[228:231], a[240:243]
    v_mfma_f32_32x32x16_bf16 v[80:95], a[56:59], v[224:227], v[80:95]
    v_permlane32_swap_b32 v228, v230
    v_permlane32_swap_b32 v229, v231
    ds_read_b64_tr_b16 v[116:117], v46 offset:57344
    ds_read_b64_tr_b16 v[118:119], v46 offset:58368
    s_lshl2_add_u32 s93, s2, s44
    s_lshl_b32 s93, s93, 9
    buffer_load_dword a255, v31, s[24:27], s93 offen
    s_waitcnt lgkmcnt(4)
    v_mfma_f32_32x32x16_bf16 v[64:79], v[104:107], v[228:231], v[64:79]
    buffer_load_dword a255, v30, s[36:39], s61 offen
    ds_read_b64_tr_b16 v[96:97], v47 offset:24576
    ds_read_b64_tr_b16 v[98:99], v47 offset:25600
    v_mfma_f32_16x16x32_bf16 a[240:243], v[32:35], v[232:235], a[240:243]
    v_mfma_f32_32x32x16_bf16 v[80:95], v[108:111], v[228:231], v[80:95]
    v_permlane32_swap_b32 v232, v234
    v_permlane32_swap_b32 v233, v235
    ds_read_b64_tr_b16 v[100:101], v47 offset:57344
    ds_read_b64_tr_b16 v[102:103], v47 offset:58368
    s_lshr_b32 s93, s2, 3
    s_cmp_eq_u32 s44, 3
    s_cbranch_scc1 L_p3w11
    s_mul_i32 s93, s93, 48
    s_add_u32 s93, s93, s44
    s_lshl_b32 s93, s93, 10
    v_mul_u32_u24 v58, 736, v62
    v_add_u32 v58, v58, v60
    v_lshl_add_u32 v58, v62, 5, v58
    buffer_load_dword a255, v58, s[16:19], s93 offen offset:384
    s_branch L_p3j11
L_p3w11:
    s_lshl_b32 s93, s93, 14
    v_lshl_add_u32 v58, v62, 8, v60
    buffer_load_dword a255, v58, s[24:27], s93 offen offset:384
L_p3j11:
    s_waitcnt lgkmcnt(4)
    v_mfma_f32_32x32x16_bf16 v[64:79], v[112:115], v[232:235], v[64:79]
    s_waitcnt vmcnt(9)
    s_barrier
    ds_read_b128 v[240:243], v16 offset:16384
    ds_read_b128 v[244:247], v17 offset:16384
    ds_read_b128 v[248:251], v18 offset:16384
    ds_read_b128 v[252:255], v19 offset:16384
    ds_read_b64_tr_b16 a[28:29], v44 offset:28672
    ds_read_b64_tr_b16 a[30:31], v44 offset:29696
    v_mfma_f32_16x16x32_bf16 a[240:243], v[32:35], v[236:239], a[240:243]
    v_mfma_f32_32x32x16_bf16 v[80:95], v[116:119], v[232:235], v[80:95]
    v_permlane32_swap_b32 v236, v238
    v_permlane32_swap_b32 v237, v239
    ds_read_b64_tr_b16 a[60:61], v44 offset:61440
    ds_read_b64_tr_b16 a[62:63], v44 offset:62464
    s_cmp_lg_u32 s79, 7
    s_cbranch_scc1 L_nores7
    ds_read_b64 v[4:5], v124 offset:16384
    v_xor_b32 v124, 32, v124
    ds_read_b64 v[6:7], v124 offset:16384
    v_xor_b32 v124, 96, v124
    ds_read_b64 v[8:9], v124 offset:16384
    v_xor_b32 v124, 32, v124
    ds_read_b64 v[10:11], v124 offset:16384
L_nores7:
    s_waitcnt lgkmcnt(8)
    v_mfma_f32_32x32x16_bf16 v[64:79], v[96:99], v[236:239], v[64:79]
    ds_read_b64_tr_b16 v[112:113], v45 offset:28672
    ds_read_b64_tr_b16 v[114:115], v45 offset:29696
    s_waitcnt lgkmcnt(9)
    v_mfma_f32_16x16x32_bf16 a[240:243], v[32:35], v[240:243], a[240:243]
    s_waitcnt lgkmcnt(8)
    v_mfma_f32_16x16x32_bf16 a[240:243], v[32:35], v[244:247], a[240:243]
    s_waitcnt lgkmcnt(7)
    v_mfma_f32_16x16x32_bf16 a[240:243], v[32:35], v[248:251], a[240:243]
    s_waitcnt lgkmcnt(6)
    v_mfma_f32_16x16x32_bf16 a[240:243], v[32:35], v[252:255], a[240:243]
    v_mfma_f32_32x32x16_bf16 v[80:95], v[100:103], v[236:239], v[80:95]
    v_permlane32_swap_b32 v240, v242
    v_permlane32_swap_b32 v241, v243
    ds_read_b64_tr_b16 v[116:117], v45 offset:61440
    ds_read_b64_tr_b16 v[118:119], v45 offset:62464
    v_dot2_f32_bf16 v120, v240, v240, v120
    v_dot2_f32_bf16 v121, v241, v241, v121
    v_dot2_f32_bf16 v120, v242, v242, v120
    v_dot2_f32_bf16 v121, v243, v243, v121
    v_dot2_f32_bf16 v120, v244, v244, v120
    v_dot2_f32_bf16 v121, v245, v245, v121
    v_dot2_f32_bf16 v120, v246, v246, v120
    v_dot2_f32_bf16 v121, v247, v247, v121
    v_dot2_f32_bf16 v120, v248, v248, v120
    v_dot2_f32_bf16 v121, v249, v249, v121
    v_dot2_f32_bf16 v120, v250, v250, v120
    v_dot2_f32_bf16 v121, v251, v251, v121
    v_dot2_f32_bf16 v120, v252, v252, v120
    v_dot2_f32_bf16 v121, v253, v253, v121
    v_dot2_f32_bf16 v120, v254, v254, v120
    v_dot2_f32_bf16 v121, v255, v255, v121
    s_waitcnt lgkmcnt(4)
    v_mfma_f32_16x16x32_bf16 a[244:247], v[32:35], a[28:31], a[244:247]
    v_mfma_f32_16x16x32_bf16 a[248:251], v[32:35], a[60:63], a[248:251]
    v_mfma_f32_32x32x16_bf16 v[64:79], a[28:31], v[240:243], v[64:79]
    ds_read_b64_tr_b16 v[96:97], v46 offset:28672
    ds_read_b64_tr_b16 v[98:99], v46 offset:29696
    s_nop 3
    ds_write_b32 v43, a244 offset:512
    ds_write_b32 v43, a248 offset:1024
    v_accvgpr_read_b32 v12, a240
    v_add_f32 v13, v120, v121
    v_mov_b32 v15, v13
    v_mfma_f32_32x32x16_bf16 v[80:95], a[60:63], v[240:243], v[80:95]
    v_permlane32_swap_b32 v244, v246
    v_permlane32_swap_b32 v245, v247
    ds_read_b64_tr_b16 v[100:101], v46 offset:61440
    ds_read_b64_tr_b16 v[102:103], v46 offset:62464
    v_permlane32_swap_b32 v13, v15
    v_add_f32 v13, v13, v15
    v_mul_f32 v12, 0xbb000000, v12
    v_mul_f32 v13, 0x3b000000, v13
    v_fma_f32 v13, -v12, v12, v13
    s_waitcnt lgkmcnt(2)
    s_barrier
    v_and_b32 v16, -16, v43
    ds_read_b128 v[16:19], v16 offset:512
    v_and_b32 v32, -16, v43
    ds_read_b128 v[32:35], v32 offset:1024
    v_mfma_f32_32x32x16_bf16 v[64:79], v[112:115], v[244:247], v[64:79]
    ds_read_b64_tr_b16 v[104:105], v47 offset:28672
    ds_read_b64_tr_b16 v[106:107], v47 offset:29696
    v_max_f32 v13, 0, v13
    v_add_f32 v13, 0x3727c5ac, v13
    v_rsq_f32 v38, v13
    v_and_b32 v14, s76, v12
    v_sub_f32 v14, v12, v14
    v_mfma_f32_32x32x16_bf16 v[80:95], v[116:119], v[244:247], v[80:95]
    v_permlane32_swap_b32 v248, v250
    v_permlane32_swap_b32 v249, v251
    ds_read_b64_tr_b16 v[108:109], v47 offset:61440
    ds_read_b64_tr_b16 v[110:111], v47 offset:62464
    s_mov_b64 vcc, 0xffffffff
    v_mul_f32 v39, s84, v38
    v_cndmask_b32 v12, v14, v12, vcc
    v_perm_b32 v36, v12, v12, s75
    v_lshrrev_b32 v37, 16, v12
    s_xor_b32 s80, s54, 0
    s_add_u32 m0, s80, 98304
    s_lshl3_add_u32 s80, s80, 0
    buffer_load_dwordx4 v49, s[12:15], s80 offen offset:0 lds
    s_waitcnt lgkmcnt(4)
    v_mfma_f32_32x32x16_bf16 v[64:79], v[96:99], v[248:251], v[64:79]
    v_add_f32 v16, v16, v18
    v_add_f32 v17, v17, v19
    v_add_f32 v16, v16, v17
    v_and_b32 v17, s76, v16
    v_sub_f32 v17, v16, v17
    v_mfma_f32_32x32x16_bf16 v[80:95], v[100:103], v[248:251], v[80:95]
    v_permlane32_swap_b32 v252, v254
    v_permlane32_swap_b32 v253, v255
    v_perm_b32 v26, v17, v16, s75
    v_and_b32 v18, s76, v17
    v_sub_f32 v18, v17, v18
    v_lshrrev_b32 v27, 16, v18
    v_add_f32 v32, v32, v34
    s_add_u32 s80, s80, 7168
    buffer_load_dwordx4 v49, s[12:15], s80 offen offset:1024 lds
    v_mfma_f32_32x32x8_bf16 v[64:79], v[26:27], v[36:37], v[64:79]
    v_add_f32 v33, v33, v35
    v_add_f32 v32, v32, v33
    v_and_b32 v33, s76, v32
    v_sub_f32 v33, v32, v33
    v_perm_b32 v28, v33, v32, s75
    s_waitcnt lgkmcnt(0)
    v_mfma_f32_32x32x16_bf16 v[64:79], v[104:107], v[252:255], v[64:79]
    v_and_b32 v34, s76, v33
    v_sub_f32 v34, v33, v34
    v_lshrrev_b32 v29, 16, v34
    s_nop 1
    v_mfma_f32_32x32x8_bf16 v[80:95], v[28:29], v[36:37], v[80:95]
    v_mfma_f32_32x32x16_bf16 v[80:95], v[108:111], v[252:255], v[80:95]
    s_xor_b32 s80, s54, 8192
    s_add_u32 m0, s80, 98304
    s_lshl3_add_u32 s80, s80, 0
    buffer_load_dwordx4 v49, s[12:15], s80 offen offset:0 lds
    s_add_u32 s80, s80, 7168
    buffer_load_dwordx4 v49, s[12:15], s80 offen offset:1024 lds
    v_add_u32 v44, 65536, v44
    v_add_u32 v45, 65536, v45
    v_add_u32 v46, 65536, v46
    v_add_u32 v47, 65536, v47
    s_add_u32 s88, s68, 0
    s_add_u32 s89, s71, 0
    v_pk_mul_f32 v[96:97], v[64:65], v[38:39] op_sel:[0,1] op_sel_hi:[1,1]
    v_pk_mul_f32 v[98:99], v[66:67], v[38:39] op_sel:[0,1] op_sel_hi:[1,1]
    v_pk_mul_f32 v[100:101], v[68:69], v[38:39] op_sel:[0,1] op_sel_hi:[1,1]
    v_pk_mul_f32 v[102:103], v[70:71], v[38:39] op_sel:[0,1] op_sel_hi:[1,1]
    v_exp_f32_e64 v96, v96 clamp
    v_exp_f32_e64 v97, v97 clamp
    v_exp_f32_e64 v98, v98 clamp
    v_exp_f32_e64 v99, v99 clamp
    v_exp_f32_e64 v100, v100 clamp
    v_exp_f32_e64 v101, v101 clamp
    v_exp_f32_e64 v102, v102 clamp
    v_exp_f32_e64 v103, v103 clamp
    v_pk_fma_f32 v[64:65], v[64:65], v[38:39], 1.0 op_sel_hi:[1,0,0]
    v_pk_fma_f32 v[66:67], v[66:67], v[38:39], 1.0 op_sel_hi:[1,0,0]
    v_pk_fma_f32 v[68:69], v[68:69], v[38:39], 1.0 op_sel_hi:[1,0,0]
    v_pk_fma_f32 v[70:71], v[70:71], v[38:39], 1.0 op_sel_hi:[1,0,0]
    v_max_f32 v64, v64, v96
    v_max_f32 v65, v65, v97
    v_max_f32 v66, v66, v98
    v_max_f32 v67, v67, v99
    v_max_f32 v68, v68, v100
    v_max_f32 v69, v69, v101
    v_max_f32 v70, v70, v102
    v_max_f32_e64 v71, v71, v103
    v_pk_add_f32 v[64:65], v[64:65], s[86:87]
    v_pk_add_f32 v[66:67], v[66:67], s[86:87]
    v_pk_add_f32 v[68:69], v[68:69], s[86:87]
    v_pk_add_f32 v[70:71], v[70:71], s[86:87]
    v_cvt_pk_bf16_f32 v120, v64, v65
    v_cvt_pk_bf16_f32 v121, v66, v67
    v_cvt_pk_bf16_f32 v122, v68, v69
    v_cvt_pk_bf16_f32 v123, v70, v71
    ds_write_b128 v50, v[120:123] offset:0
    v_pk_mul_f32 v[104:105], v[72:73], v[38:39] op_sel:[0,1] op_sel_hi:[1,1]
    v_pk_mul_f32 v[106:107], v[74:75], v[38:39] op_sel:[0,1] op_sel_hi:[1,1]
    v_pk_mul_f32 v[108:109], v[76:77], v[38:39] op_sel:[0,1] op_sel_hi:[1,1]
    v_pk_mul_f32 v[110:111], v[78:79], v[38:39] op_sel:[0,1] op_sel_hi:[1,1]
    v_exp_f32_e64 v104, v104 clamp
    v_exp_f32_e64 v105, v105 clamp
    v_exp_f32_e64 v106, v106 clamp
    v_exp_f32_e64 v107, v107 clamp
    v_exp_f32_e64 v108, v108 clamp
    v_exp_f32_e64 v109, v109 clamp
    v_exp_f32_e64 v110, v110 clamp
    v_exp_f32_e64 v111, v111 clamp
    v_pk_fma_f32 v[72:73], v[72:73], v[38:39], 1.0 op_sel_hi:[1,0,0]
    v_pk_fma_f32 v[74:75], v[74:75], v[38:39], 1.0 op_sel_hi:[1,0,0]
    v_pk_fma_f32 v[76:77], v[76:77], v[38:39], 1.0 op_sel_hi:[1,0,0]
    v_pk_fma_f32 v[78:79], v[78:79], v[38:39], 1.0 op_sel_hi:[1,0,0]
    v_max_f32 v72, v72, v104
    v_max_f32 v73, v73, v105
    v_max_f32 v74, v74, v106
    v_max_f32 v75, v75, v107
    v_max_f32 v76, v76, v108
    v_max_f32 v77, v77, v109
    v_max_f32 v78, v78, v110
    v_max_f32 v79, v79, v111
    v_pk_add_f32 v[72:73], v[72:73], s[86:87]
    v_pk_add_f32 v[74:75], v[74:75], s[86:87]
    v_pk_add_f32 v[76:77], v[76:77], s[86:87]
    v_pk_add_f32 v[78:79], v[78:79], s[86:87]
    v_cvt_pk_bf16_f32 v124, v72, v73
    v_cvt_pk_bf16_f32 v125, v74, v75
    v_cvt_pk_bf16_f32 v126, v76, v77
    v_cvt_pk_bf16_f32 v127, v78, v79
    ds_write_b128 v50, v[124:127] offset:4352
    v_pk_mul_f32 v[80:81], v[80:81], v[38:39] op_sel_hi:[1,0]
    v_pk_mul_f32 v[82:83], v[82:83], v[38:39] op_sel_hi:[1,0]
    v_pk_mul_f32 v[84:85], v[84:85], v[38:39] op_sel_hi:[1,0]
    v_pk_mul_f32 v[86:87], v[86:87], v[38:39] op_sel_hi:[1,0]
    v_cvt_pk_bf16_f32 v80, v80, v81
    v_cvt_pk_bf16_f32 v81, v82, v83
    v_cvt_pk_bf16_f32 v82, v84, v85
    v_cvt_pk_bf16_f32 v83, v86, v87
    v_pk_mul_f32 v[88:89], v[88:89], v[38:39] op_sel_hi:[1,0]
    v_pk_mul_f32 v[90:91], v[90:91], v[38:39] op_sel_hi:[1,0]
    v_pk_mul_f32 v[92:93], v[92:93], v[38:39] op_sel_hi:[1,0]
    v_pk_mul_f32 v[94:95], v[94:95], v[38:39] op_sel_hi:[1,0]
    v_cvt_pk_bf16_f32 v84, v88, v89
    v_cvt_pk_bf16_f32 v85, v90, v91
    v_cvt_pk_bf16_f32 v86, v92, v93
    v_cvt_pk_bf16_f32 v87, v94, v95
    ds_write_b128 v50, v[80:83] offset:17408
    ds_write_b128 v50, v[84:87] offset:21760
    v_mov_b32 v124, s74
    v_mov_b32 v125, s74
    v_mov_b32 v126, s74
    v_mov_b32 v127, s74
    s_waitcnt vmcnt(10)
    s_waitcnt vmcnt(9)
    s_waitcnt lgkmcnt(0)
    s_barrier
    ds_read_b64_tr_b16 v[64:65], v52 offset:0
    ds_read_b64_tr_b16 v[66:67], v52 offset:256
    ds_read_b64_tr_b16 v[80:81], v52 offset:17408
    ds_read_b64_tr_b16 v[82:83], v52 offset:17664
    ds_read_b64_tr_b16 v[68:69], v52 offset:512
    ds_read_b64_tr_b16 v[70:71], v52 offset:768
    ds_read_b64_tr_b16 v[84:85], v52 offset:17920
    ds_read_b64_tr_b16 v[86:87], v52 offset:18176
    ds_read_b64_tr_b16 v[72:73], v52 offset:1024
    ds_read_b64_tr_b16 v[74:75], v52 offset:1280
    ds_read_b64_tr_b16 v[88:89], v52 offset:18432
    ds_read_b64_tr_b16 v[90:91], v52 offset:18688
    ds_read_b64_tr_b16 v[76:77], v52 offset:1536
    ds_read_b64_tr_b16 v[78:79], v52 offset:1792
    ds_read_b64_tr_b16 v[92:93], v52 offset:18944
    ds_read_b64_tr_b16 v[94:95], v52 offset:19200
    v_add_u32 v122, s72, v59
    v_add_u32 v123, s72, v60
    s_xor_b32 s80, s54, 16384
    s_add_u32 m0, s80, 98304
    s_lshl3_add_u32 s80, s80, 0
    buffer_load_dwordx4 v49, s[12:15], s80 offen offset:0 lds
    s_add_u32 s80, s80, 7168
    buffer_load_dwordx4 v49, s[12:15], s80 offen offset:1024 lds
    s_waitcnt lgkmcnt(12)
    v_mfma_f32_16x16x32_bf16 v[112:115], v[64:67], v[80:83], 0
    v_mfma_f32_16x16x32_bf16 v[116:119], v[124:127], v[64:67], 0
    ds_read_b64_tr_b16 a[64:65], v44 offset:0
    ds_read_b64_tr_b16 a[66:67], v44 offset:1024
    s_waitcnt lgkmcnt(10)
    v_mfma_f32_16x16x32_bf16 v[112:115], v[68:71], v[84:87], v[112:115]
    v_mfma_f32_16x16x32_bf16 v[116:119], v[124:127], v[68:71], v[116:119]
    ds_read_b64_tr_b16 a[68:69], v44 offset:4096
    ds_read_b64_tr_b16 a[70:71], v44 offset:5120
    s_waitcnt lgkmcnt(8)
    v_mfma_f32_16x16x32_bf16 v[112:115], v[72:75], v[88:91], v[112:115]
    v_mfma_f32_16x16x32_bf16 v[116:119], v[124:127], v[72:75], v[116:119]
    ds_read_b64_tr_b16 a[72:73], v44 offset:8192
    ds_read_b64_tr_b16 a[74:75], v44 offset:9216
    s_waitcnt lgkmcnt(6)
    v_mfma_f32_16x16x32_bf16 v[112:115], v[76:79], v[92:95], v[112:115]
    v_mfma_f32_16x16x32_bf16 v[116:119], v[124:127], v[76:79], v[116:119]
    ds_read_b64_tr_b16 a[76:77], v44 offset:12288
    ds_read_b64_tr_b16 a[78:79], v44 offset:13312
    s_nop 4
    v_cvt_pk_bf16_f32 v120, v112, v113
    v_cvt_pk_bf16_f32 v121, v114, v115
    v_min_u32 v120, -2, v120
    v_min_u32 v121, -2, v121
    buffer_store_dwordx2 v[120:121], v122, s[36:39], s88 offen sc1
    v_min_u32 v124, -2, v116
    buffer_store_dword v124, v123, s[36:39], s89 offen sc1
    s_waitcnt lgkmcnt(6)
    v_mfma_f32_32x32x16_bf16 v[64:79], a[64:67], v[128:131], 0
    s_mov_b32 vcc_lo, 0xf0f00f0f
    s_mov_b32 vcc_hi, 0xf0f00f0f
    v_mov_b32 v89, s74
    v_cndmask_b32 v88, 0, v89, vcc
    v_mov_b32 v89, v88
    v_mov_b32 v90, v88
    v_mov_b32 v91, v88
    ds_read_b64_tr_b16 a[80:81], v44 offset:16384
    ds_read_b64_tr_b16 a[82:83], v44 offset:17408
    s_waitcnt lgkmcnt(6)
    v_mfma_f32_32x32x16_bf16 v[64:79], a[68:71], v[144:147], v[64:79]
    ds_read_b64_tr_b16 a[84:85], v44 offset:20480
    ds_read_b64_tr_b16 a[86:87], v44 offset:21504
    v_mov_b32 v124, -1
    v_mov_b32 v125, -1
    s_add_u32 s92, s68, 1048576
    s_add_u32 s93, s71, 131072
    buffer_store_dwordx2 v[124:125], v122, s[36:39], s92 offen sc1
    buffer_store_dword v124, v123, s[36:39], s93 offen sc1
    s_xor_b32 s80, s54, 24576
    s_add_u32 m0, s80, 98304
    s_lshl3_add_u32 s80, s80, 0
    buffer_load_dwordx4 v49, s[12:15], s80 offen offset:0 lds
    s_waitcnt lgkmcnt(4)
    v_mfma_f32_16x16x32_bf16 v[92:95], v[88:91], a[64:67], 0
    v_mfma_f32_32x32x16_bf16 v[64:79], a[72:75], v[160:163], v[64:79]
    ds_read_b64_tr_b16 a[88:89], v44 offset:24576
    ds_read_b64_tr_b16 a[90:91], v44 offset:25600
    v_and_b32 v123, 0x7c, v3
    buffer_load_dword v122, v123, s[32:35], 0 offen sc1
    s_add_u32 s80, s80, 7168
    buffer_load_dwordx4 v49, s[12:15], s80 offen offset:1024 lds
    v_mfma_f32_16x16x32_bf16 v[92:95], v[88:91], a[68:71], v[92:95]
    v_mfma_f32_32x32x16_bf16 v[64:79], a[76:79], v[176:179], v[64:79]
    ds_read_b64_tr_b16 a[92:93], v44 offset:28672
    ds_read_b64_tr_b16 a[94:95], v44 offset:29696
    s_lshl_b32 s93, s46, 11
    s_add_u32 s93, s93, s56
    buffer_load_dword a255, v30, s[36:39], s93 offen
    s_and_b32 s93, s46, 3
    s_lshl_b32 s93, s93, 9
    s_add_u32 s93, s93, s58
    buffer_load_dword a255, v31, s[36:39], s93 offen
    s_waitcnt lgkmcnt(4)
    v_mfma_f32_16x16x32_bf16 v[92:95], v[88:91], a[72:75], v[92:95]
    v_mfma_f32_32x32x16_bf16 v[64:79], a[80:83], v[192:195], v[64:79]
    ds_read_b64_tr_b16 v[104:105], v45 offset:0
    ds_read_b64_tr_b16 v[106:107], v45 offset:1024
    s_xor_b32 s80, s54, 0
    s_add_u32 m0, s80, 0
    s_lshl3_add_u32 s80, s80, 262144
    buffer_load_dwordx4 v49, s[12:15], s80 offen offset:0 lds
    v_mfma_f32_16x16x32_bf16 v[92:95], v[88:91], a[76:79], v[92:95]
    v_mfma_f32_32x32x16_bf16 v[64:79], a[84:87], v[208:211], v[64:79]
    ds_read_b64_tr_b16 v[108:109], v46 offset:0
    ds_read_b64_tr_b16 v[110:111], v46 offset:1024
    s_waitcnt lgkmcnt(4)
    v_mfma_f32_16x16x32_bf16 v[92:95], v[88:91], a[80:83], v[92:95]
    v_mfma_f32_32x32x16_bf16 v[64:79], a[88:91], v[224:227], v[64:79]
    ds_read_b64_tr_b16 v[112:113], v47 offset:0
    ds_read_b64_tr_b16 v[114:115], v47 offset:1024
    s_add_u32 s80, s80, 7168
    buffer_load_dwordx4 v49, s[12:15], s80 offen offset:1024 lds
    v_mfma_f32_16x16x32_bf16 v[92:95], v[88:91], a[84:87], v[92:95]
    v_mfma_f32_32x32x16_bf16 v[64:79], a[92:95], v[240:243], v[64:79]
    ds_read_b64_tr_b16 v[116:117], v45 offset:4096
    ds_read_b64_tr_b16 v[118:119], v45 offset:5120
    s_waitcnt lgkmcnt(4)
    v_mfma_f32_16x16x32_bf16 v[92:95], v[88:91], a[88:91], v[92:95]
    v_mfma_f32_32x32x16_bf16 v[64:79], v[104:107], v[132:135], v[64:79]
    ds_read_b64_tr_b16 v[96:97], v46 offset:4096
    ds_read_b64_tr_b16 v[98:99], v46 offset:5120
    s_xor_b32 s80, s54, 8192
    s_add_u32 m0, s80, 0
    s_lshl3_add_u32 s80, s80, 262144
    buffer_load_dwordx4 v49, s[12:15], s80 offen offset:0 lds
    v_mfma_f32_16x16x32_bf16 v[92:95], v[88:91], a[92:95], v[92:95]
    v_mfma_f32_32x32x16_bf16 v[64:79], v[108:111], v[136:139], v[64:79]
    ds_read_b64_tr_b16 v[100:101], v47 offset:4096
    ds_read_b64_tr_b16 v[102:103], v47 offset:5120
    s_waitcnt lgkmcnt(4)
    v_mfma_f32_32x32x16_bf16 v[64:79], v[112:115], v[140:143], v[64:79]
    ds_read_b64_tr_b16 v[104:105], v45 offset:8192
    ds_read_b64_tr_b16 v[106:107], v45 offset:9216
    s_add_u32 s80, s80, 7168
    buffer_load_dwordx4 v49, s[12:15], s80 offen offset:1024 lds
    v_mfma_f32_32x32x16_bf16 v[64:79], v[116:119], v[148:151], v[64:79]
    ds_read_b64_tr_b16 v[108:109], v46 offset:8192
    ds_read_b64_tr_b16 v[110:111], v46 offset:9216
    ds_write_b32 v43, v92 offset:0
    s_waitcnt lgkmcnt(5)
    v_mfma_f32_32x32x16_bf16 v[64:79], v[96:99], v[152:155], v[64:79]
    ds_read_b64_tr_b16 v[112:113], v47 offset:8192
    ds_read_b64_tr_b16 v[114:115], v47 offset:9216
    s_xor_b32 s80, s54, 16384
    s_add_u32 m0, s80, 0
    s_lshl3_add_u32 s80, s80, 262144
    buffer_load_dwordx4 v49, s[12:15], s80 offen offset:0 lds
    v_mfma_f32_32x32x16_bf16 v[64:79], v[100:103], v[156:159], v[64:79]
    ds_read_b64_tr_b16 v[116:117], v45 offset:12288
    ds_read_b64_tr_b16 v[118:119], v45 offset:13312
    s_waitcnt lgkmcnt(4)
    s_barrier
    v_and_b32 v80, -16, v43
    ds_read_b128 v[80:83], v80 offset:0
    v_mfma_f32_32x32x16_bf16 v[64:79], v[104:107], v[164:167], v[64:79]
    ds_read_b64_tr_b16 v[96:97], v46 offset:12288
    ds_read_b64_tr_b16 v[98:99], v46 offset:13312
    s_add_u32 s80, s80, 7168
    buffer_load_dwordx4 v49, s[12:15], s80 offen offset:1024 lds
    v_mfma_f32_32x32x16_bf16 v[64:79], v[108:111], v[168:171], v[64:79]
    ds_read_b64_tr_b16 v[100:101], v47 offset:12288
    ds_read_b64_tr_b16 v[102:103], v47 offset:13312
    s_waitcnt lgkmcnt(5)
    v_mfma_f32_32x32x16_bf16 v[64:79], v[112:115], v[172:175], v[64:79]
    ds_read_b64_tr_b16 v[104:105], v45 offset:16384
    ds_read_b64_tr_b16 v[106:107], v45 offset:17408
    s_xor_b32 s80, s54, 24576
    s_add_u32 m0, s80, 0
    s_lshl3_add_u32 s80, s80, 262144
    buffer_load_dwordx4 v49, s[12:15], s80 offen offset:0 lds
    s_waitcnt lgkmcnt(6)
    v_add_f32 v80, v80, v82
    v_add_f32 v81, v81, v83
    v_mfma_f32_32x32x16_bf16 v[64:79], v[116:119], v[180:183], v[64:79]
    ds_read_b64_tr_b16 v[108:109], v46 offset:16384
    ds_read_b64_tr_b16 v[110:111], v46 offset:17408
    v_add_f32 v80, v80, v81
    v_and_b32 v81, s76, v80
    s_waitcnt lgkmcnt(4)
    v_mfma_f32_32x32x16_bf16 v[64:79], v[96:99], v[184:187], v[64:79]
    ds_read_b64_tr_b16 v[112:113], v47 offset:16384
    ds_read_b64_tr_b16 v[114:115], v47 offset:17408
    s_add_u32 s80, s80, 7168
    buffer_load_dwordx4 v49, s[12:15], s80 offen offset:1024 lds
    v_sub_f32 v81, v80, v81
    v_perm_b32 v24, v81, v80, s75
    v_mfma_f32_32x32x16_bf16 v[64:79], v[100:103], v[188:191], v[64:79]
    ds_read_b64_tr_b16 v[116:117], v45 offset:20480
    ds_read_b64_tr_b16 v[118:119], v45 offset:21504
    v_and_b32 v82, s76, v81
    v_sub_f32 v82, v81, v82
    s_waitcnt lgkmcnt(4)
    v_mfma_f32_32x32x16_bf16 v[64:79], v[104:107], v[196:199], v[64:79]
    ds_read_b64_tr_b16 v[96:97], v46 offset:20480
    ds_read_b64_tr_b16 v[98:99], v46 offset:21504
    v_lshrrev_b32 v25, 16, v82
    v_mfma_f32_32x32x16_bf16 v[64:79], v[108:111], v[200:203], v[64:79]
    ds_read_b64_tr_b16 v[100:101], v47 offset:20480
    ds_read_b64_tr_b16 v[102:103], v47 offset:21504
    v_mfma_f32_32x32x8_bf16 v[64:79], v[24:25], v[36:37], v[64:79]
    s_waitcnt lgkmcnt(4)
    v_mfma_f32_32x32x16_bf16 v[64:79], v[112:115], v[204:207], v[64:79]
    ds_read_b64_tr_b16 v[104:105], v45 offset:24576
    ds_read_b64_tr_b16 v[106:107], v45 offset:25600
    s_waitcnt vmcnt(11)
    s_mov_b32 s90, 0x11111111
L_all_chk:
    v_dot8_u32_u4 v121, v122, s90, 0
    s_lshl_b32 s91, 8, s77
    s_nop 1
    v_cmp_ne_u32 vcc, 8, v121
    s_cbranch_vccnz L_all_retry
    v_cmp_ne_u32 vcc, s91, v122
    s_lshl_b32 s91, s45, 1
    s_lshr_b32 s50, vcc_lo, s91
    s_and_b32 s50, s50, 3
    s_cselect_b32 s52, 5242880, 0
    s_cselect_b32 s91, 0x4000, 0
    s_add_u32 s81, s63, s91
    s_add_u32 s82, s65, s91
    s_add_u32 s60, s60, s52
    s_add_u32 s61, s61, s52
    s_add_u32 s89, s69, 0
    buffer_load_dword v160, v3, s[36:39], s89 offen offset:0 sc1
    v_mfma_f32_32x32x16_bf16 v[64:79], v[116:119], v[212:215], v[64:79]
    ds_read_b64_tr_b16 v[108:109], v46 offset:24576
    ds_read_b64_tr_b16 v[110:111], v46 offset:25600
    buffer_load_dword v161, v3, s[36:39], s89 offen offset:256 sc1
    s_waitcnt lgkmcnt(4)
    v_mfma_f32_32x32x16_bf16 v[64:79], v[96:99], v[216:219], v[64:79]
    ds_read_b64_tr_b16 v[112:113], v47 offset:24576
    ds_read_b64_tr_b16 v[114:115], v47 offset:25600
    s_add_u32 s88, s66, 0
    buffer_load_dwordx4 v[128:131], v2, s[36:39], s88 offen offset:0 sc1
    v_mfma_f32_32x32x16_bf16 v[64:79], v[100:103], v[220:223], v[64:79]
    ds_read_b64_tr_b16 v[116:117], v45 offset:28672
    ds_read_b64_tr_b16 v[118:119], v45 offset:29696
    buffer_load_dwordx4 v[132:135], v2, s[36:39], s88 offen offset:1024 sc1
    s_waitcnt lgkmcnt(4)
    v_mfma_f32_32x32x16_bf16 v[64:79], v[104:107], v[228:231], v[64:79]
    ds_read_b64_tr_b16 v[96:97], v46 offset:28672
    ds_read_b64_tr_b16 v[98:99], v46 offset:29696
    buffer_load_dwordx4 v[136:139], v2, s[36:39], s88 offen offset:2048 sc1
    v_mfma_f32_32x32x16_bf16 v[64:79], v[108:111], v[232:235], v[64:79]
    ds_read_b64_tr_b16 v[100:101], v47 offset:28672
    ds_read_b64_tr_b16 v[102:103], v47 offset:29696
    buffer_load_dwordx4 v[140:143], v2, s[36:39], s88 offen offset:3072 sc1
    s_waitcnt lgkmcnt(4)
    v_mfma_f32_32x32x16_bf16 v[64:79], v[112:115], v[236:239], v[64:79]
    buffer_load_dword a255, v62, s[36:39], s62 offen sc1
    v_mfma_f32_32x32x16_bf16 v[64:79], v[116:119], v[244:247], v[64:79]
    buffer_load_dword a255, v62, s[36:39], s64 offen sc1
    s_waitcnt lgkmcnt(0)
    v_mfma_f32_32x32x16_bf16 v[64:79], v[96:99], v[248:251], v[64:79]
    s_mov_b32 m0, 162432
L_pad2:
    s_cbranch_execz L_pad6
    s_lshl_b32 s92, s46, 10
    buffer_load_dwordx4 v2, s[20:23], s92 offen lds
    v_mfma_f32_32x32x16_bf16 v[64:79], v[100:103], v[252:255], v[64:79]
    s_nop 11
    v_pk_mul_f32 v[96:97], v[64:65], v[38:39] op_sel:[0,1] op_sel_hi:[1,1]
    v_pk_mul_f32 v[98:99], v[66:67], v[38:39] op_sel:[0,1] op_sel_hi:[1,1]
    v_pk_mul_f32 v[100:101], v[68:69], v[38:39] op_sel:[0,1] op_sel_hi:[1,1]
    v_pk_mul_f32 v[102:103], v[70:71], v[38:39] op_sel:[0,1] op_sel_hi:[1,1]
    v_exp_f32_e64 v96, v96 clamp
    v_exp_f32_e64 v97, v97 clamp
    v_exp_f32_e64 v98, v98 clamp
    v_exp_f32_e64 v99, v99 clamp
    v_exp_f32_e64 v100, v100 clamp
    v_exp_f32_e64 v101, v101 clamp
    v_exp_f32_e64 v102, v102 clamp
    v_exp_f32_e64 v103, v103 clamp
    s_xor_b32 s80, s53, 0
    s_add_u32 m0, s80, 31744
    s_mul_i32 s80, s80, 48
    buffer_load_dwordx4 v48, s[16:19], s80 offen offset:1024 lds
    s_add_u32 s80, s80, 48128
    buffer_load_dwordx4 v48, s[16:19], s80 offen offset:2048 lds
    v_pk_fma_f32 v[64:65], v[64:65], v[38:39], 1.0 op_sel_hi:[1,0,0]
    v_pk_fma_f32 v[66:67], v[66:67], v[38:39], 1.0 op_sel_hi:[1,0,0]
    v_pk_fma_f32 v[68:69], v[68:69], v[38:39], 1.0 op_sel_hi:[1,0,0]
    v_pk_fma_f32 v[70:71], v[70:71], v[38:39], 1.0 op_sel_hi:[1,0,0]
    v_max_f32 v64, v64, v96
    v_max_f32 v65, v65, v97
    v_max_f32 v66, v66, v98
    v_max_f32 v67, v67, v99
    v_max_f32 v68, v68, v100
    v_max_f32 v69, v69, v101
    v_max_f32 v70, v70, v102
    v_max_f32_e64 v71, v71, v103
    v_pk_add_f32 v[64:65], v[64:65], s[86:87]
    v_pk_add_f32 v[66:67], v[66:67], s[86:87]
    v_pk_add_f32 v[68:69], v[68:69], s[86:87]
    v_pk_add_f32 v[70:71], v[70:71], s[86:87]
    v_cvt_pk_bf16_f32 v192, v64, v65
    v_cvt_pk_bf16_f32 v193, v66, v67
    v_cvt_pk_bf16_f32 v194, v68, v69
    v_cvt_pk_bf16_f32 v195, v70, v71
    s_xor_b32 s80, s53, 8192
    s_add_u32 m0, s80, 31744
    s_mul_i32 s80, s80, 48
    buffer_load_dwordx4 v48, s[16:19], s80 offen offset:1024 lds
    s_add_u32 s80, s80, 48128
    buffer_load_dwordx4 v48, s[16:19], s80 offen offset:2048 lds
    v_pk_mul_f32 v[104:105], v[72:73], v[38:39] op_sel:[0,1] op_sel_hi:[1,1]
    v_pk_mul_f32 v[106:107], v[74:75], v[38:39] op_sel:[0,1] op_sel_hi:[1,1]
    v_pk_mul_f32 v[108:109], v[76:77], v[38:39] op_sel:[0,1] op_sel_hi:[1,1]
    v_pk_mul_f32 v[110:111], v[78:79], v[38:39] op_sel:[0,1] op_sel_hi:[1,1]
    v_exp_f32_e64 v104, v104 clamp
    v_exp_f32_e64 v105, v105 clamp
    v_exp_f32_e64 v106, v106 clamp
    v_exp_f32_e64 v107, v107 clamp
    v_exp_f32_e64 v108, v108 clamp
    v_exp_f32_e64 v109, v109 clamp
    v_exp_f32_e64 v110, v110 clamp
    v_exp_f32_e64 v111, v111 clamp
    s_xor_b32 s80, s53, 16384
    s_add_u32 m0, s80, 31744
    s_mul_i32 s80, s80, 48
    buffer_load_dwordx4 v48, s[16:19], s80 offen offset:1024 lds
    s_add_u32 s80, s80, 48128
    buffer_load_dwordx4 v48, s[16:19], s80 offen offset:2048 lds
    v_pk_fma_f32 v[72:73], v[72:73], v[38:39], 1.0 op_sel_hi:[1,0,0]
    v_pk_fma_f32 v[74:75], v[74:75], v[38:39], 1.0 op_sel_hi:[1,0,0]
    v_pk_fma_f32 v[76:77], v[76:77], v[38:39], 1.0 op_sel_hi:[1,0,0]
    v_pk_fma_f32 v[78:79], v[78:79], v[38:39], 1.0 op_sel_hi:[1,0,0]
    v_max_f32 v72, v72, v104
    v_max_f32 v73, v73, v105
    v_max_f32 v74, v74, v106
    v_max_f32 v75, v75, v107
    v_max_f32 v76, v76, v108
    v_max_f32 v77, v77, v109
    v_max_f32 v78, v78, v110
    v_max_f32 v79, v79, v111
    v_pk_add_f32 v[72:73], v[72:73], s[86:87]
    v_pk_add_f32 v[74:75], v[74:75], s[86:87]
    v_pk_add_f32 v[76:77], v[76:77], s[86:87]
    v_pk_add_f32 v[78:79], v[78:79], s[86:87]
    v_cvt_pk_bf16_f32 v196, v72, v73
    v_cvt_pk_bf16_f32 v197, v74, v75
    v_cvt_pk_bf16_f32 v198, v76, v77
    v_cvt_pk_bf16_f32 v199, v78, v79
    s_xor_b32 s80, s53, 24576
    s_add_u32 m0, s80, 31744
    s_mul_i32 s80, s80, 48
    buffer_load_dwordx4 v48, s[16:19], s80 offen offset:1024 lds
    s_add_u32 s80, s80, 48128
    buffer_load_dwordx4 v48, s[16:19], s80 offen offset:2048 lds
L_e1c0:
    s_waitcnt vmcnt(15)
    v_max_u32 v120, v160, v161
    v_add_f32 v160, v160, v161
    v_mov_b32 v161, v160
    s_waitcnt vmcnt(14)
    v_mfma_f32_16x16x32_bf16 v[96:99], v[20:23], v[128:131], 0
    v_max3_u32 v120, v120, v128, v129
    v_max3_u32 v120, v120, v130, v131
    v_permlane16_swap_b32 v160, v161
    v_add_f32 v160, v160, v161
    v_mov_b32 v161, v160
    s_waitcnt vmcnt(13)
    v_mfma_f32_16x16x32_bf16 v[96:99], v[20:23], v[132:135], v[96:99]
    v_max3_u32 v120, v120, v132, v133
    v_max3_u32 v120, v120, v134, v135
    s_waitcnt vmcnt(12)
    v_mfma_f32_16x16x32_bf16 v[96:99], v[20:23], v[136:139], v[96:99]
    v_max3_u32 v120, v120, v136, v137
    v_max3_u32 v120, v120, v138, v139
    s_waitcnt vmcnt(11)
    v_mfma_f32_16x16x32_bf16 v[96:99], v[20:23], v[140:143], v[96:99]
    v_max3_u32 v120, v120, v140, v141
    v_max3_u32 v120, v120, v142, v143
    v_cmp_eq_u32 vcc, -1, v120
    s_cbranch_vccnz L_e1r0
    v_permlane32_swap_b32 v160, v161
    v_add_f32 v160, v160, v161
    v_cvt_pk_bf16_f32 v160, v160, v160
    ds_write_b16 v55, v160 offset:512
    v_cvt_pk_bf16_f32 v120, v96, v97
    v_cvt_pk_bf16_f32 v121, v98, v99
    ds_write_b64 v54, v[120:121]
    s_waitcnt lgkmcnt(0)
    s_barrier
    ds_read_b128 v[104:107], v56 offset:0
    ds_read_b128 v[108:111], v56 offset:1088
    ds_read_b128 v[112:115], v56 offset:544
    ds_read_b128 v[116:119], v56 offset:1632
    v_add_u32 v44, 32768, v41
    v_mov_b32 v96, 1
    v_add_u32 v124, 98304, v63
    s_waitcnt lgkmcnt(3)
    v_mfma_f32_32x32x16_bf16 v[64:79], v[104:107], v[192:195], 0
    s_waitcnt lgkmcnt(2)
    v_mfma_f32_32x32x16_bf16 v[64:79], v[108:111], v[192:195], v[64:79]
    v_xor_b32 v125, 32, v124
    v_xor_b32 v126, 64, v124
    v_xor_b32 v127, 96, v124
    v_lshrrev_b32 v120, 6, v3
    s_waitcnt lgkmcnt(0)
    v_mfma_f32_32x32x16_bf16 v[80:95], v[112:115], v[196:199], 0
    v_lshl_add_u32 v45, v120, 8, v2
    v_and_b32 v120, 1, v120
    v_lshrrev_b32 v121, 7, v3
    v_lshl_add_u32 v120, v120, 2, v121
    v_lshlrev_b32 v121, 2, v62
    v_lshl_add_u32 v46, v120, 8, v121
    v_mfma_f32_32x32x16_bf16 v[80:95], v[116:119], v[196:199], v[80:95]
    v_add_f32 v72, s86, v72
    v_rcp_f32 v72, v72
    s_nop 0
    v_mul_f32 v64, v72, v64
    v_mul_f32 v65, v72, v65
    v_mul_f32 v66, v72, v66
    v_mul_f32 v67, v72, v67
    v_mul_f32 v68, v72, v68
    v_mul_f32 v69, v72, v69
    v_mul_f32 v70, v72, v70
    v_mul_f32 v71, v72, v71
    v_cvt_pk_bf16_f32 v224, v64, v65
    v_cvt_pk_bf16_f32 v225, v66, v67
    v_and_b32 v224, -2, v224
    v_cvt_pk_bf16_f32 v226, v68, v69
    v_cvt_pk_bf16_f32 v227, v70, v71
    s_cmp_lg_u32 s50, 0
    s_cbranch_scc1 L_po00_safe
    buffer_store_dwordx4 v[224:227], v46, s[36:39], s61 offen offset:0
L_po00_join:
    v_add_f32 v88, s86, v88
    v_rcp_f32 v88, v88
    s_nop 0
    v_pk_mul_f32 v[80:81], v[80:81], v[88:89] op_sel_hi:[1,0]
    v_pk_mul_f32 v[82:83], v[82:83], v[88:89] op_sel_hi:[1,0]
    v_pk_mul_f32 v[84:85], v[84:85], v[88:89] op_sel_hi:[1,0]
    v_pk_mul_f32 v[86:87], v[86:87], v[88:89] op_sel_hi:[1,0]
    v_cvt_pk_bf16_f32 v228, v80, v81
    v_cvt_pk_bf16_f32 v229, v82, v83
    v_and_b32 v228, -2, v228
    v_cvt_pk_bf16_f32 v230, v84, v85
    v_cvt_pk_bf16_f32 v231, v86, v87
    s_cmp_lg_u32 s50, 0
    s_cbranch_scc1 L_po01_safe
    buffer_store_dwordx4 v[228:231], v46, s[36:39], s61 offen offset:512
    s_waitcnt vmcnt(0)
    s_mov_b64 exec, 1
    buffer_store_dword v96, off, s[36:39], s63
    s_mov_b64 exec, -1
L_po01_join:
    v_bfe_u32 v120, v3, 4, 2
    v_lshrrev_b32 v121, 7, v3
    v_lshl_add_u32 v120, v121, 3, v120
    v_lshlrev_b32_e64 v120, 5, v120
    v_bfe_u32 v121, v3, 6, 1
    v_lshl_add_u32 v120, v121, 4, v120
    v_bfe_u32 v121, v3, 3, 1
    v_lshl_add_u32 v120, v121, 3, v120
    v_add_u32 v120, 162432, v120
    ds_read_b64_tr_b16 v[12:13], v120 offset:0
    ds_read_b64_tr_b16 v[14:15], v120 offset:128
    ds_read_b64_tr_b16 v[16:17], v120 offset:512
    ds_read_b64_tr_b16 v[18:19], v120 offset:640
    v_bfe_u32 v121, v3, 4, 1
    v_mul_u32_u24 v121, 0x8000, v121
    v_lshl_or_b32 v121, v121, 16, v121
    s_waitcnt lgkmcnt(0)
    v_xor_b32 v12, v121, v12
    v_xor_b32 v13, v121, v13
    v_xor_b32 v14, v121, v14
    v_xor_b32 v15, v121, v15
    v_xor_b32 v16, v121, v16
    v_xor_b32 v17, v121, v17
    v_xor_b32 v18, v121, v18
    v_xor_b32 v19, v121, v19
    ds_read_b64_tr_b16 v[80:81], v124 offset:0
    ds_read_b64_tr_b16 v[82:83], v124 offset:1024
    ds_read_b64_tr_b16 v[84:85], v125 offset:0
    ds_read_b64_tr_b16 v[86:87], v125 offset:1024
    ds_read_b64_tr_b16 v[88:89], v126 offset:0
    ds_read_b64_tr_b16 v[90:91], v126 offset:1024
    ds_read_b64_tr_b16 v[92:93], v127 offset:0
    ds_read_b64_tr_b16 v[94:95], v127 offset:1024
    ds_read_b64_tr_b16 v[96:97], v124 offset:4096
    ds_read_b64_tr_b16 v[98:99], v124 offset:5120
    ds_read_b64_tr_b16 v[100:101], v125 offset:4096
    ds_read_b64_tr_b16 v[102:103], v125 offset:5120
    v_lshlrev_b32 v64, 16, v4
    v_and_b32 v65, s76, v4
    v_lshlrev_b32 v66, 16, v5
    v_and_b32 v67, s76, v5
    v_lshlrev_b32 v68, 16, v6
    v_and_b32 v69, s76, v6
    v_lshlrev_b32 v70, 16, v7
    v_and_b32 v71, s76, v7
    v_lshlrev_b32 v72, 16, v8
    v_and_b32 v73, s76, v8
    v_lshlrev_b32 v74, 16, v9
    v_and_b32 v75, s76, v9
    v_lshlrev_b32 v76, 16, v10
    v_and_b32 v77, s76, v10
    v_lshlrev_b32 v78, 16, v11
    v_and_b32 v79, s76, v11
    buffer_load_dword v120, v62, s[36:39], s62 offen sc1
    v_xor_b32 v58, 65536, v42
    ds_read_b64_tr_b16 a[96:97], v58 offset:32768
    ds_read_b64_tr_b16 a[98:99], v58 offset:33792
    ds_read_b64_tr_b16 a[100:101], v58 offset:40960
    ds_read_b64_tr_b16 a[102:103], v58 offset:41984
    ds_read_b64_tr_b16 a[104:105], v58 offset:49152
    ds_read_b64_tr_b16 a[106:107], v58 offset:50176
    ds_read_b64_tr_b16 a[108:109], v58 offset:57344
    ds_read_b64_tr_b16 a[110:111], v58 offset:58368
    v_xor_b32 v58, 65600, v42
    ds_read_b64_tr_b16 a[112:113], v58 offset:32768
    ds_read_b64_tr_b16 a[114:115], v58 offset:33792
    ds_read_b64_tr_b16 a[116:117], v58 offset:40960
    ds_read_b64_tr_b16 a[118:119], v58 offset:41984
    ds_read_b64_tr_b16 a[120:121], v58 offset:49152
    ds_read_b64_tr_b16 a[122:123], v58 offset:50176
    ds_read_b64_tr_b16 a[124:125], v58 offset:57344
    ds_read_b64_tr_b16 a[126:127], v58 offset:58368
    buffer_load_dword v252, v62, s[36:39], s62 offen sc1
    s_waitcnt vmcnt(1)
    v_cmp_gt_u32 vcc, 1, v120
    s_cbranch_vccz L_ok_o0
    buffer_load_dword v120, v62, s[36:39], s62 offen sc1
L_again_o0:
    s_waitcnt vmcnt(1)
    v_cmp_gt_u32 vcc, 1, v252
    s_cbranch_vccz L_ok_o0
    buffer_load_dword v252, v62, s[36:39], s62 offen sc1
    s_waitcnt vmcnt(1)
    v_cmp_gt_u32 vcc, 1, v120
    s_cbranch_vccz L_ok_o0
    buffer_load_dword v120, v62, s[36:39], s62 offen sc1
    s_sub_u32 s51, s51, 1
    s_cbranch_scc0 L_again_o0
    s_endpgm
L_ok_o0:
    s_add_u32 s88, s60, 0
    buffer_load_dwordx4 v[128:131], v2, s[36:39], s88 offen offset:0 sc1
    buffer_load_dwordx4 v[132:135], v2, s[36:39], s88 offen offset:2048 sc1
    s_add_u32 s88, s60, 4096
    buffer_load_dwordx4 v[136:139], v2, s[36:39], s88 offen offset:0 sc1
    buffer_load_dwordx4 v[140:143], v2, s[36:39], s88 offen offset:2048 sc1
    s_add_u32 s88, s60, 8192
    buffer_load_dwordx4 v[144:147], v2, s[36:39], s88 offen offset:0 sc1
    buffer_load_dwordx4 v[148:151], v2, s[36:39], s88 offen offset:2048 sc1
    s_xor_b32 s80, s53, 0
    s_add_u32 m0, s80, 63488
    s_mul_i32 s80, s80, 48
    buffer_load_dwordx4 v48, s[16:19], s80 offen offset:2048 lds
    s_add_u32 s80, s80, 48128
    buffer_load_dwordx4 v48, s[16:19], s80 offen offset:3072 lds
    s_waitcnt vmcnt(7) lgkmcnt(15)
    v_mfma_f32_16x16x32_bf16 v[64:67], v[80:83], v[128:131], v[64:67]
    ds_read_b64_tr_b16 v[104:105], v126 offset:4096
    ds_read_b64_tr_b16 v[106:107], v126 offset:5120
    s_add_u32 s88, s60, 12288
    buffer_load_dwordx4 v[152:155], v2, s[36:39], s88 offen offset:0 sc1
    v_mfma_f32_16x16x32_bf16 v[68:71], v[84:87], v[128:131], v[68:71]
    ds_read_b64_tr_b16 v[108:109], v127 offset:4096
    ds_read_b64_tr_b16 v[110:111], v127 offset:5120
    v_mfma_f32_16x16x32_bf16 v[72:75], v[88:91], v[128:131], v[72:75]
    ds_read_b64_tr_b16 v[112:113], v124 offset:8192
    ds_read_b64_tr_b16 v[114:115], v124 offset:9216
    v_mfma_f32_16x16x32_bf16 v[76:79], v[92:95], v[128:131], v[76:79]
    ds_read_b64_tr_b16 v[116:117], v125 offset:8192
    ds_read_b64_tr_b16 v[118:119], v125 offset:9216
    s_waitcnt vmcnt(7)
    v_mfma_f32_16x16x32_bf16 v[64:67], v[96:99], v[132:135], v[64:67]
    ds_read_b64_tr_b16 v[80:81], v126 offset:8192
    ds_read_b64_tr_b16 v[82:83], v126 offset:9216
    buffer_load_dwordx4 v[156:159], v2, s[36:39], s88 offen offset:2048 sc1
    v_mfma_f32_16x16x32_bf16 v[68:71], v[100:103], v[132:135], v[68:71]
    ds_read_b64_tr_b16 v[84:85], v127 offset:8192
    ds_read_b64_tr_b16 v[86:87], v127 offset:9216
    s_waitcnt lgkmcnt(8)
    v_mfma_f32_16x16x32_bf16 v[72:75], v[104:107], v[132:135], v[72:75]
    ds_read_b64_tr_b16 v[88:89], v124 offset:12288
    ds_read_b64_tr_b16 v[90:91], v124 offset:13312
    v_mfma_f32_16x16x32_bf16 v[76:79], v[108:111], v[132:135], v[76:79]
    ds_read_b64_tr_b16 v[92:93], v125 offset:12288
    ds_read_b64_tr_b16 v[94:95], v125 offset:13312
    s_waitcnt vmcnt(7) lgkmcnt(8)
    v_mfma_f32_16x16x32_bf16 v[64:67], v[112:115], v[136:139], v[64:67]
    ds_read_b64_tr_b16 v[96:97], v126 offset:12288
    ds_read_b64_tr_b16 v[98:99], v126 offset:13312
    s_add_u32 s88, s60, 16384
    buffer_load_dwordx4 v[160:163], v2, s[36:39], s88 offen offset:0 sc1
    v_mfma_f32_16x16x32_bf16 v[68:71], v[116:119], v[136:139], v[68:71]
    ds_read_b64_tr_b16 v[100:101], v127 offset:12288
    ds_read_b64_tr_b16 v[102:103], v127 offset:13312
    s_waitcnt lgkmcnt(8)
    v_mfma_f32_16x16x32_bf16 v[72:75], v[80:83], v[136:139], v[72:75]
    ds_read_b64_tr_b16 v[104:105], v124 offset:16384
    ds_read_b64_tr_b16 v[106:107], v124 offset:17408
    v_mfma_f32_16x16x32_bf16 v[76:79], v[84:87], v[136:139], v[76:79]
    ds_read_b64_tr_b16 v[108:109], v125 offset:16384
    ds_read_b64_tr_b16 v[110:111], v125 offset:17408
    s_waitcnt vmcnt(7) lgkmcnt(8)
    v_mfma_f32_16x16x32_bf16 v[64:67], v[88:91], v[140:143], v[64:67]
    ds_read_b64_tr_b16 v[112:113], v126 offset:16384
    ds_read_b64_tr_b16 v[114:115], v126 offset:17408
    buffer_load_dwordx4 v[164:167], v2, s[36:39], s88 offen offset:2048 sc1
    v_mfma_f32_16x16x32_bf16 v[68:71], v[92:95], v[140:143], v[68:71]
    ds_read_b64_tr_b16 v[116:117], v127 offset:16384
    ds_read_b64_tr_b16 v[118:119], v127 offset:17408
    s_waitcnt lgkmcnt(8)
    v_mfma_f32_16x16x32_bf16 v[72:75], v[96:99], v[140:143], v[72:75]
    ds_read_b64_tr_b16 v[80:81], v124 offset:20480
    ds_read_b64_tr_b16 v[82:83], v124 offset:21504
    v_mfma_f32_16x16x32_bf16 v[76:79], v[100:103], v[140:143], v[76:79]
    ds_read_b64_tr_b16 v[84:85], v125 offset:20480
    ds_read_b64_tr_b16 v[86:87], v125 offset:21504
    s_waitcnt vmcnt(7) lgkmcnt(8)
    v_mfma_f32_16x16x32_bf16 v[64:67], v[104:107], v[144:147], v[64:67]
    ds_read_b64_tr_b16 v[88:89], v126 offset:20480
    ds_read_b64_tr_b16 v[90:91], v126 offset:21504
    s_add_u32 s88, s60, 20480
    buffer_load_dwordx4 v[168:171], v2, s[36:39], s88 offen offset:0 sc1
    v_mfma_f32_16x16x32_bf16 v[68:71], v[108:111], v[144:147], v[68:71]
    ds_read_b64_tr_b16 v[92:93], v127 offset:20480
    ds_read_b64_tr_b16 v[94:95], v127 offset:21504
    s_waitcnt lgkmcnt(8)
    v_mfma_f32_16x16x32_bf16 v[72:75], v[112:115], v[144:147], v[72:75]
    ds_read_b64_tr_b16 v[96:97], v124 offset:24576
    ds_read_b64_tr_b16 v[98:99], v124 offset:25600
    v_mfma_f32_16x16x32_bf16 v[76:79], v[116:119], v[144:147], v[76:79]
    ds_read_b64_tr_b16 v[100:101], v125 offset:24576
    ds_read_b64_tr_b16 v[102:103], v125 offset:25600
    s_waitcnt vmcnt(7) lgkmcnt(8)
    v_mfma_f32_16x16x32_bf16 v[64:67], v[80:83], v[148:151], v[64:67]
    ds_read_b64_tr_b16 v[104:105], v126 offset:24576
    ds_read_b64_tr_b16 v[106:107], v126 offset:25600
    buffer_load_dwordx4 v[172:175], v2, s[36:39], s88 offen offset:2048 sc1
    v_mfma_f32_16x16x32_bf16 v[68:71], v[84:87], v[148:151], v[68:71]
    ds_read_b64_tr_b16 v[108:109], v127 offset:24576
    ds_read_b64_tr_b16 v[110:111], v127 offset:25600
    s_waitcnt lgkmcnt(8)
    v_mfma_f32_16x16x32_bf16 v[72:75], v[88:91], v[148:151], v[72:75]
    ds_read_b64_tr_b16 v[112:113], v124 offset:28672
    ds_read_b64_tr_b16 v[114:115], v124 offset:29696
    v_mfma_f32_16x16x32_bf16 v[76:79], v[92:95], v[148:151], v[76:79]
    ds_read_b64_tr_b16 v[116:117], v125 offset:28672
    ds_read_b64_tr_b16 v[118:119], v125 offset:29696
    s_waitcnt vmcnt(5) lgkmcnt(8)
    v_mfma_f32_16x16x32_bf16 v[64:67], v[96:99], v[152:155], v[64:67]
    ds_read_b64_tr_b16 v[80:81], v126 offset:28672
    ds_read_b64_tr_b16 v[82:83], v126 offset:29696
    s_add_u32 s88, s60, 24576
    buffer_load_dwordx4 v[176:179], v2, s[36:39], s88 offen offset:0 sc1
    v_mfma_f32_16x16x32_bf16 v[68:71], v[100:103], v[152:155], v[68:71]
    ds_read_b64_tr_b16 v[84:85], v127 offset:28672
    ds_read_b64_tr_b16 v[86:87], v127 offset:29696
    s_waitcnt lgkmcnt(8)
    v_mfma_f32_16x16x32_bf16 v[72:75], v[104:107], v[152:155], v[72:75]
    v_add_u32 v124, 4294868992, v124
    ds_read_b64_tr_b16 v[88:89], v124 offset:0
    ds_read_b64_tr_b16 v[90:91], v124 offset:1024
    v_mfma_f32_16x16x32_bf16 v[76:79], v[108:111], v[152:155], v[76:79]
    v_add_u32 v125, 4294868992, v125
    ds_read_b64_tr_b16 v[92:93], v125 offset:0
    ds_read_b64_tr_b16 v[94:95], v125 offset:1024
    s_waitcnt vmcnt(5) lgkmcnt(8)
    v_mfma_f32_16x16x32_bf16 v[64:67], v[112:115], v[156:159], v[64:67]
    v_add_u32 v126, 4294868992, v126
    ds_read_b64_tr_b16 v[96:97], v126 offset:0
    ds_read_b64_tr_b16 v[98:99], v126 offset:1024
    buffer_load_dwordx4 v[180:183], v2, s[36:39], s88 offen offset:2048 sc1
    v_mfma_f32_16x16x32_bf16 v[68:71], v[116:119], v[156:159], v[68:71]
    v_add_u32 v127, 4294868992, v127
    ds_read_b64_tr_b16 v[100:101], v127 offset:0
    ds_read_b64_tr_b16 v[102:103], v127 offset:1024
    s_waitcnt lgkmcnt(8)
    v_mfma_f32_16x16x32_bf16 v[72:75], v[80:83], v[156:159], v[72:75]
    ds_read_b64_tr_b16 v[104:105], v124 offset:4096
    ds_read_b64_tr_b16 v[106:107], v124 offset:5120
    v_mfma_f32_16x16x32_bf16 v[76:79], v[84:87], v[156:159], v[76:79]
    ds_read_b64_tr_b16 v[108:109], v125 offset:4096
    ds_read_b64_tr_b16 v[110:111], v125 offset:5120
    s_waitcnt vmcnt(5) lgkmcnt(8)
    v_mfma_f32_16x16x32_bf16 v[64:67], v[88:91], v[160:163], v[64:67]
    ds_read_b64_tr_b16 v[112:113], v126 offset:4096
    ds_read_b64_tr_b16 v[114:115], v126 offset:5120
    s_add_u32 s88, s60, 28672
    buffer_load_dwordx4 v[184:187], v2, s[36:39], s88 offen offset:0 sc1
    s_xor_b32 s80, s53, 8192
    s_add_u32 m0, s80, 63488
    s_mul_i32 s80, s80, 48
    buffer_load_dwordx4 v48, s[16:19], s80 offen offset:2048 lds
    v_mfma_f32_16x16x32_bf16 v[68:71], v[92:95], v[160:163], v[68:71]
    ds_read_b64_tr_b16 v[116:117], v127 offset:4096
    ds_read_b64_tr_b16 v[118:119], v127 offset:5120
    s_waitcnt lgkmcnt(8)
    v_mfma_f32_16x16x32_bf16 v[72:75], v[96:99], v[160:163], v[72:75]
    ds_read_b64_tr_b16 v[80:81], v124 offset:8192
    ds_read_b64_tr_b16 v[82:83], v124 offset:9216
    v_mfma_f32_16x16x32_bf16 v[76:79], v[100:103], v[160:163], v[76:79]
    ds_read_b64_tr_b16 v[84:85], v125 offset:8192
    ds_read_b64_tr_b16 v[86:87], v125 offset:9216
    s_waitcnt vmcnt(6) lgkmcnt(8)
    v_mfma_f32_16x16x32_bf16 v[64:67], v[104:107], v[164:167], v[64:67]
    ds_read_b64_tr_b16 v[88:89], v126 offset:8192
    ds_read_b64_tr_b16 v[90:91], v126 offset:9216
    buffer_load_dwordx4 v[188:191], v2, s[36:39], s88 offen offset:2048 sc1
    s_add_u32 s80, s80, 48128
    buffer_load_dwordx4 v48, s[16:19], s80 offen offset:3072 lds
    v_mfma_f32_16x16x32_bf16 v[68:71], v[108:111], v[164:167], v[68:71]
    ds_read_b64_tr_b16 v[92:93], v127 offset:8192
    ds_read_b64_tr_b16 v[94:95], v127 offset:9216
    s_waitcnt lgkmcnt(8)
    v_mfma_f32_16x16x32_bf16 v[72:75], v[112:115], v[164:167], v[72:75]
    ds_read_b64_tr_b16 v[96:97], v124 offset:12288
    ds_read_b64_tr_b16 v[98:99], v124 offset:13312
    v_mfma_f32_16x16x32_bf16 v[76:79], v[116:119], v[164:167], v[76:79]
    ds_read_b64_tr_b16 v[100:101], v125 offset:12288
    ds_read_b64_tr_b16 v[102:103], v125 offset:13312
    s_waitcnt vmcnt(7) lgkmcnt(8)
    v_mfma_f32_16x16x32_bf16 v[64:67], v[80:83], v[168:171], v[64:67]
    ds_read_b64_tr_b16 v[104:105], v126 offset:12288
    ds_read_b64_tr_b16 v[106:107], v126 offset:13312
    s_xor_b32 s80, s53, 16384
    s_add_u32 m0, s80, 63488
    s_mul_i32 s80, s80, 48
    buffer_load_dwordx4 v48, s[16:19], s80 offen offset:2048 lds
    v_mfma_f32_16x16x32_bf16 v[68:71], v[84:87], v[168:171], v[68:71]
    ds_read_b64_tr_b16 v[108:109], v127 offset:12288
    ds_read_b64_tr_b16 v[110:111], v127 offset:13312
    s_waitcnt lgkmcnt(8)
    v_mfma_f32_16x16x32_bf16 v[72:75], v[88:91], v[168:171], v[72:75]
    ds_read_b64_tr_b16 v[112:113], v124 offset:16384
    ds_read_b64_tr_b16 v[114:115], v124 offset:17408
    v_mfma_f32_16x16x32_bf16 v[76:79], v[92:95], v[168:171], v[76:79]
    ds_read_b64_tr_b16 v[116:117], v125 offset:16384
    ds_read_b64_tr_b16 v[118:119], v125 offset:17408
    s_waitcnt vmcnt(7) lgkmcnt(8)
    v_mfma_f32_16x16x32_bf16 v[64:67], v[96:99], v[172:175], v[64:67]
    ds_read_b64_tr_b16 v[80:81], v126 offset:16384
    ds_read_b64_tr_b16 v[82:83], v126 offset:17408
    s_add_u32 s80, s80, 48128
    buffer_load_dwordx4 v48, s[16:19], s80 offen offset:3072 lds
    v_mfma_f32_16x16x32_bf16 v[68:71], v[100:103], v[172:175], v[68:71]
    ds_read_b64_tr_b16 v[84:85], v127 offset:16384
    ds_read_b64_tr_b16 v[86:87], v127 offset:17408
    s_waitcnt lgkmcnt(8)
    v_mfma_f32_16x16x32_bf16 v[72:75], v[104:107], v[172:175], v[72:75]
    ds_read_b64_tr_b16 v[88:89], v124 offset:20480
    ds_read_b64_tr_b16 v[90:91], v124 offset:21504
    v_mfma_f32_16x16x32_bf16 v[76:79], v[108:111], v[172:175], v[76:79]
    ds_read_b64_tr_b16 v[92:93], v125 offset:20480
    ds_read_b64_tr_b16 v[94:95], v125 offset:21504
    s_waitcnt vmcnt(7) lgkmcnt(8)
    v_mfma_f32_16x16x32_bf16 v[64:67], v[112:115], v[176:179], v[64:67]
    ds_read_b64_tr_b16 v[96:97], v126 offset:20480
    ds_read_b64_tr_b16 v[98:99], v126 offset:21504
    s_xor_b32 s80, s53, 24576
    s_add_u32 m0, s80, 63488
    s_mul_i32 s80, s80, 48
    buffer_load_dwordx4 v48, s[16:19], s80 offen offset:2048 lds
    v_mfma_f32_16x16x32_bf16 v[68:71], v[116:119], v[176:179], v[68:71]
    ds_read_b64_tr_b16 v[100:101], v127 offset:20480
    ds_read_b64_tr_b16 v[102:103], v127 offset:21504
    s_waitcnt lgkmcnt(8)
    v_mfma_f32_16x16x32_bf16 v[72:75], v[80:83], v[176:179], v[72:75]
    ds_read_b64_tr_b16 v[104:105], v124 offset:24576
    ds_read_b64_tr_b16 v[106:107], v124 offset:25600
    v_mov_b32 v123, 2
    v_mfma_f32_16x16x32_bf16 v[76:79], v[84:87], v[176:179], v[76:79]
    ds_read_b64_tr_b16 v[108:109], v125 offset:24576
    ds_read_b64_tr_b16 v[110:111], v125 offset:25600
    s_waitcnt vmcnt(7) lgkmcnt(8)
    v_mfma_f32_16x16x32_bf16 v[64:67], v[88:91], v[180:183], v[64:67]
    ds_read_b64_tr_b16 v[112:113], v126 offset:24576
    ds_read_b64_tr_b16 v[114:115], v126 offset:25600
    s_add_u32 s80, s80, 48128
    buffer_load_dwordx4 v48, s[16:19], s80 offen offset:3072 lds
    v_mfma_f32_16x16x32_bf16 v[68:71], v[92:95], v[180:183], v[68:71]
    ds_read_b64_tr_b16 v[116:117], v127 offset:24576
    ds_read_b64_tr_b16 v[118:119], v127 offset:25600
    s_waitcnt lgkmcnt(8)
    v_mfma_f32_16x16x32_bf16 v[72:75], v[96:99], v[180:183], v[72:75]
    ds_read_b64_tr_b16 v[80:81], v124 offset:28672
    ds_read_b64_tr_b16 v[82:83], v124 offset:29696
    v_mfma_f32_16x16x32_bf16 v[76:79], v[100:103], v[180:183], v[76:79]
    ds_read_b64_tr_b16 v[84:85], v125 offset:28672
    ds_read_b64_tr_b16 v[86:87], v125 offset:29696
    s_waitcnt vmcnt(7) lgkmcnt(8)
    v_mfma_f32_16x16x32_bf16 v[64:67], v[104:107], v[184:187], v[64:67]
    ds_read_b64_tr_b16 v[88:89], v126 offset:28672
    ds_read_b64_tr_b16 v[90:91], v126 offset:29696
    v_mfma_f32_16x16x32_bf16 v[68:71], v[108:111], v[184:187], v[68:71]
    ds_read_b64_tr_b16 v[92:93], v127 offset:28672
    ds_read_b64_tr_b16 v[94:95], v127 offset:29696
    s_waitcnt lgkmcnt(8)
    v_mfma_f32_16x16x32_bf16 v[72:75], v[112:115], v[184:187], v[72:75]
    v_mfma_f32_16x16x32_bf16 v[76:79], v[116:119], v[184:187], v[76:79]
    s_waitcnt vmcnt(5) lgkmcnt(4)
    v_mfma_f32_16x16x32_bf16 v[64:67], v[80:83], v[188:191], v[64:67]
    v_mfma_f32_16x16x32_bf16 v[68:71], v[84:87], v[188:191], v[68:71]
    s_waitcnt lgkmcnt(0)
    v_mfma_f32_16x16x32_bf16 v[72:75], v[88:91], v[188:191], v[72:75]
    v_mfma_f32_16x16x32_bf16 v[76:79], v[92:95], v[188:191], v[76:79]
    s_add_u32 s56, s56, s52
    s_add_u32 s57, s57, s52
    s_add_u32 s58, s58, s52
    s_add_u32 s59, s59, s52
    s_add_u32 s60, s60, s52
    s_add_u32 s61, s61, s52
    v_cvt_pk_bf16_f32 v4, v64, v65
    v_cvt_pk_bf16_f32 v5, v66, v67
    v_and_b32 v4, -2, v4
    v_cvt_pk_bf16_f32 v6, v68, v69
    v_cvt_pk_bf16_f32 v7, v70, v71
    s_cmp_lg_u32 s50, 0
    s_cbranch_scc1 L_px00_safe
    buffer_store_dwordx4 v[4:7], v45, s[36:39], s57 offen offset:0
L_px00_join:
    v_cvt_pk_bf16_f32 v8, v72, v73
    v_cvt_pk_bf16_f32 v9, v74, v75
    v_and_b32 v8, -2, v8
    v_cvt_pk_bf16_f32 v10, v76, v77
    v_cvt_pk_bf16_f32 v11, v78, v79
    s_cmp_lg_u32 s50, 0
    s_cbranch_scc1 L_px01_safe
    buffer_store_dwordx4 v[8:11], v45, s[36:39], s57 offen offset:2048
L_px01_join:
    s_lshl_b32 s90, s44, 13
    s_add_u32 s90, s90, s56
    v_dot2_f32_bf16 v120, v4, s74, 0
    v_dot2_f32_bf16 v121, v4, v4, 0
    v_dot2_f32_bf16 v120, v5, s74, v120
    v_dot2_f32_bf16 v121, v5, v5, v121
    v_dot2_f32_bf16 v120, v6, s74, v120
    v_dot2_f32_bf16 v121, v6, v6, v121
    v_dot2_f32_bf16 v120, v7, s74, v120
    v_dot2_f32_bf16 v121, v7, v7, v121
    v_dot2_f32_bf16 v120, v8, s74, v120
    v_dot2_f32_bf16 v121, v8, v8, v121
    v_dot2_f32_bf16 v120, v9, s74, v120
    v_dot2_f32_bf16 v121, v9, v9, v121
    v_dot2_f32_bf16 v120, v10, s74, v120
    v_dot2_f32_bf16 v121, v10, v10, v121
    v_dot2_f32_bf16 v120, v11, s74, v120
    v_dot2_f32_bf16 v121, v11, v11, v121
    s_nop 2
    v_permlane32_swap_b32 v120, v121
    v_add_f32 v120, v120, v121
    v_mov_b32 v121, v120
    s_nop 1
    v_permlane16_swap_b32 v120, v121
    v_add_f32 v120, v120, v121
    v_and_b32 v120, -2, v120
    s_cmp_lg_u32 s50, 0
    s_cbranch_scc1 L_px0s_safe
    buffer_store_dword v120, v61, s[36:39], s59 offen
    s_waitcnt vmcnt(0)
    s_mov_b64 exec, 1
    buffer_store_dword v123, off, s[36:39], s65
    s_mov_b64 exec, -1
L_px0s_join:
    buffer_load_dword v125, v62, s[36:39], s64 offen sc1
    ds_read_b64_tr_b16 a[128:129], v42 offset:0
    ds_read_b64_tr_b16 a[130:131], v42 offset:1024
    ds_read_b64_tr_b16 a[132:133], v42 offset:8192
L_pad3:
    s_cbranch_execz L_pad7
    ds_read_b64_tr_b16 a[134:135], v42 offset:9216
    ds_read_b64_tr_b16 a[136:137], v42 offset:16384
    ds_read_b64_tr_b16 a[138:139], v42 offset:17408
    ds_read_b64_tr_b16 a[140:141], v42 offset:24576
    ds_read_b64_tr_b16 a[142:143], v42 offset:25600
    v_xor_b32 v58, 64, v42
    ds_read_b64_tr_b16 a[144:145], v58 offset:0
    ds_read_b64_tr_b16 a[146:147], v58 offset:1024
    ds_read_b64_tr_b16 a[148:149], v58 offset:8192
    ds_read_b64_tr_b16 a[150:151], v58 offset:9216
    ds_read_b64_tr_b16 a[152:153], v58 offset:16384
    ds_read_b64_tr_b16 a[154:155], v58 offset:17408
    ds_read_b64_tr_b16 a[156:157], v58 offset:24576
    ds_read_b64_tr_b16 a[158:159], v58 offset:25600
    s_barrier
    ds_read_b64_tr_b16 a[160:161], v44 offset:0
    ds_read_b64_tr_b16 a[162:163], v44 offset:1024
    ds_read_b64_tr_b16 a[224:225], v44 offset:32768
    ds_read_b64_tr_b16 a[226:227], v44 offset:33792
    ds_read_b64_tr_b16 a[164:165], v44 offset:512
    ds_read_b64_tr_b16 a[166:167], v44 offset:1536
    ds_read_b64_tr_b16 a[228:229], v44 offset:33280
    ds_read_b64_tr_b16 a[230:231], v44 offset:34304
    s_mov_b32 vcc_lo, 0xf0f00f0f
    s_mov_b32 vcc_hi, 0xf0f00f0f
    v_mov_b32 v33, s74
    v_cndmask_b32 v32, 0, v33, vcc
    v_mov_b32 v33, v32
    v_mov_b32 v34, v32
    v_mov_b32 v35, v32
    buffer_load_dword v252, v62, s[36:39], s64 offen sc1
    s_waitcnt vmcnt(1)
    v_cmp_gt_u32 vcc, 2, v125
    s_cbranch_vccz L_ok_x1
    buffer_load_dword v125, v62, s[36:39], s64 offen sc1
L_again_x1:
    s_waitcnt vmcnt(1)
    v_cmp_gt_u32 vcc, 2, v252
    s_cbranch_vccz L_ok_x1
    buffer_load_dword v252, v62, s[36:39], s64 offen sc1
    s_waitcnt vmcnt(1)
    v_cmp_gt_u32 vcc, 2, v125
    s_cbranch_vccz L_ok_x1
    buffer_load_dword v125, v62, s[36:39], s64 offen sc1
    s_sub_u32 s51, s51, 1
    s_cbranch_scc0 L_again_x1
    s_endpgm
L_ok_x1:
    s_xor_b32 s88, s90, 0
    buffer_load_dwordx4 v[128:131], v2, s[36:39], s88 offen offset:0 sc1
    buffer_load_dwordx4 v[132:135], v2, s[36:39], s88 offen offset:1024 sc1
    buffer_load_dwordx4 v[136:139], v2, s[36:39], s88 offen offset:2048 sc1
    buffer_load_dwordx4 v[140:143], v2, s[36:39], s88 offen offset:3072 sc1
    s_xor_b32 s88, s90, 4096
    buffer_load_dwordx4 v[144:147], v2, s[36:39], s88 offen offset:0 sc1
    buffer_load_dwordx4 v[148:151], v2, s[36:39], s88 offen offset:1024 sc1
    buffer_load_dwordx4 v[152:155], v2, s[36:39], s88 offen offset:2048 sc1
    s_waitcnt vmcnt(6) lgkmcnt(4)
    v_mfma_f32_16x16x32_bf16 a[192:195], v[32:35], a[160:163], 0
    v_mfma_f32_16x16x32_bf16 a[196:199], v[32:35], a[224:227], 0
    v_mfma_f32_32x32x16_bf16 v[64:79], a[160:163], v[128:131], 0
    buffer_load_dwordx4 v[156:159], v2, s[36:39], s88 offen offset:3072 sc1
    ds_read_b64_tr_b16 a[168:169], v44 offset:2048
    ds_read_b64_tr_b16 a[170:171], v44 offset:3072
    v_mfma_f32_32x32x16_bf16 v[80:95], a[224:227], v[128:131], 0
    ds_read_b64_tr_b16 a[232:233], v44 offset:34816
    ds_read_b64_tr_b16 a[234:235], v44 offset:35840
    s_waitcnt vmcnt(6) lgkmcnt(4)
    v_mfma_f32_16x16x32_bf16 a[192:195], v[32:35], a[164:167], a[192:195]
    v_mfma_f32_16x16x32_bf16 a[196:199], v[32:35], a[228:231], a[196:199]
    v_mfma_f32_32x32x16_bf16 v[64:79], a[164:167], v[132:135], v[64:79]
    s_xor_b32 s88, s90, 8192
    buffer_load_dwordx4 v[160:163], v2, s[36:39], s88 offen offset:0 sc1
    buffer_load_dwordx4 v[164:167], v2, s[36:39], s88 offen offset:1024 sc1
    ds_read_b64_tr_b16 a[172:173], v44 offset:2560
    ds_read_b64_tr_b16 a[174:175], v44 offset:3584
    v_mfma_f32_32x32x16_bf16 v[80:95], a[228:231], v[132:135], v[80:95]
    ds_read_b64_tr_b16 a[236:237], v44 offset:35328
    ds_read_b64_tr_b16 a[238:239], v44 offset:36352
    s_waitcnt vmcnt(7) lgkmcnt(4)
    v_mfma_f32_16x16x32_bf16 a[192:195], v[32:35], a[168:171], a[192:195]
    v_mfma_f32_16x16x32_bf16 a[196:199], v[32:35], a[232:235], a[196:199]
    v_mfma_f32_32x32x16_bf16 v[64:79], a[168:171], v[136:139], v[64:79]
    buffer_load_dwordx4 v[168:171], v2, s[36:39], s88 offen offset:2048 sc1
    ds_read_b64_tr_b16 a[176:177], v44 offset:4096
    ds_read_b64_tr_b16 a[178:179], v44 offset:5120
    v_mfma_f32_32x32x16_bf16 v[80:95], a[232:235], v[136:139], v[80:95]
    ds_read_b64_tr_b16 a[240:241], v44 offset:36864
    ds_read_b64_tr_b16 a[242:243], v44 offset:37888
    s_waitcnt vmcnt(7) lgkmcnt(4)
    v_mfma_f32_16x16x32_bf16 a[192:195], v[32:35], a[172:175], a[192:195]
    v_mfma_f32_16x16x32_bf16 a[196:199], v[32:35], a[236:239], a[196:199]
    v_mfma_f32_32x32x16_bf16 v[64:79], a[172:175], v[140:143], v[64:79]
    buffer_load_dwordx4 v[172:175], v2, s[36:39], s88 offen offset:3072 sc1
    s_xor_b32 s88, s90, 12288
    buffer_load_dwordx4 v[176:179], v2, s[36:39], s88 offen offset:0 sc1
    ds_read_b64_tr_b16 a[180:181], v44 offset:4608
    ds_read_b64_tr_b16 a[182:183], v44 offset:5632
    v_mfma_f32_32x32x16_bf16 v[80:95], a[236:239], v[140:143], v[80:95]
    ds_read_b64_tr_b16 a[244:245], v44 offset:37376
    ds_read_b64_tr_b16 a[246:247], v44 offset:38400
    s_waitcnt vmcnt(8) lgkmcnt(4)
    v_mfma_f32_16x16x32_bf16 a[192:195], v[32:35], a[176:179], a[192:195]
    v_mfma_f32_16x16x32_bf16 a[196:199], v[32:35], a[240:243], a[196:199]
    v_mfma_f32_32x32x16_bf16 v[64:79], a[176:179], v[144:147], v[64:79]
    buffer_load_dwordx4 v[180:183], v2, s[36:39], s88 offen offset:1024 sc1
    ds_read_b64_tr_b16 a[184:185], v44 offset:6144
    ds_read_b64_tr_b16 a[186:187], v44 offset:7168
    v_mfma_f32_32x32x16_bf16 v[80:95], a[240:243], v[144:147], v[80:95]
    buffer_load_dwordx4 v[248:251], v2, s[36:39], s58 offen offset:0 sc1
    ds_read_b64_tr_b16 a[248:249], v44 offset:38912
    ds_read_b64_tr_b16 a[250:251], v44 offset:39936
    s_waitcnt vmcnt(9) lgkmcnt(4)
    v_mfma_f32_16x16x32_bf16 a[192:195], v[32:35], a[180:183], a[192:195]
    v_mfma_f32_16x16x32_bf16 a[196:199], v[32:35], a[244:247], a[196:199]
    v_mfma_f32_32x32x16_bf16 v[64:79], a[180:183], v[148:151], v[64:79]
    buffer_load_dwordx4 v[184:187], v2, s[36:39], s88 offen offset:2048 sc1
    buffer_load_dwordx4 v[188:191], v2, s[36:39], s88 offen offset:3072 sc1
    ds_read_b64_tr_b16 a[188:189], v44 offset:6656
    ds_read_b64_tr_b16 a[190:191], v44 offset:7680
    v_mfma_f32_32x32x16_bf16 v[80:95], a[244:247], v[148:151], v[80:95]
    buffer_load_dwordx4 v[252:255], v2, s[36:39], s58 offen offset:1024 sc1
    ds_read_b64_tr_b16 a[252:253], v44 offset:39424
    ds_read_b64_tr_b16 a[254:255], v44 offset:40448
    s_waitcnt vmcnt(11) lgkmcnt(4)
    v_mfma_f32_16x16x32_bf16 a[192:195], v[32:35], a[184:187], a[192:195]
    v_mfma_f32_16x16x32_bf16 a[196:199], v[32:35], a[248:251], a[196:199]
    v_mfma_f32_32x32x16_bf16 v[64:79], a[184:187], v[152:155], v[64:79]
    s_xor_b32 s88, s90, 16384
    buffer_load_dwordx4 v[192:195], v2, s[36:39], s88 offen offset:0 sc1
    v_xor_b32 v44, 8192, v44
    ds_read_b64_tr_b16 v[112:113], v44 offset:0
    ds_read_b64_tr_b16 v[114:115], v44 offset:1024
    v_mfma_f32_32x32x16_bf16 v[80:95], a[248:251], v[152:155], v[80:95]
    ds_read_b64_tr_b16 v[116:117], v44 offset:32768
    ds_read_b64_tr_b16 v[118:119], v44 offset:33792
    s_waitcnt vmcnt(11) lgkmcnt(4)
    v_mfma_f32_16x16x32_bf16 a[192:195], v[32:35], a[188:191], a[192:195]
    v_mfma_f32_16x16x32_bf16 a[196:199], v[32:35], a[252:255], a[196:199]
    v_mfma_f32_32x32x16_bf16 v[64:79], a[188:191], v[156:159], v[64:79]
    buffer_load_dwordx4 v[196:199], v2, s[36:39], s88 offen offset:1024 sc1
    ds_read_b64_tr_b16 v[96:97], v44 offset:512
    ds_read_b64_tr_b16 v[98:99], v44 offset:1536
    v_mfma_f32_32x32x16_bf16 v[80:95], a[252:255], v[156:159], v[80:95]
    ds_read_b64_tr_b16 v[100:101], v44 offset:33280
    ds_read_b64_tr_b16 v[102:103], v44 offset:34304
    s_waitcnt vmcnt(11) lgkmcnt(4)
    v_mfma_f32_32x32x16_bf16 v[64:79], v[112:115], v[160:163], v[64:79]
    buffer_load_dwordx4 v[200:203], v2, s[36:39], s88 offen offset:2048 sc1
    ds_read_b64_tr_b16 v[104:105], v44 offset:2048
    ds_read_b64_tr_b16 v[106:107], v44 offset:3072
    v_mfma_f32_32x32x16_bf16 v[80:95], v[116:119], v[160:163], v[80:95]
    ds_write_b32 v43, a192 offset:512
    ds_write_b32 v43, a196 offset:1024
    ds_read_b64_tr_b16 v[108:109], v44 offset:34816
    ds_read_b64_tr_b16 v[110:111], v44 offset:35840
    s_waitcnt vmcnt(11) lgkmcnt(6)
    v_mfma_f32_32x32x16_bf16 v[64:79], v[96:99], v[164:167], v[64:79]
    buffer_load_dwordx4 v[204:207], v2, s[36:39], s88 offen offset:3072 sc1
    ds_read_b64_tr_b16 v[112:113], v44 offset:2560
    ds_read_b64_tr_b16 v[114:115], v44 offset:3584
    v_mfma_f32_32x32x16_bf16 v[80:95], v[100:103], v[164:167], v[80:95]
    ds_read_b64_tr_b16 v[116:117], v44 offset:35328
    ds_read_b64_tr_b16 v[118:119], v44 offset:36352
    s_waitcnt lgkmcnt(6)
    s_barrier
    v_and_b32 v124, -16, v43
    ds_read_b128 v[124:127], v124 offset:512
    s_waitcnt vmcnt(11) lgkmcnt(5)
    v_mfma_f32_32x32x16_bf16 v[64:79], v[104:107], v[168:171], v[64:79]
    s_xor_b32 s88, s90, 20480
    buffer_load_dwordx4 v[208:211], v2, s[36:39], s88 offen offset:0 sc1
    ds_read_b64_tr_b16 v[96:97], v44 offset:4096
    ds_read_b64_tr_b16 v[98:99], v44 offset:5120
    v_mfma_f32_32x32x16_bf16 v[80:95], v[108:111], v[168:171], v[80:95]
    ds_read_b64_tr_b16 v[100:101], v44 offset:36864
    ds_read_b64_tr_b16 v[102:103], v44 offset:37888
    s_waitcnt vmcnt(11) lgkmcnt(5)
    v_mfma_f32_32x32x16_bf16 v[64:79], v[112:115], v[172:175], v[64:79]
    buffer_load_dwordx4 v[212:215], v2, s[36:39], s88 offen offset:1024 sc1
    ds_read_b64_tr_b16 v[104:105], v44 offset:4608
    ds_read_b64_tr_b16 v[106:107], v44 offset:5632
    v_mfma_f32_32x32x16_bf16 v[80:95], v[116:119], v[172:175], v[80:95]
    ds_read_b64_tr_b16 v[108:109], v44 offset:37376
    ds_read_b64_tr_b16 v[110:111], v44 offset:38400
    s_waitcnt lgkmcnt(8)
    v_add_f32 v124, v124, v126
    v_add_f32 v125, v125, v127
    s_waitcnt vmcnt(11) lgkmcnt(4)
    v_mfma_f32_32x32x16_bf16 v[64:79], v[96:99], v[176:179], v[64:79]
    buffer_load_dwordx4 v[216:219], v2, s[36:39], s88 offen offset:2048 sc1
    ds_read_b64_tr_b16 v[112:113], v44 offset:6144
    ds_read_b64_tr_b16 v[114:115], v44 offset:7168
    v_add_f32 v124, v124, v125
    v_mfma_f32_32x32x16_bf16 v[80:95], v[100:103], v[176:179], v[80:95]
    ds_read_b64_tr_b16 v[116:117], v44 offset:38912
    ds_read_b64_tr_b16 v[118:119], v44 offset:39936
    v_and_b32 v125, s76, v124
    v_sub_f32 v125, v124, v125
    s_waitcnt vmcnt(11) lgkmcnt(4)
    v_mfma_f32_32x32x16_bf16 v[64:79], v[104:107], v[180:183], v[64:79]
    buffer_load_dwordx4 v[220:223], v2, s[36:39], s88 offen offset:3072 sc1
    ds_read_b64_tr_b16 v[96:97], v44 offset:6656
    ds_read_b64_tr_b16 v[98:99], v44 offset:7680
    v_perm_b32 v32, v125, v124, s75
    v_mfma_f32_32x32x16_bf16 v[80:95], v[108:111], v[180:183], v[80:95]
    ds_read_b64_tr_b16 v[100:101], v44 offset:39424
    ds_read_b64_tr_b16 v[102:103], v44 offset:40448
    v_and_b32 v126, s76, v125
    v_sub_f32 v126, v125, v126
    s_waitcnt vmcnt(10) lgkmcnt(4)
    v_mfma_f32_32x32x16_bf16 v[64:79], v[112:115], v[184:187], v[64:79]
    s_xor_b32 s88, s90, 24576
    buffer_load_dwordx4 v[224:227], v2, s[36:39], s88 offen offset:0 sc1
    v_xor_b32 v44, 24576, v44
    ds_read_b64_tr_b16 v[104:105], v44 offset:0
    ds_read_b64_tr_b16 v[106:107], v44 offset:1024
    v_lshrrev_b32 v33, 16, v126
    v_mfma_f32_32x32x16_bf16 v[80:95], v[116:119], v[184:187], v[80:95]
    ds_read_b64_tr_b16 v[108:109], v44 offset:32768
    ds_read_b64_tr_b16 v[110:111], v44 offset:33792
    v_and_b32 v124, -16, v43
    ds_read_b128 v[124:127], v124 offset:1024
    s_waitcnt vmcnt(10) lgkmcnt(5)
    v_mfma_f32_32x32x16_bf16 v[64:79], v[96:99], v[188:191], v[64:79]
    buffer_load_dwordx4 v[228:231], v2, s[36:39], s88 offen offset:1024 sc1
    ds_read_b64_tr_b16 v[112:113], v44 offset:512
    ds_read_b64_tr_b16 v[114:115], v44 offset:1536
    v_mfma_f32_32x32x16_bf16 v[80:95], v[100:103], v[188:191], v[80:95]
    ds_read_b64_tr_b16 v[116:117], v44 offset:33280
    ds_read_b64_tr_b16 v[118:119], v44 offset:34304
    s_waitcnt vmcnt(9) lgkmcnt(5)
    v_mfma_f32_32x32x16_bf16 v[64:79], v[104:107], v[192:195], v[64:79]
    buffer_load_dwordx4 v[232:235], v2, s[36:39], s88 offen offset:2048 sc1
    ds_read_b64_tr_b16 v[96:97], v44 offset:2048
    ds_read_b64_tr_b16 v[98:99], v44 offset:3072
    v_add_f32 v248, v248, v250
    v_mfma_f32_32x32x16_bf16 v[80:95], v[108:111], v[192:195], v[80:95]
    ds_read_b64_tr_b16 v[100:101], v44 offset:34816
    ds_read_b64_tr_b16 v[102:103], v44 offset:35840
    s_waitcnt lgkmcnt(8)
    v_add_f32 v124, v124, v126
    v_add_f32 v125, v125, v127
    s_waitcnt vmcnt(9) lgkmcnt(4)
    v_mfma_f32_32x32x16_bf16 v[64:79], v[112:115], v[196:199], v[64:79]
    buffer_load_dwordx4 v[236:239], v2, s[36:39], s88 offen offset:3072 sc1
    ds_read_b64_tr_b16 v[104:105], v44 offset:2560
    ds_read_b64_tr_b16 v[106:107], v44 offset:3584
    v_add_f32 v124, v124, v125
    v_mfma_f32_32x32x16_bf16 v[80:95], v[116:119], v[196:199], v[80:95]
    ds_read_b64_tr_b16 v[108:109], v44 offset:35328
    ds_read_b64_tr_b16 v[110:111], v44 offset:36352
    v_and_b32 v125, s76, v124
    v_sub_f32 v125, v124, v125
    s_waitcnt vmcnt(9) lgkmcnt(4)
    v_mfma_f32_32x32x16_bf16 v[64:79], v[96:99], v[200:203], v[64:79]
    s_xor_b32 s88, s90, 28672
    buffer_load_dwordx4 v[240:243], v2, s[36:39], s88 offen offset:0 sc1
    ds_read_b64_tr_b16 v[112:113], v44 offset:4096
    ds_read_b64_tr_b16 v[114:115], v44 offset:5120
    v_perm_b32 v34, v125, v124, s75
    v_mfma_f32_32x32x16_bf16 v[80:95], v[100:103], v[200:203], v[80:95]
    ds_read_b64_tr_b16 v[116:117], v44 offset:36864
    ds_read_b64_tr_b16 v[118:119], v44 offset:37888
    v_and_b32 v126, s76, v125
    v_sub_f32 v126, v125, v126
    s_waitcnt vmcnt(9) lgkmcnt(4)
    v_mfma_f32_32x32x16_bf16 v[64:79], v[104:107], v[204:207], v[64:79]
    buffer_load_dwordx4 v[244:247], v2, s[36:39], s88 offen offset:1024 sc1
    ds_read_b64_tr_b16 v[96:97], v44 offset:4608
    ds_read_b64_tr_b16 v[98:99], v44 offset:5632
    v_lshrrev_b32 v35, 16, v126
    v_mfma_f32_32x32x16_bf16 v[80:95], v[108:111], v[204:207], v[80:95]
    ds_read_b64_tr_b16 v[100:101], v44 offset:37376
    ds_read_b64_tr_b16 v[102:103], v44 offset:38400
    v_add_f32 v249, v249, v251
    v_add_f32 v252, v252, v254
    s_waitcnt vmcnt(9) lgkmcnt(4)
    v_mfma_f32_32x32x16_bf16 v[64:79], v[112:115], v[208:211], v[64:79]
    v_add_f32 v253, v253, v255
    v_add_f32 v120, v248, v252
    v_add_f32 v121, v249, v253
    buffer_load_dwordx4 v[248:251], v2, s[36:39], s88 offen offset:2048 sc1
    ds_read_b64_tr_b16 v[104:105], v44 offset:6144
    ds_read_b64_tr_b16 v[106:107], v44 offset:7168
    v_mov_b32 v122, v120
    v_mfma_f32_32x32x16_bf16 v[80:95], v[116:119], v[208:211], v[80:95]
    ds_read_b64_tr_b16 v[108:109], v44 offset:38912
    ds_read_b64_tr_b16 v[110:111], v44 offset:39936
    v_mov_b32 v123, v121
    v_permlane32_swap_b32 v120, v122
    s_waitcnt vmcnt(9) lgkmcnt(4)
    v_mfma_f32_32x32x16_bf16 v[64:79], v[96:99], v[212:215], v[64:79]
    buffer_load_dwordx4 v[252:255], v2, s[36:39], s88 offen offset:3072 sc1
    ds_read_b64_tr_b16 v[112:113], v44 offset:6656
    ds_read_b64_tr_b16 v[114:115], v44 offset:7680
    v_permlane32_swap_b32 v121, v123
    v_mfma_f32_32x32x16_bf16 v[80:95], v[100:103], v[212:215], v[80:95]
    ds_read_b64_tr_b16 v[116:117], v44 offset:39424
    ds_read_b64_tr_b16 v[118:119], v44 offset:40448
    v_add_f32 v120, v120, v122
    v_add_f32 v121, v121, v123
    s_waitcnt vmcnt(9) lgkmcnt(4)
    v_mfma_f32_32x32x16_bf16 v[64:79], v[104:107], v[216:219], v[64:79]
    v_xor_b32 v44, 8192, v44
    ds_read_b64_tr_b16 v[96:97], v44 offset:0
    ds_read_b64_tr_b16 v[98:99], v44 offset:1024
    v_mul_f32 v120, 0xbb000000, v120
    v_mfma_f32_32x32x16_bf16 v[80:95], v[108:111], v[216:219], v[80:95]
    ds_read_b64_tr_b16 v[100:101], v44 offset:32768
    ds_read_b64_tr_b16 v[102:103], v44 offset:33792
    v_mul_f32 v121, 0x3b000000, v121
    v_fma_f32 v121, -v120, v120, v121
    s_waitcnt vmcnt(8) lgkmcnt(4)
    v_mfma_f32_32x32x16_bf16 v[64:79], v[112:115], v[220:223], v[64:79]
    ds_read_b64_tr_b16 v[104:105], v44 offset:512
    ds_read_b64_tr_b16 v[106:107], v44 offset:1536
    v_max_f32 v121, 0, v121
    v_mfma_f32_32x32x16_bf16 v[80:95], v[116:119], v[220:223], v[80:95]
    ds_read_b64_tr_b16 v[108:109], v44 offset:33280
    ds_read_b64_tr_b16 v[110:111], v44 offset:34304
    v_add_f32 v121, 0x3727c5ac, v121
    v_rsq_f32 v38, v121
    s_waitcnt vmcnt(7) lgkmcnt(4)
    v_mfma_f32_32x32x16_bf16 v[64:79], v[96:99], v[224:227], v[64:79]
    ds_read_b64_tr_b16 v[112:113], v44 offset:2048
    ds_read_b64_tr_b16 v[114:115], v44 offset:3072
    v_and_b32 v122, s76, v120
    s_xor_b32 s80, s53, 0
    s_add_u32 m0, s80, 98304
    s_mul_i32 s80, s80, 48
    buffer_load_dwordx4 v48, s[16:19], s80 offen offset:0 lds
    v_mfma_f32_32x32x16_bf16 v[80:95], v[100:103], v[224:227], v[80:95]
    ds_read_b64_tr_b16 v[116:117], v44 offset:34816
    ds_read_b64_tr_b16 v[118:119], v44 offset:35840
    v_sub_f32 v122, v120, v122
    s_mov_b64 vcc, 0xffffffff
    s_waitcnt vmcnt(7) lgkmcnt(4)
    v_mfma_f32_32x32x16_bf16 v[64:79], v[104:107], v[228:231], v[64:79]
    ds_read_b64_tr_b16 v[96:97], v44 offset:2560
    ds_read_b64_tr_b16 v[98:99], v44 offset:3584
    v_mul_f32 v39, s84, v38
    s_add_u32 s80, s80, 48128
    buffer_load_dwordx4 v48, s[16:19], s80 offen offset:1024 lds
    v_mfma_f32_32x32x16_bf16 v[80:95], v[108:111], v[228:231], v[80:95]
    ds_read_b64_tr_b16 v[100:101], v44 offset:35328
    ds_read_b64_tr_b16 v[102:103], v44 offset:36352
    v_cndmask_b32 v120, v122, v120, vcc
    v_perm_b32 v36, v120, v120, s75
    s_waitcnt vmcnt(7) lgkmcnt(4)
    v_mfma_f32_32x32x16_bf16 v[64:79], v[112:115], v[232:235], v[64:79]
    ds_read_b64_tr_b16 v[104:105], v44 offset:4096
    ds_read_b64_tr_b16 v[106:107], v44 offset:5120
    v_lshrrev_b32 v37, 16, v120
    s_xor_b32 s80, s53, 8192
    s_add_u32 m0, s80, 98304
    s_mul_i32 s80, s80, 48
    buffer_load_dwordx4 v48, s[16:19], s80 offen offset:0 lds
    v_mfma_f32_32x32x16_bf16 v[80:95], v[116:119], v[232:235], v[80:95]
    ds_read_b64_tr_b16 v[108:109], v44 offset:36864
    ds_read_b64_tr_b16 v[110:111], v44 offset:37888
    v_mfma_f32_32x32x8_bf16 v[64:79], v[32:33], v[36:37], v[64:79]
    v_mfma_f32_32x32x8_bf16 v[80:95], v[34:35], v[36:37], v[80:95]
    s_waitcnt vmcnt(7) lgkmcnt(4)
    v_mfma_f32_32x32x16_bf16 v[64:79], v[96:99], v[236:239], v[64:79]
    ds_read_b64_tr_b16 v[112:113], v44 offset:4608
    ds_read_b64_tr_b16 v[114:115], v44 offset:5632
    s_add_u32 s80, s80, 48128
    buffer_load_dwordx4 v48, s[16:19], s80 offen offset:1024 lds
    v_mfma_f32_32x32x16_bf16 v[80:95], v[100:103], v[236:239], v[80:95]
    ds_read_b64_tr_b16 v[116:117], v44 offset:37376
    ds_read_b64_tr_b16 v[118:119], v44 offset:38400
    s_waitcnt vmcnt(7) lgkmcnt(4)
    v_mfma_f32_32x32x16_bf16 v[64:79], v[104:107], v[240:243], v[64:79]
    ds_read_b64_tr_b16 v[96:97], v44 offset:6144
    ds_read_b64_tr_b16 v[98:99], v44 offset:7168
    s_xor_b32 s80, s53, 16384
    s_add_u32 m0, s80, 98304
    s_mul_i32 s80, s80, 48
    buffer_load_dwordx4 v48, s[16:19], s80 offen offset:0 lds
    v_mfma_f32_32x32x16_bf16 v[80:95], v[108:111], v[240:243], v[80:95]
    ds_read_b64_tr_b16 v[100:101], v44 offset:38912
    ds_read_b64_tr_b16 v[102:103], v44 offset:39936
    s_waitcnt vmcnt(7) lgkmcnt(4)
    v_mfma_f32_32x32x16_bf16 v[64:79], v[112:115], v[244:247], v[64:79]
    ds_read_b64_tr_b16 v[104:105], v44 offset:6656
    ds_read_b64_tr_b16 v[106:107], v44 offset:7680
    s_add_u32 s80, s80, 48128
    buffer_load_dwordx4 v48, s[16:19], s80 offen offset:1024 lds
    v_mfma_f32_32x32x16_bf16 v[80:95], v[116:119], v[244:247], v[80:95]
    ds_read_b64_tr_b16 v[108:109], v44 offset:39424
    ds_read_b64_tr_b16 v[110:111], v44 offset:40448
    s_waitcnt vmcnt(7) lgkmcnt(4)
    v_mfma_f32_32x32x16_bf16 v[64:79], v[96:99], v[248:251], v[64:79]
    s_xor_b32 s80, s53, 24576
    s_add_u32 m0, s80, 98304
    s_mul_i32 s80, s80, 48
    buffer_load_dwordx4 v48, s[16:19], s80 offen offset:0 lds
    v_mfma_f32_32x32x16_bf16 v[80:95], v[100:103], v[248:251], v[80:95]
    s_waitcnt vmcnt(7) lgkmcnt(0)
    v_mfma_f32_32x32x16_bf16 v[64:79], v[104:107], v[252:255], v[64:79]
    s_add_u32 s80, s80, 48128
    buffer_load_dwordx4 v48, s[16:19], s80 offen offset:1024 lds
    v_mfma_f32_32x32x16_bf16 v[80:95], v[108:111], v[252:255], v[80:95]
    v_add_u32 v44, 98304, v41
    s_add_u32 s88, s68, 524288
    s_add_u32 s89, s71, 65536
    s_nop 5
    v_cvt_pk_bf16_f32 v120, v64, v65
    v_cvt_pk_bf16_f32 v121, v66, v67
    v_cvt_pk_bf16_f32 v122, v68, v69
    v_cvt_pk_bf16_f32 v123, v70, v71
    v_cvt_pk_bf16_f32 v124, v72, v73
    v_cvt_pk_bf16_f32 v125, v74, v75
    v_mfma_f32_32x32x16_bf16 v[96:111], v[12:15], v[120:123], 0
    v_cvt_pk_bf16_f32 v126, v76, v77
    v_cvt_pk_bf16_f32 v127, v78, v79
    v_mul_f32 v80, v38, v80
    v_mul_f32 v81, v38, v81
    v_mul_f32 v82, v38, v82
    v_mul_f32 v83, v38, v83
    v_mfma_f32_32x32x16_bf16 v[64:79], v[16:19], v[124:127], 0
    v_mul_f32 v84, v38, v84
    v_mul_f32 v85, v38, v85
    v_mul_f32 v86, v38, v86
    v_mul_f32 v87, v38, v87
    v_mul_f32 v88, v38, v88
    v_mul_f32 v89, v38, v89
    v_mul_f32 v90, v38, v90
    v_mul_f32 v91, v38, v91
    v_mul_f32 v92, v38, v92
    v_mul_f32 v93, v38, v93
    v_mul_f32 v94, v38, v94
    v_mul_f32 v95, v38, v95
    v_cvt_pk_bf16_f32 v80, v80, v81
    v_cvt_pk_bf16_f32 v81, v82, v83
    v_cvt_pk_bf16_f32 v82, v84, v85
    v_cvt_pk_bf16_f32 v83, v86, v87
    v_cvt_pk_bf16_f32 v84, v88, v89
    v_cvt_pk_bf16_f32 v85, v90, v91
    v_cvt_pk_bf16_f32 v86, v92, v93
    v_cvt_pk_bf16_f32 v87, v94, v95
    ds_write_b128 v50, v[80:83] offset:17408
    ds_write_b128 v50, v[84:87] offset:21760
    v_max3_f32 v120, v96, v97, v98
    v_max3_f32 v121, v99, v100, v101
    v_max3_f32 v120, v120, v102, v103
    v_max3_f32 v121, v121, v104, v105
    v_max3_f32 v120, v120, v106, v107
    v_max3_f32 v121, v121, v108, v109
    v_max3_f32 v120, v120, v110, v111
    v_max_f32 v120, v120, v121
    v_mul_f32 v120, v39, v120
    v_pk_fma_f32 v[96:97], v[96:97], v[38:39], v[120:121] op_sel:[0,1,0] op_sel_hi:[1,1,0] neg_lo:[0,0,1] neg_hi:[0,0,1]
    v_pk_fma_f32 v[98:99], v[98:99], v[38:39], v[120:121] op_sel:[0,1,0] op_sel_hi:[1,1,0] neg_lo:[0,0,1] neg_hi:[0,0,1]
    v_pk_fma_f32 v[100:101], v[100:101], v[38:39], v[120:121] op_sel:[0,1,0] op_sel_hi:[1,1,0] neg_lo:[0,0,1] neg_hi:[0,0,1]
    v_pk_fma_f32 v[102:103], v[102:103], v[38:39], v[120:121] op_sel:[0,1,0] op_sel_hi:[1,1,0] neg_lo:[0,0,1] neg_hi:[0,0,1]
    v_pk_fma_f32 v[104:105], v[104:105], v[38:39], v[120:121] op_sel:[0,1,0] op_sel_hi:[1,1,0] neg_lo:[0,0,1] neg_hi:[0,0,1]
    v_pk_fma_f32 v[106:107], v[106:107], v[38:39], v[120:121] op_sel:[0,1,0] op_sel_hi:[1,1,0] neg_lo:[0,0,1] neg_hi:[0,0,1]
    v_pk_fma_f32 v[108:109], v[108:109], v[38:39], v[120:121] op_sel:[0,1,0] op_sel_hi:[1,1,0] neg_lo:[0,0,1] neg_hi:[0,0,1]
    v_pk_fma_f32 v[110:111], v[110:111], v[38:39], v[120:121] op_sel:[0,1,0] op_sel_hi:[1,1,0] neg_lo:[0,0,1] neg_hi:[0,0,1]
    v_exp_f32 v96, v96
    v_exp_f32 v97, v97
    v_exp_f32 v98, v98
    v_exp_f32 v99, v99
    v_exp_f32 v100, v100
    v_exp_f32 v101, v101
    v_exp_f32 v102, v102
    v_exp_f32 v103, v103
    v_exp_f32 v104, v104
    v_exp_f32 v105, v105
    v_exp_f32 v106, v106
    v_exp_f32 v107, v107
    v_exp_f32 v108, v108
    v_exp_f32 v109, v109
    v_exp_f32 v110, v110
    v_exp_f32 v111, v111
    v_pk_add_f32 v[120:121], v[96:97], v[98:99]
    v_pk_add_f32 v[122:123], v[100:101], v[102:103]
    v_pk_add_f32 v[124:125], v[104:105], v[106:107]
    v_pk_add_f32 v[126:127], v[108:109], v[110:111]
    v_pk_add_f32 v[120:121], v[120:121], v[122:123]
    v_pk_add_f32 v[124:125], v[124:125], v[126:127]
    v_pk_add_f32 v[120:121], v[120:121], v[124:125]
    v_add_f32 v120, v120, v121
    v_rcp_f32 v120, v120
    s_nop 0
    v_pk_mul_f32 v[96:97], v[96:97], v[120:121] op_sel_hi:[1,0]
    v_pk_mul_f32 v[98:99], v[98:99], v[120:121] op_sel_hi:[1,0]
    v_pk_mul_f32 v[100:101], v[100:101], v[120:121] op_sel_hi:[1,0]
    v_pk_mul_f32 v[102:103], v[102:103], v[120:121] op_sel_hi:[1,0]
    v_pk_mul_f32 v[104:105], v[104:105], v[120:121] op_sel_hi:[1,0]
    v_pk_mul_f32 v[106:107], v[106:107], v[120:121] op_sel_hi:[1,0]
    v_pk_mul_f32 v[108:109], v[108:109], v[120:121] op_sel_hi:[1,0]
    v_pk_mul_f32 v[110:111], v[110:111], v[120:121] op_sel_hi:[1,0]
    v_cvt_pk_bf16_f32 v96, v96, v97
    v_cvt_pk_bf16_f32 v97, v98, v99
    v_cvt_pk_bf16_f32 v98, v100, v101
    v_cvt_pk_bf16_f32 v99, v102, v103
    v_cvt_pk_bf16_f32 v100, v104, v105
    v_cvt_pk_bf16_f32 v101, v106, v107
    v_cvt_pk_bf16_f32 v102, v108, v109
    v_cvt_pk_bf16_f32 v103, v110, v111
    ds_write_b128 v51, v[96:99] offset:0
    ds_write_b128 v51, v[100:103] offset:2176
    v_max3_f32 v120, v64, v65, v66
    v_max3_f32 v121, v67, v68, v69
    v_max3_f32 v120, v120, v70, v71
    v_max3_f32 v121, v121, v72, v73
    v_max3_f32 v120, v120, v74, v75
    v_max3_f32 v121, v121, v76, v77
    v_max3_f32 v120, v120, v78, v79
    v_max_f32 v120, v120, v121
    v_mul_f32_e64 v120, v39, v120
    v_pk_fma_f32 v[64:65], v[64:65], v[38:39], v[120:121] op_sel:[0,1,0] op_sel_hi:[1,1,0] neg_lo:[0,0,1] neg_hi:[0,0,1]
    v_pk_fma_f32 v[66:67], v[66:67], v[38:39], v[120:121] op_sel:[0,1,0] op_sel_hi:[1,1,0] neg_lo:[0,0,1] neg_hi:[0,0,1]
    v_pk_fma_f32 v[68:69], v[68:69], v[38:39], v[120:121] op_sel:[0,1,0] op_sel_hi:[1,1,0] neg_lo:[0,0,1] neg_hi:[0,0,1]
    v_pk_fma_f32 v[70:71], v[70:71], v[38:39], v[120:121] op_sel:[0,1,0] op_sel_hi:[1,1,0] neg_lo:[0,0,1] neg_hi:[0,0,1]
    v_pk_fma_f32 v[72:73], v[72:73], v[38:39], v[120:121] op_sel:[0,1,0] op_sel_hi:[1,1,0] neg_lo:[0,0,1] neg_hi:[0,0,1]
    v_pk_fma_f32 v[74:75], v[74:75], v[38:39], v[120:121] op_sel:[0,1,0] op_sel_hi:[1,1,0] neg_lo:[0,0,1] neg_hi:[0,0,1]
    v_pk_fma_f32 v[76:77], v[76:77], v[38:39], v[120:121] op_sel:[0,1,0] op_sel_hi:[1,1,0] neg_lo:[0,0,1] neg_hi:[0,0,1]
    v_pk_fma_f32 v[78:79], v[78:79], v[38:39], v[120:121] op_sel:[0,1,0] op_sel_hi:[1,1,0] neg_lo:[0,0,1] neg_hi:[0,0,1]
    s_xor_b32 s80, s54, 0
    s_add_u32 m0, s80, 0
    s_lshl3_add_u32 s80, s80, 0
    buffer_load_dwordx4 v49, s[24:27], s80 offen offset:0 lds
    v_exp_f32 v64, v64
    v_exp_f32 v65, v65
    v_exp_f32 v66, v66
    v_exp_f32 v67, v67
    v_exp_f32 v68, v68
    v_exp_f32 v69, v69
    v_exp_f32 v70, v70
    v_exp_f32 v71, v71
    s_add_u32 s80, s80, 7168
    buffer_load_dwordx4 v49, s[24:27], s80 offen offset:1024 lds
    v_exp_f32 v72, v72
    v_exp_f32 v73, v73
    v_exp_f32 v74, v74
    v_exp_f32 v75, v75
    v_exp_f32 v76, v76
    v_exp_f32 v77, v77
    v_exp_f32 v78, v78
    v_exp_f32 v79, v79
    s_xor_b32 s80, s54, 8192
    s_add_u32 m0, s80, 0
    s_lshl3_add_u32 s80, s80, 0
    buffer_load_dwordx4 v49, s[24:27], s80 offen offset:0 lds
    v_pk_add_f32 v[120:121], v[64:65], v[66:67]
    v_pk_add_f32 v[122:123], v[68:69], v[70:71]
    v_pk_add_f32 v[124:125], v[72:73], v[74:75]
    v_pk_add_f32 v[126:127], v[76:77], v[78:79]
    v_pk_add_f32 v[120:121], v[120:121], v[122:123]
    v_pk_add_f32 v[124:125], v[124:125], v[126:127]
    v_pk_add_f32 v[120:121], v[120:121], v[124:125]
    v_add_f32 v120, v120, v121
    v_rcp_f32 v120, v120
    s_add_u32 s80, s80, 7168
    buffer_load_dwordx4 v49, s[24:27], s80 offen offset:1024 lds
    v_pk_mul_f32 v[64:65], v[64:65], v[120:121] op_sel_hi:[1,0]
    v_pk_mul_f32 v[66:67], v[66:67], v[120:121] op_sel_hi:[1,0]
    v_pk_mul_f32 v[68:69], v[68:69], v[120:121] op_sel_hi:[1,0]
    v_pk_mul_f32 v[70:71], v[70:71], v[120:121] op_sel_hi:[1,0]
    v_pk_mul_f32 v[72:73], v[72:73], v[120:121] op_sel_hi:[1,0]
    v_pk_mul_f32 v[74:75], v[74:75], v[120:121] op_sel_hi:[1,0]
    v_pk_mul_f32 v[76:77], v[76:77], v[120:121] op_sel_hi:[1,0]
    v_pk_mul_f32 v[78:79], v[78:79], v[120:121] op_sel_hi:[1,0]
    v_cvt_pk_bf16_f32 v64, v64, v65
    v_cvt_pk_bf16_f32 v65, v66, v67
    v_cvt_pk_bf16_f32 v66, v68, v69
    v_cvt_pk_bf16_f32 v67, v70, v71
    v_cvt_pk_bf16_f32 v68, v72, v73
    v_cvt_pk_bf16_f32 v69, v74, v75
    v_cvt_pk_bf16_f32 v70, v76, v77
    v_cvt_pk_bf16_f32 v71, v78, v79
    ds_write_b128 v51, v[64:67] offset:4352
    ds_write_b128 v51, v[68:71] offset:6528
    v_mov_b32 v124, s74
    v_mov_b32 v125, s74
    v_mov_b32 v126, s74
    v_mov_b32 v127, s74
    s_waitcnt vmcnt(4)
    s_waitcnt lgkmcnt(0)
    s_barrier
    ds_read_b64_tr_b16 v[64:65], v53 offset:0
    ds_read_b64_tr_b16 v[66:67], v53 offset:256
    ds_read_b64_tr_b16 v[80:81], v52 offset:17408
    ds_read_b64_tr_b16 v[82:83], v52 offset:17664
    ds_read_b64_tr_b16 v[68:69], v53 offset:512
    ds_read_b64_tr_b16 v[70:71], v53 offset:768
    ds_read_b64_tr_b16 v[84:85], v52 offset:17920
    ds_read_b64_tr_b16 v[86:87], v52 offset:18176
    ds_read_b64_tr_b16 v[72:73], v53 offset:1024
    ds_read_b64_tr_b16 v[74:75], v53 offset:1280
    ds_read_b64_tr_b16 v[88:89], v52 offset:18432
    ds_read_b64_tr_b16 v[90:91], v52 offset:18688
    ds_read_b64_tr_b16 v[76:77], v53 offset:1536
L_pad4:
    s_cbranch_execz L_pad8
    ds_read_b64_tr_b16 v[78:79], v53 offset:1792
    ds_read_b64_tr_b16 v[92:93], v52 offset:18944
    ds_read_b64_tr_b16 v[94:95], v52 offset:19200
    s_waitcnt lgkmcnt(12)
    v_mfma_f32_16x16x32_bf16 v[112:115], v[64:67], v[80:83], 0
    v_mfma_f32_16x16x32_bf16 v[116:119], v[124:127], v[64:67], 0
    ds_read_b64_tr_b16 a[192:193], v44 offset:0
    ds_read_b64_tr_b16 a[194:195], v44 offset:1024
    s_waitcnt lgkmcnt(10)
    v_mfma_f32_16x16x32_bf16 v[112:115], v[68:71], v[84:87], v[112:115]
    v_mfma_f32_16x16x32_bf16 v[116:119], v[124:127], v[68:71], v[116:119]
    ds_read_b64_tr_b16 a[196:197], v44 offset:512
    ds_read_b64_tr_b16 a[198:199], v44 offset:1536
    s_waitcnt lgkmcnt(8)
    v_mfma_f32_16x16x32_bf16 v[112:115], v[72:75], v[88:91], v[112:115]
    v_mfma_f32_16x16x32_bf16 v[116:119], v[124:127], v[72:75], v[116:119]
    ds_read_b64_tr_b16 a[200:201], v44 offset:2048
    ds_read_b64_tr_b16 a[202:203], v44 offset:3072
    s_waitcnt lgkmcnt(6)
    v_mfma_f32_16x16x32_bf16 v[112:115], v[76:79], v[92:95], v[112:115]
    v_mfma_f32_16x16x32_bf16 v[116:119], v[124:127], v[76:79], v[116:119]
    ds_read_b64_tr_b16 a[204:205], v44 offset:2560
    ds_read_b64_tr_b16 a[206:207], v44 offset:3584
    s_nop 4
    v_cvt_pk_bf16_f32 v120, v112, v113
    v_cvt_pk_bf16_f32 v121, v114, v115
    v_min_u32 v120, -2, v120
    v_min_u32 v121, -2, v121
    buffer_store_dwordx2 v[120:121], v59, s[36:39], s88 offen sc1
    v_min_u32 v124, -2, v116
    buffer_store_dword v124, v60, s[36:39], s89 offen sc1
    s_waitcnt lgkmcnt(6)
    v_mfma_f32_32x32x16_bf16 v[64:79], a[192:195], v[128:131], 0
    s_mov_b32 vcc_lo, 0xf0f00f0f
    s_mov_b32 vcc_hi, 0xf0f00f0f
    v_mov_b32 v89, s74
    v_cndmask_b32 v88, 0, v89, vcc
    v_mov_b32 v89, v88
    v_mov_b32 v90, v88
    v_mov_b32 v91, v88
    ds_read_b64_tr_b16 a[208:209], v44 offset:4096
    ds_read_b64_tr_b16 a[210:211], v44 offset:5120
    s_waitcnt lgkmcnt(6)
    v_mfma_f32_32x32x16_bf16 v[64:79], a[196:199], v[132:135], v[64:79]
    ds_read_b64_tr_b16 a[212:213], v44 offset:4608
    ds_read_b64_tr_b16 a[214:215], v44 offset:5632
    v_mov_b32 v124, -1
    v_mov_b32 v125, -1
    s_add_u32 s92, s68, 1572864
    s_add_u32 s93, s71, 196608
    buffer_store_dwordx2 v[124:125], v59, s[36:39], s92 offen sc1
    buffer_store_dword v124, v60, s[36:39], s93 offen sc1
    s_waitcnt lgkmcnt(4)
    v_mfma_f32_16x16x32_bf16 v[92:95], v[88:91], a[192:195], 0
    v_mfma_f32_32x32x16_bf16 v[64:79], a[200:203], v[136:139], v[64:79]
    ds_read_b64_tr_b16 a[216:217], v44 offset:6144
    ds_read_b64_tr_b16 a[218:219], v44 offset:7168
    v_mfma_f32_16x16x32_bf16 v[92:95], v[88:91], a[196:199], v[92:95]
    v_mfma_f32_32x32x16_bf16 v[64:79], a[204:207], v[140:143], v[64:79]
    ds_read_b64_tr_b16 a[220:221], v44 offset:6656
    ds_read_b64_tr_b16 a[222:223], v44 offset:7680
    s_xor_b32 s80, s54, 16384
    s_add_u32 m0, s80, 0
    s_lshl3_add_u32 s80, s80, 0
    buffer_load_dwordx4 v49, s[24:27], s80 offen offset:0 lds
    s_waitcnt lgkmcnt(4)
    v_mfma_f32_16x16x32_bf16 v[92:95], v[88:91], a[200:203], v[92:95]
    v_mfma_f32_32x32x16_bf16 v[64:79], a[208:211], v[144:147], v[64:79]
    v_xor_b32 v44, 8192, v44
    ds_read_b64_tr_b16 v[104:105], v44 offset:0
    ds_read_b64_tr_b16 v[106:107], v44 offset:1024
    v_mfma_f32_16x16x32_bf16 v[92:95], v[88:91], a[204:207], v[92:95]
    v_mfma_f32_32x32x16_bf16 v[64:79], a[212:215], v[148:151], v[64:79]
    ds_read_b64_tr_b16 v[108:109], v44 offset:512
    ds_read_b64_tr_b16 v[110:111], v44 offset:1536
    s_add_u32 s80, s80, 7168
    buffer_load_dwordx4 v49, s[24:27], s80 offen offset:1024 lds
    s_waitcnt lgkmcnt(4)
    v_mfma_f32_16x16x32_bf16 v[92:95], v[88:91], a[208:211], v[92:95]
    v_mfma_f32_32x32x16_bf16 v[64:79], a[216:219], v[152:155], v[64:79]
    ds_read_b64_tr_b16 v[112:113], v44 offset:2048
    ds_read_b64_tr_b16 v[114:115], v44 offset:3072
    v_mfma_f32_16x16x32_bf16 v[92:95], v[88:91], a[212:215], v[92:95]
    v_mfma_f32_32x32x16_bf16 v[64:79], a[220:223], v[156:159], v[64:79]
    ds_read_b64_tr_b16 v[116:117], v44 offset:2560
    ds_read_b64_tr_b16 v[118:119], v44 offset:3584
    s_xor_b32 s80, s54, 24576
    s_add_u32 m0, s80, 0
    s_lshl3_add_u32 s80, s80, 0
    buffer_load_dwordx4 v49, s[24:27], s80 offen offset:0 lds
    s_waitcnt lgkmcnt(4)
    v_mfma_f32_16x16x32_bf16 v[92:95], v[88:91], a[216:219], v[92:95]
    v_mfma_f32_32x32x16_bf16 v[64:79], v[104:107], v[160:163], v[64:79]
    ds_read_b64_tr_b16 v[96:97], v44 offset:4096
    ds_read_b64_tr_b16 v[98:99], v44 offset:5120
    v_mfma_f32_16x16x32_bf16 v[92:95], v[88:91], a[220:223], v[92:95]
    v_mfma_f32_32x32x16_bf16 v[64:79], v[108:111], v[164:167], v[64:79]
    ds_read_b64_tr_b16 v[100:101], v44 offset:4608
    ds_read_b64_tr_b16 v[102:103], v44 offset:5632
    s_add_u32 s80, s80, 7168
    buffer_load_dwordx4 v49, s[24:27], s80 offen offset:1024 lds
    s_waitcnt lgkmcnt(4)
    v_mfma_f32_32x32x16_bf16 v[64:79], v[112:115], v[168:171], v[64:79]
    ds_read_b64_tr_b16 v[104:105], v44 offset:6144
    ds_read_b64_tr_b16 v[106:107], v44 offset:7168
    v_mfma_f32_32x32x16_bf16 v[64:79], v[116:119], v[172:175], v[64:79]
    ds_read_b64_tr_b16 v[108:109], v44 offset:6656
    ds_read_b64_tr_b16 v[110:111], v44 offset:7680
    s_xor_b32 s80, s54, 0
    s_add_u32 m0, s80, 32768
    s_lshl3_add_u32 s80, s80, 262144
    buffer_load_dwordx4 v49, s[24:27], s80 offen offset:0 lds
    ds_write_b32 v43, v92 offset:0
    s_waitcnt lgkmcnt(5)
    v_mfma_f32_32x32x16_bf16 v[64:79], v[96:99], v[176:179], v[64:79]
    v_xor_b32 v44, 24576, v44
    ds_read_b64_tr_b16 v[112:113], v44 offset:0
    ds_read_b64_tr_b16 v[114:115], v44 offset:1024
    v_mfma_f32_32x32x16_bf16 v[64:79], v[100:103], v[180:183], v[64:79]
    ds_read_b64_tr_b16 v[116:117], v44 offset:512
    ds_read_b64_tr_b16 v[118:119], v44 offset:1536
    s_add_u32 s80, s80, 7168
    buffer_load_dwordx4 v49, s[24:27], s80 offen offset:1024 lds
    s_waitcnt lgkmcnt(4)
    s_barrier
    v_and_b32 v80, -16, v43
    ds_read_b128 v[80:83], v80 offset:0
    v_mfma_f32_32x32x16_bf16 v[64:79], v[104:107], v[184:187], v[64:79]
    ds_read_b64_tr_b16 v[96:97], v44 offset:2048
    ds_read_b64_tr_b16 v[98:99], v44 offset:3072
    v_mfma_f32_32x32x16_bf16 v[64:79], v[108:111], v[188:191], v[64:79]
    ds_read_b64_tr_b16 v[100:101], v44 offset:2560
    ds_read_b64_tr_b16 v[102:103], v44 offset:3584
    s_xor_b32 s80, s54, 8192
    s_add_u32 m0, s80, 32768
    s_lshl3_add_u32 s80, s80, 262144
    buffer_load_dwordx4 v49, s[24:27], s80 offen offset:0 lds
    s_waitcnt lgkmcnt(5)
    v_mfma_f32_32x32x16_bf16 v[64:79], v[112:115], v[192:195], v[64:79]
    ds_read_b64_tr_b16 v[104:105], v44 offset:4096
    ds_read_b64_tr_b16 v[106:107], v44 offset:5120
    s_waitcnt lgkmcnt(6)
    v_add_f32 v80, v80, v82
    v_add_f32 v81, v81, v83
    v_mfma_f32_32x32x16_bf16 v[64:79], v[116:119], v[196:199], v[64:79]
    ds_read_b64_tr_b16 v[108:109], v44 offset:4608
    ds_read_b64_tr_b16 v[110:111], v44 offset:5632
    s_add_u32 s80, s80, 7168
    buffer_load_dwordx4 v49, s[24:27], s80 offen offset:1024 lds
    v_add_f32 v80, v80, v81
    v_and_b32 v81, s76, v80
    s_waitcnt lgkmcnt(4)
    v_mfma_f32_32x32x16_bf16 v[64:79], v[96:99], v[200:203], v[64:79]
    ds_read_b64_tr_b16 v[112:113], v44 offset:6144
    ds_read_b64_tr_b16 v[114:115], v44 offset:7168
    v_sub_f32 v81, v80, v81
    v_perm_b32 v30, v81, v80, s75
    v_mfma_f32_32x32x16_bf16 v[64:79], v[100:103], v[204:207], v[64:79]
    ds_read_b64_tr_b16 v[116:117], v44 offset:6656
    ds_read_b64_tr_b16 v[118:119], v44 offset:7680
    v_and_b32 v82, s76, v81
    v_sub_f32 v82, v81, v82
    s_waitcnt lgkmcnt(4)
    v_mfma_f32_32x32x16_bf16 v[64:79], v[104:107], v[208:211], v[64:79]
    v_xor_b32 v44, 8192, v44
    ds_read_b64_tr_b16 v[96:97], v44 offset:0
    ds_read_b64_tr_b16 v[98:99], v44 offset:1024
    s_add_u32 s89, s70, 65536
    buffer_load_dword v160, v3, s[36:39], s89 offen offset:0 sc1
    v_lshrrev_b32 v31, 16, v82
    v_mfma_f32_32x32x16_bf16 v[64:79], v[108:111], v[212:215], v[64:79]
    ds_read_b64_tr_b16 v[100:101], v44 offset:512
    ds_read_b64_tr_b16 v[102:103], v44 offset:1536
    buffer_load_dword v161, v3, s[36:39], s89 offen offset:256 sc1
    v_mfma_f32_32x32x8_bf16 v[64:79], v[30:31], v[36:37], v[64:79]
    s_waitcnt lgkmcnt(4)
    v_mfma_f32_32x32x16_bf16 v[64:79], v[112:115], v[216:219], v[64:79]
    ds_read_b64_tr_b16 v[104:105], v44 offset:2048
    ds_read_b64_tr_b16 v[106:107], v44 offset:3072
    buffer_load_dword v162, v3, s[36:39], s89 offen offset:512 sc1
    v_mfma_f32_32x32x16_bf16 v[64:79], v[116:119], v[220:223], v[64:79]
    ds_read_b64_tr_b16 v[108:109], v44 offset:2560
    ds_read_b64_tr_b16 v[110:111], v44 offset:3584
    buffer_load_dword v163, v3, s[36:39], s89 offen offset:768 sc1
    s_waitcnt lgkmcnt(4)
    v_mfma_f32_32x32x16_bf16 v[64:79], v[96:99], v[224:227], v[64:79]
    ds_read_b64_tr_b16 v[112:113], v44 offset:4096
    ds_read_b64_tr_b16 v[114:115], v44 offset:5120
    s_add_u32 s88, s67, 524288
    buffer_load_dwordx4 v[128:131], v2, s[36:39], s88 offen offset:0 sc1
    v_mfma_f32_32x32x16_bf16 v[64:79], v[100:103], v[228:231], v[64:79]
    ds_read_b64_tr_b16 v[116:117], v44 offset:4608
    ds_read_b64_tr_b16 v[118:119], v44 offset:5632
    buffer_load_dwordx4 v[132:135], v2, s[36:39], s88 offen offset:1024 sc1
    s_waitcnt lgkmcnt(4)
    v_mfma_f32_32x32x16_bf16 v[64:79], v[104:107], v[232:235], v[64:79]
    ds_read_b64_tr_b16 v[96:97], v44 offset:6144
    ds_read_b64_tr_b16 v[98:99], v44 offset:7168
    buffer_load_dwordx4 v[136:139], v2, s[36:39], s88 offen offset:2048 sc1
    v_mfma_f32_32x32x16_bf16 v[64:79], v[108:111], v[236:239], v[64:79]
    ds_read_b64_tr_b16 v[100:101], v44 offset:6656
    ds_read_b64_tr_b16 v[102:103], v44 offset:7680
    buffer_load_dwordx4 v[140:143], v2, s[36:39], s88 offen offset:3072 sc1
    s_waitcnt lgkmcnt(4)
    v_mfma_f32_32x32x16_bf16 v[64:79], v[112:115], v[240:243], v[64:79]
    s_add_u32 s88, s67, 528384
    buffer_load_dwordx4 v[144:147], v2, s[36:39], s88 offen offset:0 sc1
    v_mfma_f32_32x32x16_bf16 v[64:79], v[116:119], v[244:247], v[64:79]
    buffer_load_dwordx4 v[148:151], v2, s[36:39], s88 offen offset:1024 sc1
    s_waitcnt lgkmcnt(0)
    v_mfma_f32_32x32x16_bf16 v[64:79], v[96:99], v[248:251], v[64:79]
    buffer_load_dwordx4 v[152:155], v2, s[36:39], s88 offen offset:2048 sc1
    v_mfma_f32_32x32x16_bf16 v[64:79], v[100:103], v[252:255], v[64:79]
    buffer_load_dwordx4 v[156:159], v2, s[36:39], s88 offen offset:3072 sc1
    s_nop 10
    v_cvt_pk_bf16_f32 v120, v64, v65
    v_cvt_pk_bf16_f32 v121, v66, v67
    v_cvt_pk_bf16_f32 v122, v68, v69
    v_cvt_pk_bf16_f32 v123, v70, v71
    v_cvt_pk_bf16_f32 v124, v72, v73
    v_cvt_pk_bf16_f32 v125, v74, v75
    v_mfma_f32_32x32x16_bf16 v[80:95], v[12:15], v[120:123], 0
    v_cvt_pk_bf16_f32 v126, v76, v77
    v_cvt_pk_bf16_f32 v127, v78, v79
    s_nop 3
    v_mfma_f32_32x32x16_bf16 v[64:79], v[16:19], v[124:127], 0
    s_nop 4
    v_max3_f32 v96, v80, v81, v82
    v_max3_f32 v97, v83, v84, v85
    v_max3_f32 v96, v96, v86, v87
    v_max3_f32 v97, v97, v88, v89
    v_max3_f32 v96, v96, v90, v91
    v_max3_f32 v97, v97, v92, v93
    v_max3_f32 v96, v96, v94, v95
    v_max_f32 v96, v96, v97
    v_mul_f32 v96, v39, v96
    v_pk_fma_f32 v[80:81], v[80:81], v[38:39], v[96:97] op_sel:[0,1,0] op_sel_hi:[1,1,0] neg_lo:[0,0,1] neg_hi:[0,0,1]
    v_pk_fma_f32 v[82:83], v[82:83], v[38:39], v[96:97] op_sel:[0,1,0] op_sel_hi:[1,1,0] neg_lo:[0,0,1] neg_hi:[0,0,1]
    v_pk_fma_f32 v[84:85], v[84:85], v[38:39], v[96:97] op_sel:[0,1,0] op_sel_hi:[1,1,0] neg_lo:[0,0,1] neg_hi:[0,0,1]
    v_pk_fma_f32 v[86:87], v[86:87], v[38:39], v[96:97] op_sel:[0,1,0] op_sel_hi:[1,1,0] neg_lo:[0,0,1] neg_hi:[0,0,1]
    v_pk_fma_f32 v[88:89], v[88:89], v[38:39], v[96:97] op_sel:[0,1,0] op_sel_hi:[1,1,0] neg_lo:[0,0,1] neg_hi:[0,0,1]
    v_pk_fma_f32 v[90:91], v[90:91], v[38:39], v[96:97] op_sel:[0,1,0] op_sel_hi:[1,1,0] neg_lo:[0,0,1] neg_hi:[0,0,1]
    v_pk_fma_f32 v[92:93], v[92:93], v[38:39], v[96:97] op_sel:[0,1,0] op_sel_hi:[1,1,0] neg_lo:[0,0,1] neg_hi:[0,0,1]
    v_pk_fma_f32 v[94:95], v[94:95], v[38:39], v[96:97] op_sel:[0,1,0] op_sel_hi:[1,1,0] neg_lo:[0,0,1] neg_hi:[0,0,1]
    s_xor_b32 s80, s54, 16384
    s_add_u32 m0, s80, 32768
    s_lshl3_add_u32 s80, s80, 262144
    buffer_load_dwordx4 v49, s[24:27], s80 offen offset:0 lds
    v_exp_f32 v80, v80
    v_exp_f32 v81, v81
    v_exp_f32 v82, v82
    v_exp_f32 v83, v83
    v_exp_f32 v84, v84
    v_exp_f32 v85, v85
    v_exp_f32 v86, v86
    v_exp_f32 v87, v87
    s_add_u32 s80, s80, 7168
    buffer_load_dwordx4 v49, s[24:27], s80 offen offset:1024 lds
    v_exp_f32 v88, v88
    v_exp_f32 v89, v89
    v_exp_f32 v90, v90
    v_exp_f32 v91, v91
    v_exp_f32 v92, v92
    v_exp_f32 v93, v93
    v_exp_f32 v94, v94
    v_exp_f32 v95, v95
    s_xor_b32 s80, s54, 24576
    s_add_u32 m0, s80, 32768
    s_lshl3_add_u32 s80, s80, 262144
    buffer_load_dwordx4 v49, s[24:27], s80 offen offset:0 lds
    v_pk_add_f32 v[96:97], v[80:81], v[82:83]
    v_pk_add_f32 v[98:99], v[84:85], v[86:87]
    v_pk_add_f32 v[100:101], v[88:89], v[90:91]
    v_pk_add_f32 v[102:103], v[92:93], v[94:95]
    v_pk_add_f32 v[96:97], v[96:97], v[98:99]
    v_pk_add_f32 v[100:101], v[100:101], v[102:103]
    v_pk_add_f32 v[96:97], v[96:97], v[100:101]
    v_add_f32 v96, v96, v97
    v_rcp_f32 v96, v96
    s_add_u32 s80, s80, 7168
    buffer_load_dwordx4 v49, s[24:27], s80 offen offset:1024 lds
    v_pk_mul_f32 v[80:81], v[80:81], v[96:97] op_sel_hi:[1,0]
    v_pk_mul_f32 v[82:83], v[82:83], v[96:97] op_sel_hi:[1,0]
    v_pk_mul_f32 v[84:85], v[84:85], v[96:97] op_sel_hi:[1,0]
    v_pk_mul_f32 v[86:87], v[86:87], v[96:97] op_sel_hi:[1,0]
    v_pk_mul_f32 v[88:89], v[88:89], v[96:97] op_sel_hi:[1,0]
    v_pk_mul_f32 v[90:91], v[90:91], v[96:97] op_sel_hi:[1,0]
    v_pk_mul_f32 v[92:93], v[92:93], v[96:97] op_sel_hi:[1,0]
    v_pk_mul_f32 v[94:95], v[94:95], v[96:97] op_sel_hi:[1,0]
    v_cvt_pk_bf16_f32 v192, v80, v81
    v_cvt_pk_bf16_f32 v193, v82, v83
    v_cvt_pk_bf16_f32 v194, v84, v85
    v_cvt_pk_bf16_f32 v195, v86, v87
    v_cvt_pk_bf16_f32 v196, v88, v89
    v_cvt_pk_bf16_f32 v197, v90, v91
    v_cvt_pk_bf16_f32 v198, v92, v93
    v_cvt_pk_bf16_f32 v199, v94, v95
    v_max3_f32 v96, v64, v65, v66
    v_max3_f32 v97, v67, v68, v69
    v_max3_f32 v96, v96, v70, v71
    v_max3_f32 v97, v97, v72, v73
    v_max3_f32 v96, v96, v74, v75
    v_max3_f32 v97, v97, v76, v77
    v_max3_f32 v96, v96, v78, v79
    v_max_f32 v96, v96, v97
    v_mul_f32 v96, v39, v96
    v_pk_fma_f32 v[64:65], v[64:65], v[38:39], v[96:97] op_sel:[0,1,0] op_sel_hi:[1,1,0] neg_lo:[0,0,1] neg_hi:[0,0,1]
    v_pk_fma_f32 v[66:67], v[66:67], v[38:39], v[96:97] op_sel:[0,1,0] op_sel_hi:[1,1,0] neg_lo:[0,0,1] neg_hi:[0,0,1]
    v_pk_fma_f32 v[68:69], v[68:69], v[38:39], v[96:97] op_sel:[0,1,0] op_sel_hi:[1,1,0] neg_lo:[0,0,1] neg_hi:[0,0,1]
    v_pk_fma_f32 v[70:71], v[70:71], v[38:39], v[96:97] op_sel:[0,1,0] op_sel_hi:[1,1,0] neg_lo:[0,0,1] neg_hi:[0,0,1]
    v_pk_fma_f32 v[72:73], v[72:73], v[38:39], v[96:97] op_sel:[0,1,0] op_sel_hi:[1,1,0] neg_lo:[0,0,1] neg_hi:[0,0,1]
    v_pk_fma_f32 v[74:75], v[74:75], v[38:39], v[96:97] op_sel:[0,1,0] op_sel_hi:[1,1,0] neg_lo:[0,0,1] neg_hi:[0,0,1]
    v_pk_fma_f32 v[76:77], v[76:77], v[38:39], v[96:97] op_sel:[0,1,0] op_sel_hi:[1,1,0] neg_lo:[0,0,1] neg_hi:[0,0,1]
    v_pk_fma_f32 v[78:79], v[78:79], v[38:39], v[96:97] op_sel:[0,1,0] op_sel_hi:[1,1,0] neg_lo:[0,0,1] neg_hi:[0,0,1]
    s_waitcnt vmcnt(12)
    s_mov_b32 s3, 0
    v_max3_u32 v165, v160, v161, v162
    v_max_u32 v165, v165, v163
    v_cmp_eq_u32 vcc, -1, v165
    s_cbranch_vccnz L_e1k1
L_e1kj1:
    v_exp_f32 v64, v64
    v_exp_f32 v65, v65
    v_exp_f32 v66, v66
    v_exp_f32 v67, v67
    v_exp_f32 v68, v68
    v_exp_f32 v69, v69
    v_exp_f32 v70, v70
    v_exp_f32 v71, v71
    v_exp_f32 v72, v72
    v_exp_f32 v73, v73
    v_exp_f32 v74, v74
    v_exp_f32 v75, v75
    v_exp_f32 v76, v76
    v_exp_f32 v77, v77
    v_exp_f32 v78, v78
    v_exp_f32_e64 v79, v79
    v_pk_add_f32 v[96:97], v[64:65], v[66:67]
    v_pk_add_f32 v[98:99], v[68:69], v[70:71]
    v_pk_add_f32 v[100:101], v[72:73], v[74:75]
    v_pk_add_f32 v[102:103], v[76:77], v[78:79]
    v_pk_add_f32 v[96:97], v[96:97], v[98:99]
    v_pk_add_f32 v[100:101], v[100:101], v[102:103]
    v_pk_add_f32 v[96:97], v[96:97], v[100:101]
    v_add_f32 v96, v96, v97
    v_rcp_f32 v96, v96
    s_nop 0
    v_pk_mul_f32 v[64:65], v[64:65], v[96:97] op_sel_hi:[1,0]
    v_pk_mul_f32 v[66:67], v[66:67], v[96:97] op_sel_hi:[1,0]
    v_pk_mul_f32 v[68:69], v[68:69], v[96:97] op_sel_hi:[1,0]
    v_pk_mul_f32 v[70:71], v[70:71], v[96:97] op_sel_hi:[1,0]
    v_pk_mul_f32 v[72:73], v[72:73], v[96:97] op_sel_hi:[1,0]
    v_pk_mul_f32 v[74:75], v[74:75], v[96:97] op_sel_hi:[1,0]
    v_pk_mul_f32 v[76:77], v[76:77], v[96:97] op_sel_hi:[1,0]
    v_pk_mul_f32 v[78:79], v[78:79], v[96:97] op_sel_hi:[1,0]
    v_cvt_pk_bf16_f32 v200, v64, v65
    v_cvt_pk_bf16_f32 v201, v66, v67
    v_cvt_pk_bf16_f32 v202, v68, v69
    v_cvt_pk_bf16_f32 v203, v70, v71
    v_cvt_pk_bf16_f32 v204, v72, v73
    v_cvt_pk_bf16_f32 v205, v74, v75
    v_cvt_pk_bf16_f32 v206, v76, v77
    v_cvt_pk_bf16_f32 v207, v78, v79
    s_cmp_lg_u32 s3, 0
    s_cbranch_scc1 L_e1w1
L_e1c1:
    v_max3_u32 v120, v160, v161, v162
    v_max_u32 v120, v120, v163
    v_pk_add_f32 v[160:161], v[160:161], v[162:163]
    v_add_f32 v160, v160, v161
    v_mov_b32 v161, v160
    s_waitcnt vmcnt(11)
    v_mfma_f32_16x16x32_bf16 v[96:99], v[20:23], v[128:131], 0
    v_max3_u32 v120, v120, v128, v129
    v_max3_u32 v120, v120, v130, v131
    v_permlane16_swap_b32 v160, v161
    v_add_f32 v160, v160, v161
    v_mov_b32 v161, v160
    s_waitcnt vmcnt(10)
    v_mfma_f32_16x16x32_bf16 v[96:99], v[20:23], v[132:135], v[96:99]
    v_max3_u32 v120, v120, v132, v133
    v_max3_u32 v120, v120, v134, v135
    s_waitcnt vmcnt(9)
    v_mfma_f32_16x16x32_bf16 v[96:99], v[20:23], v[136:139], v[96:99]
    v_max3_u32 v120, v120, v136, v137
    v_max3_u32 v120, v120, v138, v139
    s_waitcnt vmcnt(8)
    v_mfma_f32_16x16x32_bf16 v[96:99], v[20:23], v[140:143], v[96:99]
    v_max3_u32 v120, v120, v140, v141
    v_max3_u32 v120, v120, v142, v143
    s_waitcnt vmcnt(7)
    v_mfma_f32_16x16x32_bf16 v[96:99], v[20:23], v[144:147], v[96:99]
    v_max3_u32 v120, v120, v144, v145
    v_max3_u32 v120, v120, v146, v147
    s_waitcnt vmcnt(6)
    v_mfma_f32_16x16x32_bf16 v[96:99], v[20:23], v[148:151], v[96:99]
    v_max3_u32 v120, v120, v148, v149
    v_max3_u32 v120, v120, v150, v151
    s_waitcnt vmcnt(5)
    v_mfma_f32_16x16x32_bf16 v[96:99], v[20:23], v[152:155], v[96:99]
    v_max3_u32 v120, v120, v152, v153
    v_max3_u32 v120, v120, v154, v155
    s_waitcnt vmcnt(4)
    v_mfma_f32_16x16x32_bf16 v[96:99], v[20:23], v[156:159], v[96:99]
    v_max3_u32 v120, v120, v156, v157
    v_max3_u32 v120, v120, v158, v159
    v_cmp_eq_u32 vcc, -1, v120
    s_cbranch_vccnz L_e1r1
    v_permlane32_swap_b32 v160, v161
    v_add_f32 v160, v160, v161
    v_cvt_pk_bf16_f32 v160, v160, v160
    ds_write_b16 v55, v160 offset:512
    v_cvt_pk_bf16_f32 v120, v96, v97
    v_cvt_pk_bf16_f32 v121, v98, v99
    ds_write_b64 v54, v[120:121]
    s_waitcnt vmcnt(0)
    s_waitcnt lgkmcnt(0)
    s_barrier
    ds_read_b128 v[104:107], v57 offset:0
    ds_read_b128 v[108:111], v57 offset:16
    ds_read_b128 v[112:115], v57 offset:544
    ds_read_b128 v[116:119], v57 offset:560
    s_waitcnt lgkmcnt(3)
    v_mfma_f32_32x32x16_bf16 v[64:79], v[104:107], v[192:195], 0
    s_waitcnt lgkmcnt(2)
    v_mfma_f32_32x32x16_bf16 v[64:79], v[108:111], v[196:199], v[64:79]
    v_add_u32 v44, 65536, v2
    v_mov_b32 v96, 2
    v_add_u32 v124, 0, v63
    v_xor_b32 v125, 32, v124
    s_waitcnt lgkmcnt(0)
    v_mfma_f32_32x32x16_bf16 v[80:95], v[112:115], v[200:203], 0
    v_xor_b32 v126, 64, v124
    v_xor_b32 v127, 96, v124
    s_nop 0
    s_nop 0
    s_nop 0
    v_mfma_f32_32x32x16_bf16 v[80:95], v[116:119], v[204:207], v[80:95]
    v_add_f32 v72, s86, v72
    v_rcp_f32 v72, v72
    s_nop 0
    v_mul_f32 v64, v72, v64
    v_mul_f32 v65, v72, v65
    v_mul_f32 v66, v72, v66
    v_mul_f32 v67, v72, v67
    v_mul_f32 v68, v72, v68
    v_mul_f32 v69, v72, v69
    v_mul_f32 v70, v72, v70
    v_mul_f32 v71, v72, v71
    v_cvt_pk_bf16_f32 v224, v64, v65
    v_cvt_pk_bf16_f32 v225, v66, v67
    v_or_b32 v224, 1, v224
    v_cvt_pk_bf16_f32 v226, v68, v69
    v_cvt_pk_bf16_f32 v227, v70, v71
    s_cmp_lg_u32 s50, 0
    s_cbranch_scc1 L_po10_safe
    buffer_store_dwordx4 v[224:227], v46, s[36:39], s61 offen offset:0
L_po10_join:
    v_add_f32 v88, s86, v88
    v_rcp_f32 v88, v88
    s_nop 0
    v_pk_mul_f32 v[80:81], v[80:81], v[88:89] op_sel_hi:[1,0]
    v_pk_mul_f32 v[82:83], v[82:83], v[88:89] op_sel_hi:[1,0]
    v_pk_mul_f32 v[84:85], v[84:85], v[88:89] op_sel_hi:[1,0]
    v_pk_mul_f32 v[86:87], v[86:87], v[88:89] op_sel_hi:[1,0]
    v_cvt_pk_bf16_f32 v228, v80, v81
    v_cvt_pk_bf16_f32 v229, v82, v83
    v_or_b32 v228, 1, v228
    v_cvt_pk_bf16_f32 v230, v84, v85
    v_cvt_pk_bf16_f32 v231, v86, v87
    s_mov_b64 exec, 1
    buffer_store_dword v96, off, s[36:39], s81
    s_mov_b64 exec, -1
    s_cmp_lg_u32 s50, 0
    s_cbranch_scc1 L_po11_safe
    buffer_store_dwordx4 v[228:231], v46, s[36:39], s61 offen offset:512
L_po11_join:
    ds_read_b64_tr_b16 v[80:81], v124 offset:0
    ds_read_b64_tr_b16 v[82:83], v124 offset:1024
    ds_read_b64_tr_b16 v[84:85], v125 offset:0
    ds_read_b64_tr_b16 v[86:87], v125 offset:1024
    ds_read_b64_tr_b16 v[88:89], v126 offset:0
    ds_read_b64_tr_b16 v[90:91], v126 offset:1024
    ds_read_b64_tr_b16 v[92:93], v127 offset:0
    ds_read_b64_tr_b16 v[94:95], v127 offset:1024
    ds_read_b64_tr_b16 v[96:97], v124 offset:4096
    ds_read_b64_tr_b16 v[98:99], v124 offset:5120
    ds_read_b64_tr_b16 v[100:101], v125 offset:4096
    ds_read_b64_tr_b16 v[102:103], v125 offset:5120
    v_lshlrev_b32 v64, 16, v4
    v_and_b32 v65, s76, v4
    v_lshlrev_b32 v66, 16, v5
    v_and_b32 v67, s76, v5
    v_lshlrev_b32 v68, 16, v6
    v_and_b32 v69, s76, v6
    v_lshlrev_b32 v70, 16, v7
    v_and_b32 v71, s76, v7
    v_lshlrev_b32 v72, 16, v8
    v_and_b32 v73, s76, v8
    v_lshlrev_b32 v74, 16, v9
    v_and_b32 v75, s76, v9
    v_lshlrev_b32 v76, 16, v10
    v_and_b32 v77, s76, v10
    v_lshlrev_b32 v78, 16, v11
    v_and_b32 v79, s76, v11
    s_lshl_b32 s92, s44, 10
    s_add_u32 s92, s92, 98304
    v_add_u32 v40, s92, v2
    ds_write_b128 v40, a[32:35] offset:0
    ds_write_b128 v40, a[36:39] offset:4096
    buffer_load_dword v120, v62, s[36:39], s62 offen sc1
    ds_write_b128 v40, a[40:43] offset:8192
    ds_write_b128 v40, a[44:47] offset:12288
    ds_write_b128 v40, a[48:51] offset:16384
    ds_write_b128 v40, a[52:55] offset:20480
    buffer_load_dword v252, v62, s[36:39], s62 offen sc1
    s_waitcnt vmcnt(1)
    v_cmp_gt_u32 vcc, 2, v120
    s_cbranch_vccz L_ok_o1
    buffer_load_dword v120, v62, s[36:39], s62 offen sc1
L_again_o1:
    s_waitcnt vmcnt(1)
    v_cmp_gt_u32 vcc, 2, v252
    s_cbranch_vccz L_ok_o1
    buffer_load_dword v252, v62, s[36:39], s62 offen sc1
    s_waitcnt vmcnt(1)
    v_cmp_gt_u32 vcc, 2, v120
    s_cbranch_vccz L_ok_o1
    buffer_load_dword v120, v62, s[36:39], s62 offen sc1
    s_sub_u32 s51, s51, 1
    s_cbranch_scc0 L_again_o1
    s_endpgm
L_ok_o1:
    s_add_u32 s88, s60, 0
    buffer_load_dwordx4 v[128:131], v2, s[36:39], s88 offen offset:0 sc1
    buffer_load_dwordx4 v[132:135], v2, s[36:39], s88 offen offset:2048 sc1
    s_add_u32 s88, s60, 4096
    buffer_load_dwordx4 v[136:139], v2, s[36:39], s88 offen offset:0 sc1
    buffer_load_dwordx4 v[140:143], v2, s[36:39], s88 offen offset:2048 sc1
    s_add_u32 s88, s60, 8192
    buffer_load_dwordx4 v[144:147], v2, s[36:39], s88 offen offset:0 sc1
    buffer_load_dwordx4 v[148:151], v2, s[36:39], s88 offen offset:2048 sc1
    s_lshl_b32 s92, s44, 10
    s_add_u32 s92, s92, 98304
    v_add_u32 v40, s92, v2
    ds_write_b128 v40, a[56:59] offset:24576
    ds_write_b128 v40, a[60:63] offset:28672
    s_lshl_b32 s92, s44, 10
    s_add_u32 s92, s92, 65536
    v_add_u32 v1, s92, v2
    ds_write_b128 v1, a[0:3] offset:0
    ds_write_b128 v1, a[4:7] offset:4096
    s_waitcnt vmcnt(5) lgkmcnt(15)
    v_mfma_f32_16x16x32_bf16 v[64:67], v[80:83], v[128:131], v[64:67]
    ds_read_b64_tr_b16 v[104:105], v126 offset:4096
    ds_read_b64_tr_b16 v[106:107], v126 offset:5120
    s_add_u32 s88, s60, 12288
    buffer_load_dwordx4 v[152:155], v2, s[36:39], s88 offen offset:0 sc1
    v_mfma_f32_16x16x32_bf16 v[68:71], v[84:87], v[128:131], v[68:71]
    ds_read_b64_tr_b16 v[108:109], v127 offset:4096
    ds_read_b64_tr_b16 v[110:111], v127 offset:5120
    s_waitcnt lgkmcnt(15)
    v_mfma_f32_16x16x32_bf16 v[72:75], v[88:91], v[128:131], v[72:75]
    ds_read_b64_tr_b16 v[112:113], v124 offset:8192
    ds_read_b64_tr_b16 v[114:115], v124 offset:9216
    v_mfma_f32_16x16x32_bf16 v[76:79], v[92:95], v[128:131], v[76:79]
    ds_read_b64_tr_b16 v[116:117], v125 offset:8192
    ds_read_b64_tr_b16 v[118:119], v125 offset:9216
    s_waitcnt vmcnt(5) lgkmcnt(15)
    v_mfma_f32_16x16x32_bf16 v[64:67], v[96:99], v[132:135], v[64:67]
    ds_read_b64_tr_b16 v[80:81], v126 offset:8192
    ds_read_b64_tr_b16 v[82:83], v126 offset:9216
    buffer_load_dwordx4 v[156:159], v2, s[36:39], s88 offen offset:2048 sc1
    v_mfma_f32_16x16x32_bf16 v[68:71], v[100:103], v[132:135], v[68:71]
    ds_read_b64_tr_b16 v[84:85], v127 offset:8192
    ds_read_b64_tr_b16 v[86:87], v127 offset:9216
    s_waitcnt lgkmcnt(8)
    v_mfma_f32_16x16x32_bf16 v[72:75], v[104:107], v[132:135], v[72:75]
    ds_read_b64_tr_b16 v[88:89], v124 offset:12288
    ds_read_b64_tr_b16 v[90:91], v124 offset:13312
    v_and_b32 v121, v128, v132
    v_mfma_f32_16x16x32_bf16 v[76:79], v[108:111], v[132:135], v[76:79]
    ds_read_b64_tr_b16 v[92:93], v125 offset:12288
    ds_read_b64_tr_b16 v[94:95], v125 offset:13312
    s_waitcnt vmcnt(5) lgkmcnt(8)
    v_mfma_f32_16x16x32_bf16 v[64:67], v[112:115], v[136:139], v[64:67]
    ds_read_b64_tr_b16 v[96:97], v126 offset:12288
    ds_read_b64_tr_b16 v[98:99], v126 offset:13312
    s_add_u32 s88, s60, 16384
    buffer_load_dwordx4 v[160:163], v2, s[36:39], s88 offen offset:0 sc1
    v_mfma_f32_16x16x32_bf16 v[68:71], v[116:119], v[136:139], v[68:71]
    ds_read_b64_tr_b16 v[100:101], v127 offset:12288
    ds_read_b64_tr_b16 v[102:103], v127 offset:13312
    s_waitcnt lgkmcnt(8)
    v_mfma_f32_16x16x32_bf16 v[72:75], v[80:83], v[136:139], v[72:75]
    ds_read_b64_tr_b16 v[104:105], v124 offset:16384
    ds_read_b64_tr_b16 v[106:107], v124 offset:17408
    v_mfma_f32_16x16x32_bf16 v[76:79], v[84:87], v[136:139], v[76:79]
    ds_read_b64_tr_b16 v[108:109], v125 offset:16384
    ds_read_b64_tr_b16 v[110:111], v125 offset:17408
    s_waitcnt vmcnt(5) lgkmcnt(8)
    v_mfma_f32_16x16x32_bf16 v[64:67], v[88:91], v[140:143], v[64:67]
    ds_read_b64_tr_b16 v[112:113], v126 offset:16384
    ds_read_b64_tr_b16 v[114:115], v126 offset:17408
    buffer_load_dwordx4 v[164:167], v2, s[36:39], s88 offen offset:2048 sc1
    v_mfma_f32_16x16x32_bf16 v[68:71], v[92:95], v[140:143], v[68:71]
    ds_read_b64_tr_b16 v[116:117], v127 offset:16384
    ds_read_b64_tr_b16 v[118:119], v127 offset:17408
    s_waitcnt lgkmcnt(8)
    v_mfma_f32_16x16x32_bf16 v[72:75], v[96:99], v[140:143], v[72:75]
    ds_read_b64_tr_b16 v[80:81], v124 offset:20480
    ds_read_b64_tr_b16 v[82:83], v124 offset:21504
    v_bitop3_b32 v121, v121, v136, v140 bitop3:0x80
    v_mfma_f32_16x16x32_bf16 v[76:79], v[100:103], v[140:143], v[76:79]
    ds_read_b64_tr_b16 v[84:85], v125 offset:20480
L_pad5:
    s_cbranch_execz L_pad9
    ds_read_b64_tr_b16 v[86:87], v125 offset:21504
    s_waitcnt vmcnt(5) lgkmcnt(8)
    v_mfma_f32_16x16x32_bf16 v[64:67], v[104:107], v[144:147], v[64:67]
    ds_read_b64_tr_b16 v[88:89], v126 offset:20480
    ds_read_b64_tr_b16 v[90:91], v126 offset:21504
    s_add_u32 s88, s60, 20480
    buffer_load_dwordx4 v[168:171], v2, s[36:39], s88 offen offset:0 sc1
    v_mfma_f32_16x16x32_bf16 v[68:71], v[108:111], v[144:147], v[68:71]
    ds_read_b64_tr_b16 v[92:93], v127 offset:20480
    ds_read_b64_tr_b16 v[94:95], v127 offset:21504
    s_waitcnt lgkmcnt(8)
    v_mfma_f32_16x16x32_bf16 v[72:75], v[112:115], v[144:147], v[72:75]
    ds_read_b64_tr_b16 v[96:97], v124 offset:24576
    ds_read_b64_tr_b16 v[98:99], v124 offset:25600
    v_mfma_f32_16x16x32_bf16 v[76:79], v[116:119], v[144:147], v[76:79]
    ds_read_b64_tr_b16 v[100:101], v125 offset:24576
    ds_read_b64_tr_b16 v[102:103], v125 offset:25600
    s_waitcnt vmcnt(5) lgkmcnt(8)
    v_mfma_f32_16x16x32_bf16 v[64:67], v[80:83], v[148:151], v[64:67]
    ds_read_b64_tr_b16 v[104:105], v126 offset:24576
    ds_read_b64_tr_b16 v[106:107], v126 offset:25600
    buffer_load_dwordx4 v[172:175], v2, s[36:39], s88 offen offset:2048 sc1
    v_mfma_f32_16x16x32_bf16 v[68:71], v[84:87], v[148:151], v[68:71]
    ds_read_b64_tr_b16 v[108:109], v127 offset:24576
    ds_read_b64_tr_b16 v[110:111], v127 offset:25600
    s_waitcnt lgkmcnt(8)
    v_mfma_f32_16x16x32_bf16 v[72:75], v[88:91], v[148:151], v[72:75]
    ds_read_b64_tr_b16 v[112:113], v124 offset:28672
    ds_read_b64_tr_b16 v[114:115], v124 offset:29696
    v_bitop3_b32 v121, v121, v144, v148 bitop3:0x80
    v_mfma_f32_16x16x32_bf16 v[76:79], v[92:95], v[148:151], v[76:79]
    ds_read_b64_tr_b16 v[116:117], v125 offset:28672
    ds_read_b64_tr_b16 v[118:119], v125 offset:29696
    s_waitcnt vmcnt(5) lgkmcnt(8)
    v_mfma_f32_16x16x32_bf16 v[64:67], v[96:99], v[152:155], v[64:67]
    ds_read_b64_tr_b16 v[80:81], v126 offset:28672
    ds_read_b64_tr_b16 v[82:83], v126 offset:29696
    s_add_u32 s88, s60, 24576
    buffer_load_dwordx4 v[176:179], v2, s[36:39], s88 offen offset:0 sc1
    v_mfma_f32_16x16x32_bf16 v[68:71], v[100:103], v[152:155], v[68:71]
    ds_read_b64_tr_b16 v[84:85], v127 offset:28672
    ds_read_b64_tr_b16 v[86:87], v127 offset:29696
    s_waitcnt lgkmcnt(8)
    v_mfma_f32_16x16x32_bf16 v[72:75], v[104:107], v[152:155], v[72:75]
    ds_read_b64_tr_b16 v[88:89], v124 offset:32768
    ds_read_b64_tr_b16 v[90:91], v124 offset:33792
    v_mfma_f32_16x16x32_bf16 v[76:79], v[108:111], v[152:155], v[76:79]
    ds_read_b64_tr_b16 v[92:93], v125 offset:32768
    ds_read_b64_tr_b16 v[94:95], v125 offset:33792
    s_waitcnt vmcnt(5) lgkmcnt(8)
    v_mfma_f32_16x16x32_bf16 v[64:67], v[112:115], v[156:159], v[64:67]
    ds_read_b64_tr_b16 v[96:97], v126 offset:32768
    ds_read_b64_tr_b16 v[98:99], v126 offset:33792
    buffer_load_dwordx4 v[180:183], v2, s[36:39], s88 offen offset:2048 sc1
    v_mfma_f32_16x16x32_bf16 v[68:71], v[116:119], v[156:159], v[68:71]
    ds_read_b64_tr_b16 v[100:101], v127 offset:32768
    ds_read_b64_tr_b16 v[102:103], v127 offset:33792
    s_waitcnt lgkmcnt(8)
    v_mfma_f32_16x16x32_bf16 v[72:75], v[80:83], v[156:159], v[72:75]
    ds_read_b64_tr_b16 v[104:105], v124 offset:36864
    ds_read_b64_tr_b16 v[106:107], v124 offset:37888
    v_bitop3_b32 v121, v121, v152, v156 bitop3:0x80
    v_mfma_f32_16x16x32_bf16 v[76:79], v[84:87], v[156:159], v[76:79]
    ds_read_b64_tr_b16 v[108:109], v125 offset:36864
    ds_read_b64_tr_b16 v[110:111], v125 offset:37888
    s_waitcnt vmcnt(5) lgkmcnt(8)
    v_mfma_f32_16x16x32_bf16 v[64:67], v[88:91], v[160:163], v[64:67]
    ds_read_b64_tr_b16 v[112:113], v126 offset:36864
    ds_read_b64_tr_b16 v[114:115], v126 offset:37888
    s_add_u32 s88, s60, 28672
    buffer_load_dwordx4 v[184:187], v2, s[36:39], s88 offen offset:0 sc1
    v_mfma_f32_16x16x32_bf16 v[68:71], v[92:95], v[160:163], v[68:71]
    ds_read_b64_tr_b16 v[116:117], v127 offset:36864
    ds_read_b64_tr_b16 v[118:119], v127 offset:37888
    s_waitcnt lgkmcnt(8)
    v_mfma_f32_16x16x32_bf16 v[72:75], v[96:99], v[160:163], v[72:75]
    ds_read_b64_tr_b16 v[80:81], v124 offset:40960
    ds_read_b64_tr_b16 v[82:83], v124 offset:41984
    v_mfma_f32_16x16x32_bf16 v[76:79], v[100:103], v[160:163], v[76:79]
    ds_read_b64_tr_b16 v[84:85], v125 offset:40960
    ds_read_b64_tr_b16 v[86:87], v125 offset:41984
    s_waitcnt vmcnt(5) lgkmcnt(8)
    v_mfma_f32_16x16x32_bf16 v[64:67], v[104:107], v[164:167], v[64:67]
    ds_read_b64_tr_b16 v[88:89], v126 offset:40960
    ds_read_b64_tr_b16 v[90:91], v126 offset:41984
    buffer_load_dwordx4 v[188:191], v2, s[36:39], s88 offen offset:2048 sc1
    v_mfma_f32_16x16x32_bf16 v[68:71], v[108:111], v[164:167], v[68:71]
    ds_read_b64_tr_b16 v[92:93], v127 offset:40960
    ds_read_b64_tr_b16 v[94:95], v127 offset:41984
    s_waitcnt lgkmcnt(8)
    v_mfma_f32_16x16x32_bf16 v[72:75], v[112:115], v[164:167], v[72:75]
    ds_read_b64_tr_b16 v[96:97], v124 offset:45056
    ds_read_b64_tr_b16 v[98:99], v124 offset:46080
    v_bitop3_b32 v121, v121, v160, v164 bitop3:0x80
    v_mfma_f32_16x16x32_bf16 v[76:79], v[116:119], v[164:167], v[76:79]
    ds_read_b64_tr_b16 v[100:101], v125 offset:45056
    ds_read_b64_tr_b16 v[102:103], v125 offset:46080
    s_waitcnt vmcnt(5) lgkmcnt(8)
    v_mfma_f32_16x16x32_bf16 v[64:67], v[80:83], v[168:171], v[64:67]
    ds_read_b64_tr_b16 v[104:105], v126 offset:45056
    ds_read_b64_tr_b16 v[106:107], v126 offset:46080
    v_mfma_f32_16x16x32_bf16 v[68:71], v[84:87], v[168:171], v[68:71]
    ds_read_b64_tr_b16 v[108:109], v127 offset:45056
    ds_read_b64_tr_b16 v[110:111], v127 offset:46080
    s_waitcnt lgkmcnt(8)
    v_mfma_f32_16x16x32_bf16 v[72:75], v[88:91], v[168:171], v[72:75]
    ds_read_b64_tr_b16 v[112:113], v124 offset:49152
    ds_read_b64_tr_b16 v[114:115], v124 offset:50176
    v_mfma_f32_16x16x32_bf16 v[76:79], v[92:95], v[168:171], v[76:79]
    ds_read_b64_tr_b16 v[116:117], v125 offset:49152
    ds_read_b64_tr_b16 v[118:119], v125 offset:50176
    s_waitcnt vmcnt(4) lgkmcnt(8)
    v_mfma_f32_16x16x32_bf16 v[64:67], v[96:99], v[172:175], v[64:67]
    ds_read_b64_tr_b16 v[80:81], v126 offset:49152
    ds_read_b64_tr_b16 v[82:83], v126 offset:50176
    v_mfma_f32_16x16x32_bf16 v[68:71], v[100:103], v[172:175], v[68:71]
    ds_read_b64_tr_b16 v[84:85], v127 offset:49152
    ds_read_b64_tr_b16 v[86:87], v127 offset:50176
    s_waitcnt lgkmcnt(8)
    v_mfma_f32_16x16x32_bf16 v[72:75], v[104:107], v[172:175], v[72:75]
    ds_read_b64_tr_b16 v[88:89], v124 offset:53248
    ds_read_b64_tr_b16 v[90:91], v124 offset:54272
    v_bitop3_b32 v121, v121, v168, v172 bitop3:0x80
    v_mfma_f32_16x16x32_bf16 v[76:79], v[108:111], v[172:175], v[76:79]
    ds_read_b64_tr_b16 v[92:93], v125 offset:53248
    ds_read_b64_tr_b16 v[94:95], v125 offset:54272
    s_waitcnt vmcnt(3) lgkmcnt(8)
    v_mfma_f32_16x16x32_bf16 v[64:67], v[112:115], v[176:179], v[64:67]
    ds_read_b64_tr_b16 v[96:97], v126 offset:53248
    ds_read_b64_tr_b16 v[98:99], v126 offset:54272
    v_mfma_f32_16x16x32_bf16 v[68:71], v[116:119], v[176:179], v[68:71]
    ds_read_b64_tr_b16 v[100:101], v127 offset:53248
    ds_read_b64_tr_b16 v[102:103], v127 offset:54272
    s_waitcnt lgkmcnt(8)
    v_mfma_f32_16x16x32_bf16 v[72:75], v[80:83], v[176:179], v[72:75]
    ds_read_b64_tr_b16 v[104:105], v124 offset:57344
    ds_read_b64_tr_b16 v[106:107], v124 offset:58368
    v_mov_b32 v123, 3
    v_mfma_f32_16x16x32_bf16 v[76:79], v[84:87], v[176:179], v[76:79]
    ds_read_b64_tr_b16 v[108:109], v125 offset:57344
    ds_read_b64_tr_b16 v[110:111], v125 offset:58368
    s_waitcnt vmcnt(2) lgkmcnt(8)
    v_mfma_f32_16x16x32_bf16 v[64:67], v[88:91], v[180:183], v[64:67]
    ds_read_b64_tr_b16 v[112:113], v126 offset:57344
    ds_read_b64_tr_b16 v[114:115], v126 offset:58368
    v_mfma_f32_16x16x32_bf16 v[68:71], v[92:95], v[180:183], v[68:71]
    ds_read_b64_tr_b16 v[116:117], v127 offset:57344
    ds_read_b64_tr_b16 v[118:119], v127 offset:58368
    s_waitcnt lgkmcnt(8)
    v_mfma_f32_16x16x32_bf16 v[72:75], v[96:99], v[180:183], v[72:75]
    ds_read_b64_tr_b16 v[80:81], v124 offset:61440
    ds_read_b64_tr_b16 v[82:83], v124 offset:62464
    v_bitop3_b32 v121, v121, v176, v180 bitop3:0x80
    v_mfma_f32_16x16x32_bf16 v[76:79], v[100:103], v[180:183], v[76:79]
    ds_read_b64_tr_b16 v[84:85], v125 offset:61440
    ds_read_b64_tr_b16 v[86:87], v125 offset:62464
    s_waitcnt vmcnt(1) lgkmcnt(8)
    v_mfma_f32_16x16x32_bf16 v[64:67], v[104:107], v[184:187], v[64:67]
    ds_read_b64_tr_b16 v[88:89], v126 offset:61440
    ds_read_b64_tr_b16 v[90:91], v126 offset:62464
    v_mfma_f32_16x16x32_bf16 v[68:71], v[108:111], v[184:187], v[68:71]
    ds_read_b64_tr_b16 v[92:93], v127 offset:61440
    ds_read_b64_tr_b16 v[94:95], v127 offset:62464
    s_waitcnt lgkmcnt(8)
    v_mfma_f32_16x16x32_bf16 v[72:75], v[112:115], v[184:187], v[72:75]
    v_mfma_f32_16x16x32_bf16 v[76:79], v[116:119], v[184:187], v[76:79]
    s_waitcnt vmcnt(0) lgkmcnt(4)
    v_mfma_f32_16x16x32_bf16 v[64:67], v[80:83], v[188:191], v[64:67]
    v_mfma_f32_16x16x32_bf16 v[68:71], v[84:87], v[188:191], v[68:71]
    s_waitcnt lgkmcnt(0)
    v_mfma_f32_16x16x32_bf16 v[72:75], v[88:91], v[188:191], v[72:75]
    v_bitop3_b32 v121, v121, v184, v188 bitop3:0x80
    v_and_b32 v120, 1, v121
    v_cmp_ne_u32 vcc, 1, v120
    s_cbranch_vccnz L_redo_o1
    v_mfma_f32_16x16x32_bf16 v[76:79], v[92:95], v[188:191], v[76:79]
    s_add_u32 s56, s56, s52
    s_add_u32 s57, s57, s52
    s_add_u32 s58, s58, s52
    s_add_u32 s59, s59, s52
    s_add_u32 s60, s60, s52
    s_add_u32 s61, s61, s52
    v_cvt_pk_bf16_f32 v4, v64, v65
    v_cvt_pk_bf16_f32 v5, v66, v67
    v_or_b32 v4, 1, v4
    v_cvt_pk_bf16_f32 v6, v68, v69
    v_cvt_pk_bf16_f32 v7, v70, v71
    s_mov_b64 exec, 1
    buffer_store_dword v123, off, s[36:39], s82
    s_mov_b64 exec, -1
    s_cmp_lg_u32 s50, 0
    s_cbranch_scc1 L_px10_safe
    buffer_store_dwordx4 v[4:7], v45, s[36:39], s57 offen offset:0
L_px10_join:
    v_cvt_pk_bf16_f32 v8, v72, v73
    v_cvt_pk_bf16_f32 v9, v74, v75
    v_or_b32 v8, 1, v8
    v_cvt_pk_bf16_f32 v10, v76, v77
    v_cvt_pk_bf16_f32 v11, v78, v79
    s_cmp_lg_u32 s50, 0
    s_cbranch_scc1 L_px11_safe
    buffer_store_dwordx4 v[8:11], v45, s[36:39], s57 offen offset:2048
L_px11_join:
    s_lshl_b32 s90, s78, 12
    s_add_u32 s90, s90, s56
    v_dot2_f32_bf16 v120, v4, s74, 0
    v_dot2_f32_bf16 v121, v4, v4, 0
    v_dot2_f32_bf16 v120, v5, s74, v120
    v_dot2_f32_bf16 v121, v5, v5, v121
    v_dot2_f32_bf16 v120, v6, s74, v120
    v_dot2_f32_bf16 v121, v6, v6, v121
    v_dot2_f32_bf16 v120, v7, s74, v120
    v_dot2_f32_bf16 v121, v7, v7, v121
    v_dot2_f32_bf16 v120, v8, s74, v120
    v_dot2_f32_bf16 v121, v8, v8, v121
    v_dot2_f32_bf16 v120, v9, s74, v120
    v_dot2_f32_bf16 v121, v9, v9, v121
    v_dot2_f32_bf16 v120, v10, s74, v120
    v_dot2_f32_bf16 v121, v10, v10, v121
    v_dot2_f32_bf16 v120, v11, s74, v120
    v_dot2_f32_bf16 v121, v11, v11, v121
    s_nop 2
    v_permlane32_swap_b32 v120, v121
    v_add_f32 v120, v120, v121
    v_mov_b32 v121, v120
    s_nop 1
    v_permlane16_swap_b32 v120, v121
    v_add_f32 v120, v120, v121
    v_or_b32 v120, 1, v120
    s_cmp_lg_u32 s50, 0
    s_cbranch_scc1 L_px1s_safe
    buffer_store_dword v120, v61, s[36:39], s59 offen
L_px1s_join:
    ds_write_b128 v1, a[8:11] offset:8192
    ds_write_b128 v1, a[12:15] offset:12288
    ds_write_b128 v1, a[16:19] offset:16384
    ds_read_b64_tr_b16 a[32:33], v42 offset:32768
    ds_read_b64_tr_b16 a[34:35], v42 offset:33792
    ds_read_b64_tr_b16 a[36:37], v42 offset:40960
    ds_read_b64_tr_b16 a[38:39], v42 offset:41984
    ds_read_b64_tr_b16 a[40:41], v42 offset:49152
    ds_read_b64_tr_b16 a[42:43], v42 offset:50176
    ds_read_b64_tr_b16 a[44:45], v42 offset:57344
    ds_read_b64_tr_b16 a[46:47], v42 offset:58368
    buffer_load_dword v125, v62, s[36:39], s64 offen sc1
    ds_write_b128 v1, a[20:23] offset:20480
    ds_write_b128 v1, a[24:27] offset:24576
    ds_write_b128 v1, a[28:31] offset:28672
    v_xor_b32 v58, 64, v42
    ds_read_b64_tr_b16 a[48:49], v58 offset:32768
    ds_read_b64_tr_b16 a[50:51], v58 offset:33792
    ds_read_b64_tr_b16 a[52:53], v58 offset:40960
    ds_read_b64_tr_b16 a[54:55], v58 offset:41984
    ds_read_b64_tr_b16 a[56:57], v58 offset:49152
    ds_read_b64_tr_b16 a[58:59], v58 offset:50176
    ds_read_b64_tr_b16 a[60:61], v58 offset:57344
    ds_read_b64_tr_b16 a[62:63], v58 offset:58368
    s_waitcnt lgkmcnt(8)
    s_waitcnt lgkmcnt(0)
    s_barrier
    ds_read_b64_tr_b16 a[0:1], v42 offset:0
    ds_read_b64_tr_b16 a[2:3], v42 offset:1024
    ds_read_b64_tr_b16 a[4:5], v42 offset:8192
    ds_read_b64_tr_b16 a[6:7], v42 offset:9216
    ds_read_b64_tr_b16 a[8:9], v42 offset:16384
    ds_read_b64_tr_b16 a[10:11], v42 offset:17408
    ds_read_b64_tr_b16 a[12:13], v42 offset:24576
    ds_read_b64_tr_b16 a[14:15], v42 offset:25600
    ds_read_b64_tr_b16 a[16:17], v58 offset:0
    ds_read_b64_tr_b16 a[18:19], v58 offset:1024
    ds_read_b64_tr_b16 a[20:21], v58 offset:8192
    ds_read_b64_tr_b16 a[22:23], v58 offset:9216
    ds_read_b64_tr_b16 a[24:25], v58 offset:16384
    ds_read_b64_tr_b16 a[26:27], v58 offset:17408
    ds_read_b64_tr_b16 a[28:29], v58 offset:24576
    ds_read_b64_tr_b16 a[30:31], v58 offset:25600
    ds_read_b128 v[96:99], v44 offset:0
    ds_read_b128 v[100:103], v44 offset:32768
    ds_read_b128 v[104:107], v44 offset:1024
    ds_read_b128 v[108:111], v44 offset:33792
    buffer_load_dword v252, v62, s[36:39], s64 offen sc1
    s_waitcnt vmcnt(1)
    v_cmp_gt_u32 vcc, 3, v125
    s_cbranch_vccz L_ok_x2
    buffer_load_dword v125, v62, s[36:39], s64 offen sc1
L_again_x2:
    s_waitcnt vmcnt(1)
    v_cmp_gt_u32 vcc, 3, v252
    s_cbranch_vccz L_ok_x2
    buffer_load_dword v252, v62, s[36:39], s64 offen sc1
    s_waitcnt vmcnt(1)
    v_cmp_gt_u32 vcc, 3, v125
    s_cbranch_vccz L_ok_x2
    buffer_load_dword v125, v62, s[36:39], s64 offen sc1
    s_sub_u32 s51, s51, 1
    s_cbranch_scc0 L_again_x2
    s_endpgm
L_ok_x2:
    s_xor_b32 s88, s90, 0
    buffer_load_dwordx4 v[128:131], v2, s[36:39], s88 offen offset:0 sc1
    buffer_load_dwordx4 v[132:135], v2, s[36:39], s88 offen offset:1024 sc1
    buffer_load_dwordx4 v[136:139], v2, s[36:39], s88 offen offset:2048 sc1
    buffer_load_dwordx4 v[140:143], v2, s[36:39], s88 offen offset:3072 sc1
    s_xor_b32 s88, s90, 4096
    buffer_load_dwordx4 v[144:147], v2, s[36:39], s88 offen offset:0 sc1
    buffer_load_dwordx4 v[148:151], v2, s[36:39], s88 offen offset:1024 sc1
    buffer_load_dwordx4 v[152:155], v2, s[36:39], s88 offen offset:2048 sc1
    s_waitcnt vmcnt(6) lgkmcnt(2)
    v_mfma_f32_32x32x16_bf16 v[64:79], v[96:99], v[128:131], 0
    buffer_load_dwordx4 v[156:159], v2, s[36:39], s88 offen offset:3072 sc1
    ds_read_b128 v[112:115], v44 offset:2048
    v_mfma_f32_32x32x16_bf16 v[80:95], v[100:103], v[128:131], 0
    ds_read_b128 v[116:119], v44 offset:34816
    s_lshl_b32 s92, s44, 10
    s_add_u32 s92, s92, 32768
    v_add_u32 v40, s92, v2
    ds_write_b128 v40, a[64:67] offset:0
    s_waitcnt vmcnt(6) lgkmcnt(3)
    v_mfma_f32_32x32x16_bf16 v[64:79], v[104:107], v[132:135], v[64:79]
    s_xor_b32 s88, s90, 8192
    buffer_load_dwordx4 v[160:163], v2, s[36:39], s88 offen offset:0 sc1
    ds_read_b128 v[96:99], v44 offset:3072
    v_mfma_f32_32x32x16_bf16 v[80:95], v[108:111], v[132:135], v[80:95]
    ds_read_b128 v[100:103], v44 offset:35840
    v_and_b32 v124, v128, v132
    s_waitcnt vmcnt(6) lgkmcnt(3)
    v_mfma_f32_32x32x16_bf16 v[64:79], v[112:115], v[136:139], v[64:79]
    buffer_load_dwordx4 v[164:167], v2, s[36:39], s88 offen offset:1024 sc1
    ds_read_b128 v[104:107], v44 offset:4096
    v_mfma_f32_32x32x16_bf16 v[80:95], v[116:119], v[136:139], v[80:95]
    ds_read_b128 v[108:111], v44 offset:36864
    s_lshl_b32 s92, s44, 11
    s_add_u32 s92, s92, 0
    v_add_u32 v1, s92, v2
    ds_write_b128 v1, a[96:99] offset:0
    s_waitcnt vmcnt(6) lgkmcnt(3)
    v_mfma_f32_32x32x16_bf16 v[64:79], v[96:99], v[140:143], v[64:79]
    buffer_load_dwordx4 v[168:171], v2, s[36:39], s88 offen offset:2048 sc1
    ds_read_b128 v[112:115], v44 offset:5120
    v_mfma_f32_32x32x16_bf16 v[80:95], v[100:103], v[140:143], v[80:95]
    ds_read_b128 v[116:119], v44 offset:37888
    v_bitop3_b32 v124, v124, v136, v140 bitop3:0x80
    s_waitcnt vmcnt(6) lgkmcnt(3)
    v_mfma_f32_32x32x16_bf16 v[64:79], v[104:107], v[144:147], v[64:79]
    buffer_load_dwordx4 v[172:175], v2, s[36:39], s88 offen offset:3072 sc1
    ds_read_b128 v[96:99], v44 offset:6144
    v_mfma_f32_32x32x16_bf16 v[80:95], v[108:111], v[144:147], v[80:95]
    buffer_load_dwordx4 v[248:251], v2, s[36:39], s58 offen offset:0 sc1
    ds_read_b128 v[100:103], v44 offset:38912
    ds_write_b128 v40, a[68:71] offset:4096
    s_waitcnt vmcnt(7) lgkmcnt(3)
    v_mfma_f32_32x32x16_bf16 v[64:79], v[112:115], v[148:151], v[64:79]
    s_xor_b32 s88, s90, 12288
    buffer_load_dwordx4 v[176:179], v2, s[36:39], s88 offen offset:0 sc1
    ds_read_b128 v[104:107], v44 offset:7168
    v_mfma_f32_32x32x16_bf16 v[80:95], v[116:119], v[148:151], v[80:95]
    buffer_load_dwordx4 v[252:255], v2, s[36:39], s58 offen offset:1024 sc1
    ds_read_b128 v[108:111], v44 offset:39936
    v_bitop3_b32 v124, v124, v144, v148 bitop3:0x80
    s_waitcnt vmcnt(8) lgkmcnt(3)
    v_mfma_f32_32x32x16_bf16 v[64:79], v[96:99], v[152:155], v[64:79]
    buffer_load_dwordx4 v[180:183], v2, s[36:39], s88 offen offset:1024 sc1
    ds_read_b128 v[112:115], v44 offset:8192
    v_mfma_f32_32x32x16_bf16 v[80:95], v[100:103], v[152:155], v[80:95]
    ds_read_b128 v[116:119], v44 offset:40960
    ds_write_b128 v1, a[100:103] offset:8192
    s_waitcnt vmcnt(8) lgkmcnt(3)
    v_mfma_f32_32x32x16_bf16 v[64:79], v[104:107], v[156:159], v[64:79]
    buffer_load_dwordx4 v[184:187], v2, s[36:39], s88 offen offset:2048 sc1
    ds_read_b128 v[96:99], v44 offset:9216
    v_mfma_f32_32x32x16_bf16 v[80:95], v[108:111], v[156:159], v[80:95]
    ds_read_b128 v[100:103], v44 offset:41984
    v_bitop3_b32 v124, v124, v152, v156 bitop3:0x80
    s_waitcnt vmcnt(8) lgkmcnt(3)
    v_mfma_f32_32x32x16_bf16 v[64:79], v[112:115], v[160:163], v[64:79]
    buffer_load_dwordx4 v[188:191], v2, s[36:39], s88 offen offset:3072 sc1
    ds_read_b128 v[104:107], v44 offset:10240
    v_mfma_f32_32x32x16_bf16 v[80:95], v[116:119], v[160:163], v[80:95]
    ds_read_b128 v[108:111], v44 offset:43008
    ds_write_b128 v40, a[72:75] offset:8192
    s_waitcnt vmcnt(8) lgkmcnt(3)
    v_mfma_f32_32x32x16_bf16 v[64:79], v[96:99], v[164:167], v[64:79]
    s_xor_b32 s88, s90, 16384
    buffer_load_dwordx4 v[192:195], v2, s[36:39], s88 offen offset:0 sc1
    ds_read_b128 v[112:115], v44 offset:11264
    v_mfma_f32_32x32x16_bf16 v[80:95], v[100:103], v[164:167], v[80:95]
    ds_read_b128 v[116:119], v44 offset:44032
    v_bitop3_b32 v124, v124, v160, v164 bitop3:0x80
    s_waitcnt vmcnt(8) lgkmcnt(3)
    v_mfma_f32_32x32x16_bf16 v[64:79], v[104:107], v[168:171], v[64:79]
    buffer_load_dwordx4 v[196:199], v2, s[36:39], s88 offen offset:1024 sc1
    ds_read_b128 v[96:99], v44 offset:12288
    v_mfma_f32_32x32x16_bf16 v[80:95], v[108:111], v[168:171], v[80:95]
    ds_read_b128 v[100:103], v44 offset:45056
    ds_write_b128 v1, a[104:107] offset:16384
    s_waitcnt vmcnt(8) lgkmcnt(3)
    v_mfma_f32_32x32x16_bf16 v[64:79], v[112:115], v[172:175], v[64:79]
    buffer_load_dwordx4 v[200:203], v2, s[36:39], s88 offen offset:2048 sc1
    ds_read_b128 v[104:107], v44 offset:13312
    v_mfma_f32_32x32x16_bf16 v[80:95], v[116:119], v[172:175], v[80:95]
    ds_read_b128 v[108:111], v44 offset:46080
    v_bitop3_b32 v124, v124, v168, v172 bitop3:0x80
    s_waitcnt vmcnt(7) lgkmcnt(3)
    v_mfma_f32_32x32x16_bf16 v[64:79], v[96:99], v[176:179], v[64:79]
    buffer_load_dwordx4 v[204:207], v2, s[36:39], s88 offen offset:3072 sc1
    ds_read_b128 v[112:115], v44 offset:14336
    v_mfma_f32_32x32x16_bf16 v[80:95], v[100:103], v[176:179], v[80:95]
    ds_read_b128 v[116:119], v44 offset:47104
    ds_write_b128 v40, a[76:79] offset:12288
    s_waitcnt vmcnt(6) lgkmcnt(3)
    v_mfma_f32_32x32x16_bf16 v[64:79], v[104:107], v[180:183], v[64:79]
    s_xor_b32 s88, s90, 20480
    buffer_load_dwordx4 v[208:211], v2, s[36:39], s88 offen offset:0 sc1
    ds_read_b128 v[96:99], v44 offset:15360
    v_bitop3_b32 v124, v124, v248, v249 bitop3:0x80
    v_bitop3_b32 v124, v124, v250, v251 bitop3:0x80
    v_mfma_f32_32x32x16_bf16 v[80:95], v[108:111], v[180:183], v[80:95]
    ds_read_b128 v[100:103], v44 offset:48128
    v_bitop3_b32 v124, v124, v176, v180 bitop3:0x80
    v_add_f32 v248, v248, v250
    v_add_f32 v249, v249, v251
    s_waitcnt vmcnt(6) lgkmcnt(3)
    v_mfma_f32_32x32x16_bf16 v[64:79], v[112:115], v[184:187], v[64:79]
    buffer_load_dwordx4 v[212:215], v2, s[36:39], s88 offen offset:1024 sc1
    ds_read_b128 v[104:107], v44 offset:16384
    v_bitop3_b32 v124, v124, v252, v253 bitop3:0x80
    v_bitop3_b32 v124, v124, v254, v255 bitop3:0x80
    v_mfma_f32_32x32x16_bf16 v[80:95], v[116:119], v[184:187], v[80:95]
    ds_read_b128 v[108:111], v44 offset:49152
    ds_write_b128 v1, a[108:111] offset:24576
    v_add_f32 v252, v252, v254
    v_add_f32 v253, v253, v255
    s_waitcnt vmcnt(6) lgkmcnt(3)
    v_mfma_f32_32x32x16_bf16 v[64:79], v[96:99], v[188:191], v[64:79]
    buffer_load_dwordx4 v[216:219], v2, s[36:39], s88 offen offset:2048 sc1
    ds_read_b128 v[112:115], v44 offset:17408
    v_add_f32 v120, v248, v252
    v_add_f32 v121, v249, v253
    v_mfma_f32_32x32x16_bf16 v[80:95], v[100:103], v[188:191], v[80:95]
    ds_read_b128 v[116:119], v44 offset:50176
    v_bitop3_b32 v124, v124, v184, v188 bitop3:0x80
    v_mov_b32 v122, v120
    v_mov_b32 v123, v121
    s_waitcnt vmcnt(6) lgkmcnt(3)
    v_mfma_f32_32x32x16_bf16 v[64:79], v[104:107], v[192:195], v[64:79]
    buffer_load_dwordx4 v[220:223], v2, s[36:39], s88 offen offset:3072 sc1
    ds_read_b128 v[96:99], v44 offset:18432
    v_permlane32_swap_b32 v120, v122
    v_permlane32_swap_b32 v121, v123
    v_mfma_f32_32x32x16_bf16 v[80:95], v[108:111], v[192:195], v[80:95]
    ds_read_b128 v[100:103], v44 offset:51200
    ds_write_b128 v40, a[80:83] offset:16384
    v_add_f32 v120, v120, v122
    v_add_f32 v121, v121, v123
    s_waitcnt vmcnt(6) lgkmcnt(3)
    v_mfma_f32_32x32x16_bf16 v[64:79], v[112:115], v[196:199], v[64:79]
    s_xor_b32 s88, s90, 24576
    buffer_load_dwordx4 v[224:227], v2, s[36:39], s88 offen offset:0 sc1
    ds_read_b128 v[104:107], v44 offset:19456
    v_mul_f32 v120, 0xbb000000, v120
    v_mul_f32 v121, 0x3b000000, v121
    v_mfma_f32_32x32x16_bf16 v[80:95], v[116:119], v[196:199], v[80:95]
    ds_read_b128 v[108:111], v44 offset:52224
    v_bitop3_b32 v124, v124, v192, v196 bitop3:0x80
    v_fma_f32 v121, -v120, v120, v121
    v_max_f32 v121, 0, v121
    s_waitcnt vmcnt(6) lgkmcnt(3)
    v_mfma_f32_32x32x16_bf16 v[64:79], v[96:99], v[200:203], v[64:79]
    buffer_load_dwordx4 v[228:231], v2, s[36:39], s88 offen offset:1024 sc1
    ds_read_b128 v[112:115], v44 offset:20480
    v_add_f32 v121, 0x3727c5ac, v121
    v_rsq_f32 v38, v121
    v_mfma_f32_32x32x16_bf16 v[80:95], v[100:103], v[200:203], v[80:95]
    ds_read_b128 v[116:119], v44 offset:53248
    ds_write_b128 v1, a[112:115] offset:1024
    v_and_b32 v122, s76, v120
    v_sub_f32 v122, v120, v122
    s_waitcnt vmcnt(6) lgkmcnt(3)
    v_mfma_f32_32x32x16_bf16 v[64:79], v[104:107], v[204:207], v[64:79]
    buffer_load_dwordx4 v[232:235], v2, s[36:39], s88 offen offset:2048 sc1
    ds_read_b128 v[96:99], v44 offset:21504
    s_mov_b64 vcc, 0xffffffff
    v_mul_f32 v39, s84, v38
    v_mfma_f32_32x32x16_bf16 v[80:95], v[108:111], v[204:207], v[80:95]
    ds_read_b128 v[100:103], v44 offset:54272
    v_bitop3_b32 v124, v124, v200, v204 bitop3:0x80
    v_cndmask_b32 v120, v122, v120, vcc
    v_perm_b32 v36, v120, v120, s75
    s_waitcnt vmcnt(6) lgkmcnt(3)
    v_mfma_f32_32x32x16_bf16 v[64:79], v[112:115], v[208:211], v[64:79]
    buffer_load_dwordx4 v[236:239], v2, s[36:39], s88 offen offset:3072 sc1
    ds_read_b128 v[104:107], v44 offset:22528
    v_lshrrev_b32 v37, 16, v120
    v_mfma_f32_32x32x16_bf16 v[80:95], v[116:119], v[208:211], v[80:95]
    ds_read_b128 v[108:111], v44 offset:55296
    ds_write_b128 v40, a[84:87] offset:20480
    v_mfma_f32_32x32x8_bf16 v[64:79], v[26:27], v[36:37], v[64:79]
    v_mfma_f32_32x32x8_bf16 v[80:95], v[28:29], v[36:37], v[80:95]
    s_waitcnt vmcnt(6) lgkmcnt(3)
    v_mfma_f32_32x32x16_bf16 v[64:79], v[96:99], v[212:215], v[64:79]
    s_xor_b32 s88, s90, 28672
    buffer_load_dwordx4 v[240:243], v2, s[36:39], s88 offen offset:0 sc1
    ds_read_b128 v[112:115], v44 offset:23552
    v_mfma_f32_32x32x16_bf16 v[80:95], v[100:103], v[212:215], v[80:95]
    ds_read_b128 v[116:119], v44 offset:56320
    v_bitop3_b32 v124, v124, v208, v212 bitop3:0x80
    s_waitcnt vmcnt(6) lgkmcnt(3)
    v_mfma_f32_32x32x16_bf16 v[64:79], v[104:107], v[216:219], v[64:79]
    buffer_load_dwordx4 v[244:247], v2, s[36:39], s88 offen offset:1024 sc1
    ds_read_b128 v[96:99], v44 offset:24576
    v_mfma_f32_32x32x16_bf16 v[80:95], v[108:111], v[216:219], v[80:95]
    ds_read_b128 v[100:103], v44 offset:57344
    ds_write_b128 v1, a[116:119] offset:9216
    s_waitcnt vmcnt(6) lgkmcnt(3)
    v_mfma_f32_32x32x16_bf16 v[64:79], v[112:115], v[220:223], v[64:79]
    buffer_load_dwordx4 v[248:251], v2, s[36:39], s88 offen offset:2048 sc1
    ds_read_b128 v[104:107], v44 offset:25600
    v_mfma_f32_32x32x16_bf16 v[80:95], v[116:119], v[220:223], v[80:95]
    ds_read_b128 v[108:111], v44 offset:58368
    v_bitop3_b32 v124, v124, v216, v220 bitop3:0x80
    s_waitcnt vmcnt(6) lgkmcnt(3)
    v_mfma_f32_32x32x16_bf16 v[64:79], v[96:99], v[224:227], v[64:79]
    buffer_load_dwordx4 v[252:255], v2, s[36:39], s88 offen offset:3072 sc1
    ds_read_b128 v[112:115], v44 offset:26624
    v_mfma_f32_32x32x16_bf16 v[80:95], v[100:103], v[224:227], v[80:95]
    ds_read_b128 v[116:119], v44 offset:59392
    ds_write_b128 v40, a[88:91] offset:24576
    s_waitcnt vmcnt(6) lgkmcnt(3)
    v_mfma_f32_32x32x16_bf16 v[64:79], v[104:107], v[228:231], v[64:79]
    ds_read_b128 v[96:99], v44 offset:27648
    v_mfma_f32_32x32x16_bf16 v[80:95], v[108:111], v[228:231], v[80:95]
    ds_read_b128 v[100:103], v44 offset:60416
    v_bitop3_b32 v124, v124, v224, v228 bitop3:0x80
    s_waitcnt vmcnt(5) lgkmcnt(3)
    v_mfma_f32_32x32x16_bf16 v[64:79], v[112:115], v[232:235], v[64:79]
    ds_read_b128 v[104:107], v44 offset:28672
    v_mfma_f32_32x32x16_bf16 v[80:95], v[116:119], v[232:235], v[80:95]
    ds_read_b128 v[108:111], v44 offset:61440
    ds_write_b128 v1, a[120:123] offset:17408
    s_waitcnt vmcnt(4) lgkmcnt(3)
    v_mfma_f32_32x32x16_bf16 v[64:79], v[96:99], v[236:239], v[64:79]
    ds_read_b128 v[112:115], v44 offset:29696
    v_mfma_f32_32x32x16_bf16 v[80:95], v[100:103], v[236:239], v[80:95]
    ds_read_b128 v[116:119], v44 offset:62464
    v_bitop3_b32 v124, v124, v232, v236 bitop3:0x80
    s_waitcnt vmcnt(3) lgkmcnt(3)
    v_mfma_f32_32x32x16_bf16 v[64:79], v[104:107], v[240:243], v[64:79]
    ds_read_b128 v[96:99], v44 offset:30720
    v_mfma_f32_32x32x16_bf16 v[80:95], v[108:111], v[240:243], v[80:95]
    ds_read_b128 v[100:103], v44 offset:63488
    ds_write_b128 v40, a[92:95] offset:28672
    s_waitcnt vmcnt(2) lgkmcnt(3)
    v_mfma_f32_32x32x16_bf16 v[64:79], v[112:115], v[244:247], v[64:79]
    ds_read_b128 v[104:107], v44 offset:31744
    v_mfma_f32_32x32x16_bf16 v[80:95], v[116:119], v[244:247], v[80:95]
    ds_read_b128 v[108:111], v44 offset:64512
    v_bitop3_b32 v124, v124, v240, v244 bitop3:0x80
    s_waitcnt vmcnt(1) lgkmcnt(3)
    v_mfma_f32_32x32x16_bf16 v[64:79], v[96:99], v[248:251], v[64:79]
    v_mfma_f32_32x32x16_bf16 v[80:95], v[100:103], v[248:251], v[80:95]
    ds_write_b128 v1, a[124:127] offset:25600
    s_waitcnt vmcnt(0) lgkmcnt(1)
    v_mfma_f32_32x32x16_bf16 v[64:79], v[104:107], v[252:255], v[64:79]
    v_mfma_f32_32x32x16_bf16 v[80:95], v[108:111], v[252:255], v[80:95]
    v_bitop3_b32 v124, v124, v248, v252 bitop3:0x80
    v_and_b32 v124, 1, v124
    v_cmp_ne_u32 vcc, 1, v124
    s_cbranch_vccnz L_redo_x2
    v_add_u32 v44, 32768, v2
    s_add_u32 s88, s68, 1048576
    s_add_u32 s89, s71, 131072
    s_nop 3
    v_pk_mul_f32 v[96:97], v[64:65], v[38:39] op_sel:[0,1] op_sel_hi:[1,1]
    v_pk_mul_f32 v[98:99], v[66:67], v[38:39] op_sel:[0,1] op_sel_hi:[1,1]
    v_pk_mul_f32 v[100:101], v[68:69], v[38:39] op_sel:[0,1] op_sel_hi:[1,1]
    v_pk_mul_f32 v[102:103], v[70:71], v[38:39] op_sel:[0,1] op_sel_hi:[1,1]
    v_exp_f32_e64 v96, v96 clamp
    v_exp_f32_e64 v97, v97 clamp
    v_exp_f32_e64 v98, v98 clamp
    v_exp_f32_e64 v99, v99 clamp
    v_exp_f32_e64 v100, v100 clamp
    v_exp_f32_e64 v101, v101 clamp
    v_exp_f32_e64 v102, v102 clamp
L_pad6:
    s_cbranch_execz L_warm_done
    v_exp_f32_e64 v103, v103 clamp
    v_pk_fma_f32 v[64:65], v[64:65], v[38:39], 1.0 op_sel_hi:[1,0,0]
    v_pk_fma_f32 v[66:67], v[66:67], v[38:39], 1.0 op_sel_hi:[1,0,0]
    v_pk_fma_f32 v[68:69], v[68:69], v[38:39], 1.0 op_sel_hi:[1,0,0]
    v_pk_fma_f32 v[70:71], v[70:71], v[38:39], 1.0 op_sel_hi:[1,0,0]
    v_max_f32 v64, v64, v96
    v_max_f32 v65, v65, v97
    v_max_f32 v66, v66, v98
    v_max_f32 v67, v67, v99
    v_max_f32 v68, v68, v100
    v_max_f32 v69, v69, v101
    v_max_f32 v70, v70, v102
    v_max_f32 v71, v71, v103
    v_pk_add_f32 v[64:65], v[64:65], s[86:87]
    v_pk_add_f32 v[66:67], v[66:67], s[86:87]
    v_pk_add_f32 v[68:69], v[68:69], s[86:87]
    v_pk_add_f32 v[70:71], v[70:71], s[86:87]
    v_cvt_pk_bf16_f32 v120, v64, v65
    v_cvt_pk_bf16_f32 v121, v66, v67
    v_cvt_pk_bf16_f32 v122, v68, v69
    v_cvt_pk_bf16_f32 v123, v70, v71
    ds_write_b128 v50, v[120:123] offset:0
    v_pk_mul_f32 v[104:105], v[72:73], v[38:39] op_sel:[0,1] op_sel_hi:[1,1]
    v_pk_mul_f32 v[106:107], v[74:75], v[38:39] op_sel:[0,1] op_sel_hi:[1,1]
    v_pk_mul_f32 v[108:109], v[76:77], v[38:39] op_sel:[0,1] op_sel_hi:[1,1]
    v_pk_mul_f32 v[110:111], v[78:79], v[38:39] op_sel:[0,1] op_sel_hi:[1,1]
    v_exp_f32_e64 v104, v104 clamp
    v_exp_f32_e64 v105, v105 clamp
    v_exp_f32_e64 v106, v106 clamp
    v_exp_f32_e64 v107, v107 clamp
    v_exp_f32_e64 v108, v108 clamp
    v_exp_f32_e64 v109, v109 clamp
    v_exp_f32_e64 v110, v110 clamp
    v_exp_f32_e64 v111, v111 clamp
    v_pk_fma_f32 v[72:73], v[72:73], v[38:39], 1.0 op_sel_hi:[1,0,0]
    v_pk_fma_f32 v[74:75], v[74:75], v[38:39], 1.0 op_sel_hi:[1,0,0]
    v_pk_fma_f32 v[76:77], v[76:77], v[38:39], 1.0 op_sel_hi:[1,0,0]
    v_pk_fma_f32 v[78:79], v[78:79], v[38:39], 1.0 op_sel_hi:[1,0,0]
    v_max_f32 v72, v72, v104
    v_max_f32 v73, v73, v105
    v_max_f32 v74, v74, v106
    v_max_f32 v75, v75, v107
    v_max_f32 v76, v76, v108
    v_max_f32 v77, v77, v109
    v_max_f32 v78, v78, v110
    v_max_f32 v79, v79, v111
    v_pk_add_f32 v[72:73], v[72:73], s[86:87]
    v_pk_add_f32 v[74:75], v[74:75], s[86:87]
    v_pk_add_f32 v[76:77], v[76:77], s[86:87]
    v_pk_add_f32 v[78:79], v[78:79], s[86:87]
    v_cvt_pk_bf16_f32 v124, v72, v73
    v_cvt_pk_bf16_f32 v125, v74, v75
    v_cvt_pk_bf16_f32 v126, v76, v77
    v_cvt_pk_bf16_f32 v127, v78, v79
    ds_write_b128 v50, v[124:127] offset:4352
    v_pk_mul_f32 v[80:81], v[80:81], v[38:39] op_sel_hi:[1,0]
    v_pk_mul_f32 v[82:83], v[82:83], v[38:39] op_sel_hi:[1,0]
    v_pk_mul_f32 v[84:85], v[84:85], v[38:39] op_sel_hi:[1,0]
    v_pk_mul_f32 v[86:87], v[86:87], v[38:39] op_sel_hi:[1,0]
    v_cvt_pk_bf16_f32 v80, v80, v81
    v_cvt_pk_bf16_f32 v81, v82, v83
    v_cvt_pk_bf16_f32 v82, v84, v85
    v_cvt_pk_bf16_f32 v83, v86, v87
    v_pk_mul_f32 v[88:89], v[88:89], v[38:39] op_sel_hi:[1,0]
    v_pk_mul_f32 v[90:91], v[90:91], v[38:39] op_sel_hi:[1,0]
    v_pk_mul_f32 v[92:93], v[92:93], v[38:39] op_sel_hi:[1,0]
    v_pk_mul_f32 v[94:95], v[94:95], v[38:39] op_sel_hi:[1,0]
    v_cvt_pk_bf16_f32 v84, v88, v89
    v_cvt_pk_bf16_f32 v85, v90, v91
    v_cvt_pk_bf16_f32 v86, v92, v93
    v_cvt_pk_bf16_f32 v87, v94, v95
    ds_write_b128 v50, v[80:83] offset:17408
    ds_write_b128 v50, v[84:87] offset:21760
    v_mov_b32 v124, s74
    v_mov_b32 v125, s74
    v_mov_b32 v126, s74
    v_mov_b32 v127, s74
    s_waitcnt lgkmcnt(0)
    s_barrier
    ds_read_b64_tr_b16 v[64:65], v52 offset:0
    ds_read_b64_tr_b16 v[66:67], v52 offset:256
    ds_read_b64_tr_b16 v[80:81], v52 offset:17408
    ds_read_b64_tr_b16 v[82:83], v52 offset:17664
    ds_read_b64_tr_b16 v[68:69], v52 offset:512
    ds_read_b64_tr_b16 v[70:71], v52 offset:768
    ds_read_b64_tr_b16 v[84:85], v52 offset:17920
    ds_read_b64_tr_b16 v[86:87], v52 offset:18176
    ds_read_b64_tr_b16 v[72:73], v52 offset:1024
    ds_read_b64_tr_b16 v[74:75], v52 offset:1280
    ds_read_b64_tr_b16 v[88:89], v52 offset:18432
    ds_read_b64_tr_b16 v[90:91], v52 offset:18688
    ds_read_b64_tr_b16 v[76:77], v52 offset:1536
    ds_read_b64_tr_b16 v[78:79], v52 offset:1792
    ds_read_b64_tr_b16 v[92:93], v52 offset:18944
    ds_read_b64_tr_b16 v[94:95], v52 offset:19200
    v_add_u32 v122, s72, v59
    v_add_u32 v123, s72, v60
    s_waitcnt lgkmcnt(12)
    v_mfma_f32_16x16x32_bf16 v[112:115], v[64:67], v[80:83], 0
    v_mfma_f32_16x16x32_bf16 v[116:119], v[124:127], v[64:67], 0
    ds_read_b128 v[96:99], v44 offset:0
    s_waitcnt lgkmcnt(9)
    v_mfma_f32_16x16x32_bf16 v[112:115], v[68:71], v[84:87], v[112:115]
    v_mfma_f32_16x16x32_bf16 v[116:119], v[124:127], v[68:71], v[116:119]
    ds_read_b128 v[100:103], v44 offset:1024
    s_waitcnt lgkmcnt(6)
    v_mfma_f32_16x16x32_bf16 v[112:115], v[72:75], v[88:91], v[112:115]
    v_mfma_f32_16x16x32_bf16 v[116:119], v[124:127], v[72:75], v[116:119]
    ds_read_b128 v[104:107], v44 offset:2048
    s_waitcnt lgkmcnt(3)
    v_mfma_f32_16x16x32_bf16 v[112:115], v[76:79], v[92:95], v[112:115]
    v_mfma_f32_16x16x32_bf16 v[116:119], v[124:127], v[76:79], v[116:119]
    ds_read_b128 v[108:111], v44 offset:3072
    v_mfma_f32_32x32x8_bf16 v[64:79], v[24:25], v[36:37], 0
    s_nop 4
    v_cvt_pk_bf16_f32 v120, v112, v113
    v_cvt_pk_bf16_f32 v121, v114, v115
    v_min_u32 v120, -2, v120
    v_min_u32 v121, -2, v121
    buffer_store_dwordx2 v[120:121], v122, s[36:39], s88 offen sc1
    v_min_u32 v124, -2, v116
    buffer_store_dword v124, v123, s[36:39], s89 offen sc1
    s_waitcnt lgkmcnt(3)
    v_mfma_f32_32x32x16_bf16 v[64:79], v[96:99], v[128:131], v[64:79]
    ds_read_b128 v[112:115], v44 offset:4096
    s_waitcnt lgkmcnt(3)
    v_mfma_f32_32x32x16_bf16 v[64:79], v[100:103], v[132:135], v[64:79]
    ds_read_b128 v[116:119], v44 offset:5120
    s_lshl_b32 s92, s44, 11
    s_add_u32 s92, s92, 98304
    v_add_u32 v40, s92, v2
    ds_write_b128 v40, a[128:131] offset:0
    s_waitcnt lgkmcnt(3)
    v_mfma_f32_32x32x16_bf16 v[64:79], v[104:107], v[136:139], v[64:79]
    ds_read_b128 v[96:99], v44 offset:6144
    v_mfma_f32_32x32x16_bf16 v[64:79], v[108:111], v[140:143], v[64:79]
    ds_read_b128 v[100:103], v44 offset:7168
    s_lshl_b32 s92, s44, 13
    s_add_u32 s92, s92, 65536
    v_add_u32 v1, s92, v2
    ds_write_b128 v1, a[224:227] offset:0
    s_waitcnt lgkmcnt(4)
    v_mfma_f32_32x32x16_bf16 v[64:79], v[112:115], v[144:147], v[64:79]
    ds_read_b128 v[104:107], v44 offset:8192
    v_mfma_f32_32x32x16_bf16 v[64:79], v[116:119], v[148:151], v[64:79]
    ds_read_b128 v[108:111], v44 offset:9216
    ds_write_b128 v40, a[132:135] offset:8192
    s_waitcnt lgkmcnt(4)
    v_mfma_f32_32x32x16_bf16 v[64:79], v[96:99], v[152:155], v[64:79]
    ds_read_b128 v[112:115], v44 offset:10240
    v_mfma_f32_32x32x16_bf16 v[64:79], v[100:103], v[156:159], v[64:79]
    ds_read_b128 v[116:119], v44 offset:11264
    ds_write_b128 v1, a[228:231] offset:1024
    s_waitcnt lgkmcnt(4)
    v_mfma_f32_32x32x16_bf16 v[64:79], v[104:107], v[160:163], v[64:79]
    ds_read_b128 v[96:99], v44 offset:12288
    v_mfma_f32_32x32x16_bf16 v[64:79], v[108:111], v[164:167], v[64:79]
    ds_read_b128 v[100:103], v44 offset:13312
    ds_write_b128 v40, a[136:139] offset:16384
    s_waitcnt lgkmcnt(4)
    v_mfma_f32_32x32x16_bf16 v[64:79], v[112:115], v[168:171], v[64:79]
    ds_read_b128 v[104:107], v44 offset:14336
    v_mfma_f32_32x32x16_bf16 v[64:79], v[116:119], v[172:175], v[64:79]
    ds_read_b128 v[108:111], v44 offset:15360
    ds_write_b128 v1, a[232:235] offset:2048
    s_waitcnt lgkmcnt(4)
    v_mfma_f32_32x32x16_bf16 v[64:79], v[96:99], v[176:179], v[64:79]
    ds_read_b128 v[112:115], v44 offset:16384
    v_mfma_f32_32x32x16_bf16 v[64:79], v[100:103], v[180:183], v[64:79]
    ds_read_b128 v[116:119], v44 offset:17408
    ds_write_b128 v40, a[140:143] offset:24576
    s_waitcnt lgkmcnt(4)
    v_mfma_f32_32x32x16_bf16 v[64:79], v[104:107], v[184:187], v[64:79]
    ds_read_b128 v[96:99], v44 offset:18432
    v_mfma_f32_32x32x16_bf16 v[64:79], v[108:111], v[188:191], v[64:79]
    ds_read_b128 v[100:103], v44 offset:19456
    ds_write_b128 v1, a[236:239] offset:3072
    s_waitcnt lgkmcnt(4)
    v_mfma_f32_32x32x16_bf16 v[64:79], v[112:115], v[192:195], v[64:79]
    ds_read_b128 v[104:107], v44 offset:20480
    v_mfma_f32_32x32x16_bf16 v[64:79], v[116:119], v[196:199], v[64:79]
    ds_read_b128 v[108:111], v44 offset:21504
    ds_write_b128 v40, a[144:147] offset:1024
    s_waitcnt lgkmcnt(4)
    v_mfma_f32_32x32x16_bf16 v[64:79], v[96:99], v[200:203], v[64:79]
    ds_read_b128 v[112:115], v44 offset:22528
    v_mfma_f32_32x32x16_bf16 v[64:79], v[100:103], v[204:207], v[64:79]
    ds_read_b128 v[116:119], v44 offset:23552
    s_waitcnt lgkmcnt(3)
    v_mfma_f32_32x32x16_bf16 v[64:79], v[104:107], v[208:211], v[64:79]
    ds_read_b128 v[96:99], v44 offset:24576
    v_mfma_f32_32x32x16_bf16 v[64:79], v[108:111], v[212:215], v[64:79]
    ds_read_b128 v[100:103], v44 offset:25600
    ds_write_b128 v40, a[148:151] offset:9216
    s_waitcnt lgkmcnt(3)
    v_mfma_f32_32x32x16_bf16 v[64:79], v[112:115], v[216:219], v[64:79]
    ds_read_b128 v[104:107], v44 offset:26624
    v_mfma_f32_32x32x16_bf16 v[64:79], v[116:119], v[220:223], v[64:79]
    ds_read_b128 v[108:111], v44 offset:27648
    s_waitcnt lgkmcnt(3)
    v_mfma_f32_32x32x16_bf16 v[64:79], v[96:99], v[224:227], v[64:79]
    ds_read_b128 v[112:115], v44 offset:28672
    s_add_u32 s89, s69, 131072
    buffer_load_dword v160, v3, s[36:39], s89 offen offset:0 sc1
    v_mfma_f32_32x32x16_bf16 v[64:79], v[100:103], v[228:231], v[64:79]
    ds_read_b128 v[116:119], v44 offset:29696
    buffer_load_dword v161, v3, s[36:39], s89 offen offset:256 sc1
    ds_write_b128 v40, a[152:155] offset:17408
    s_waitcnt lgkmcnt(3)
    v_mfma_f32_32x32x16_bf16 v[64:79], v[104:107], v[232:235], v[64:79]
    ds_read_b128 v[96:99], v44 offset:30720
    s_add_u32 s88, s66, 1048576
    buffer_load_dwordx4 v[128:131], v2, s[36:39], s88 offen offset:0 sc1
    v_mfma_f32_32x32x16_bf16 v[64:79], v[108:111], v[236:239], v[64:79]
    ds_read_b128 v[100:103], v44 offset:31744
    buffer_load_dwordx4 v[132:135], v2, s[36:39], s88 offen offset:1024 sc1
    s_waitcnt lgkmcnt(3)
    v_mfma_f32_32x32x16_bf16 v[64:79], v[112:115], v[240:243], v[64:79]
    buffer_load_dwordx4 v[136:139], v2, s[36:39], s88 offen offset:2048 sc1
    v_mfma_f32_32x32x16_bf16 v[64:79], v[116:119], v[244:247], v[64:79]
    buffer_load_dwordx4 v[140:143], v2, s[36:39], s88 offen offset:3072 sc1
    ds_write_b128 v40, a[156:159] offset:25600
    s_waitcnt lgkmcnt(1)
    v_mfma_f32_32x32x16_bf16 v[64:79], v[96:99], v[248:251], v[64:79]
    v_mfma_f32_32x32x16_bf16 v[64:79], v[100:103], v[252:255], v[64:79]
    s_nop 11
    v_pk_mul_f32 v[96:97], v[64:65], v[38:39] op_sel:[0,1] op_sel_hi:[1,1]
    v_pk_mul_f32 v[98:99], v[66:67], v[38:39] op_sel:[0,1] op_sel_hi:[1,1]
    v_pk_mul_f32 v[100:101], v[68:69], v[38:39] op_sel:[0,1] op_sel_hi:[1,1]
    v_pk_mul_f32 v[102:103], v[70:71], v[38:39] op_sel:[0,1] op_sel_hi:[1,1]
    v_exp_f32_e64 v96, v96 clamp
    v_exp_f32_e64 v97, v97 clamp
    v_exp_f32_e64 v98, v98 clamp
    v_exp_f32_e64 v99, v99 clamp
    v_exp_f32_e64 v100, v100 clamp
    v_exp_f32_e64 v101, v101 clamp
    v_exp_f32_e64 v102, v102 clamp
    v_exp_f32_e64 v103, v103 clamp
    v_pk_fma_f32 v[64:65], v[64:65], v[38:39], 1.0 op_sel_hi:[1,0,0]
    v_pk_fma_f32 v[66:67], v[66:67], v[38:39], 1.0 op_sel_hi:[1,0,0]
    v_pk_fma_f32 v[68:69], v[68:69], v[38:39], 1.0 op_sel_hi:[1,0,0]
    v_pk_fma_f32 v[70:71], v[70:71], v[38:39], 1.0 op_sel_hi:[1,0,0]
    v_max_f32 v64, v64, v96
    v_max_f32 v65, v65, v97
    v_max_f32 v66, v66, v98
    v_max_f32 v67, v67, v99
    v_max_f32 v68, v68, v100
    v_max_f32 v69, v69, v101
    v_max_f32 v70, v70, v102
    v_max_f32 v71, v71, v103
    v_pk_add_f32 v[64:65], v[64:65], s[86:87]
    v_pk_add_f32 v[66:67], v[66:67], s[86:87]
    v_pk_add_f32 v[68:69], v[68:69], s[86:87]
    v_pk_add_f32 v[70:71], v[70:71], s[86:87]
    v_cvt_pk_bf16_f32 v192, v64, v65
    v_cvt_pk_bf16_f32 v193, v66, v67
    v_cvt_pk_bf16_f32 v194, v68, v69
    v_cvt_pk_bf16_f32 v195, v70, v71
    v_pk_mul_f32 v[104:105], v[72:73], v[38:39] op_sel:[0,1] op_sel_hi:[1,1]
    v_pk_mul_f32 v[106:107], v[74:75], v[38:39] op_sel:[0,1] op_sel_hi:[1,1]
    v_pk_mul_f32 v[108:109], v[76:77], v[38:39] op_sel:[0,1] op_sel_hi:[1,1]
    v_pk_mul_f32 v[110:111], v[78:79], v[38:39] op_sel:[0,1] op_sel_hi:[1,1]
    v_exp_f32_e64 v104, v104 clamp
    v_exp_f32_e64 v105, v105 clamp
    v_exp_f32_e64 v106, v106 clamp
    v_exp_f32_e64 v107, v107 clamp
    v_exp_f32_e64 v108, v108 clamp
    v_exp_f32_e64 v109, v109 clamp
    v_exp_f32_e64 v110, v110 clamp
    v_exp_f32_e64 v111, v111 clamp
    s_waitcnt vmcnt(4)
    s_mov_b32 s3, 0
    v_max_u32 v165, v160, v161
    v_cmp_eq_u32 vcc, -1, v165
    s_cbranch_vccnz L_e1k2
L_e1kj2:
    v_pk_fma_f32 v[72:73], v[72:73], v[38:39], 1.0 op_sel_hi:[1,0,0]
    v_pk_fma_f32 v[74:75], v[74:75], v[38:39], 1.0 op_sel_hi:[1,0,0]
    v_pk_fma_f32 v[76:77], v[76:77], v[38:39], 1.0 op_sel_hi:[1,0,0]
    v_pk_fma_f32 v[78:79], v[78:79], v[38:39], 1.0 op_sel_hi:[1,0,0]
    v_max_f32 v72, v72, v104
    v_max_f32 v73, v73, v105
    v_max_f32 v74, v74, v106
    v_max_f32 v75, v75, v107
    v_max_f32 v76, v76, v108
    v_max_f32 v77, v77, v109
    v_max_f32 v78, v78, v110
    v_max_f32_e64 v79, v79, v111
    v_pk_add_f32 v[72:73], v[72:73], s[86:87]
    v_pk_add_f32 v[74:75], v[74:75], s[86:87]
    v_pk_add_f32 v[76:77], v[76:77], s[86:87]
    v_pk_add_f32 v[78:79], v[78:79], s[86:87]
    v_cvt_pk_bf16_f32 v196, v72, v73
    v_cvt_pk_bf16_f32 v197, v74, v75
    v_cvt_pk_bf16_f32 v198, v76, v77
    v_cvt_pk_bf16_f32 v199, v78, v79
    s_cmp_lg_u32 s3, 0
    s_cbranch_scc1 L_e1w2
L_e1c2:
    v_max_u32 v120, v160, v161
    v_add_f32 v160, v160, v161
    v_mov_b32 v161, v160
    s_waitcnt vmcnt(3)
    v_mfma_f32_16x16x32_bf16 v[96:99], v[20:23], v[128:131], 0
    v_max3_u32 v120, v120, v128, v129
    v_max3_u32 v120, v120, v130, v131
    v_permlane16_swap_b32 v160, v161
    v_add_f32 v160, v160, v161
    v_mov_b32 v161, v160
    s_waitcnt vmcnt(2)
    v_mfma_f32_16x16x32_bf16 v[96:99], v[20:23], v[132:135], v[96:99]
    v_max3_u32 v120, v120, v132, v133
    v_max3_u32 v120, v120, v134, v135
    s_waitcnt vmcnt(1)
    v_mfma_f32_16x16x32_bf16 v[96:99], v[20:23], v[136:139], v[96:99]
    v_max3_u32 v120, v120, v136, v137
    v_max3_u32 v120, v120, v138, v139
    s_waitcnt vmcnt(0)
    v_mfma_f32_16x16x32_bf16 v[96:99], v[20:23], v[140:143], v[96:99]
    v_max3_u32 v120, v120, v140, v141
    v_max3_u32 v120, v120, v142, v143
    v_cmp_eq_u32 vcc, -1, v120
    s_cbranch_vccnz L_e1r2
    v_permlane32_swap_b32 v160, v161
    v_add_f32 v160, v160, v161
    v_cvt_pk_bf16_f32 v160, v160, v160
    ds_write_b16 v55, v160 offset:512
    v_cvt_pk_bf16_f32 v120, v96, v97
    v_cvt_pk_bf16_f32 v121, v98, v99
    ds_write_b64 v54, v[120:121]
    s_waitcnt lgkmcnt(2)
    s_waitcnt lgkmcnt(0)
    s_barrier
    ds_read_b128 v[104:107], v56 offset:0
    ds_read_b128 v[108:111], v56 offset:1088
    ds_read_b128 v[112:115], v56 offset:544
    ds_read_b128 v[116:119], v56 offset:1632
    s_waitcnt lgkmcnt(3)
    v_mfma_f32_32x32x16_bf16 v[64:79], v[104:107], v[192:195], 0
    s_waitcnt lgkmcnt(2)
    v_mfma_f32_32x32x16_bf16 v[64:79], v[108:111], v[192:195], v[64:79]
    v_add_u32 v44, 32768, v2
    v_mov_b32 v96, 3
    v_lshrrev_b32 v63, 7, v3
    v_mul_u32_u24 v63, 1536, v63
    s_waitcnt lgkmcnt(0)
    v_mfma_f32_32x32x16_bf16 v[80:95], v[112:115], v[196:199], 0
    v_add_u32 v63, v63, v2
    v_add_u32 v124, 0, v63
    v_add_u32 v125, 98304, v63
    s_nop 0
    s_nop 0
    v_mfma_f32_32x32x16_bf16 v[80:95], v[116:119], v[196:199], v[80:95]
    v_add_f32 v72, s86, v72
    v_rcp_f32 v72, v72
    s_nop 0
    v_mul_f32 v64, v72, v64
    v_mul_f32 v65, v72, v65
    v_mul_f32 v66, v72, v66
    v_mul_f32 v67, v72, v67
    v_mul_f32 v68, v72, v68
    v_mul_f32 v69, v72, v69
    v_mul_f32 v70, v72, v70
    v_mul_f32 v71, v72, v71
    v_cvt_pk_bf16_f32 v224, v64, v65
    v_cvt_pk_bf16_f32 v225, v66, v67
    v_and_b32 v224, -2, v224
    v_cvt_pk_bf16_f32 v226, v68, v69
    v_cvt_pk_bf16_f32 v227, v70, v71
    s_cmp_lg_u32 s50, 0
    s_cbranch_scc1 L_po20_safe
    buffer_store_dwordx4 v[224:227], v46, s[36:39], s61 offen offset:0
L_po20_join:
    v_add_f32 v88, s86, v88
    v_rcp_f32 v88, v88
    s_nop 0
    v_pk_mul_f32 v[80:81], v[80:81], v[88:89] op_sel_hi:[1,0]
    v_pk_mul_f32 v[82:83], v[82:83], v[88:89] op_sel_hi:[1,0]
    v_pk_mul_f32 v[84:85], v[84:85], v[88:89] op_sel_hi:[1,0]
    v_pk_mul_f32 v[86:87], v[86:87], v[88:89] op_sel_hi:[1,0]
    v_cvt_pk_bf16_f32 v228, v80, v81
    v_cvt_pk_bf16_f32 v229, v82, v83
    v_and_b32 v228, -2, v228
    v_cvt_pk_bf16_f32 v230, v84, v85
    v_cvt_pk_bf16_f32 v231, v86, v87
    s_mov_b64 exec, 1
    buffer_store_dword v96, off, s[36:39], s81
    s_mov_b64 exec, -1
    s_cmp_lg_u32 s50, 0
    s_cbranch_scc1 L_po21_safe
    buffer_store_dwordx4 v[228:231], v46, s[36:39], s61 offen offset:512
L_po21_join:
    ds_read_b128 v[80:83], v124 offset:0
    ds_read_b128 v[84:87], v124 offset:512
    ds_read_b128 v[88:91], v124 offset:1024
    ds_read_b128 v[92:95], v124 offset:1536
    ds_read_b128 v[96:99], v124 offset:4096
    ds_read_b128 v[100:103], v124 offset:4608
    v_lshlrev_b32 v64, 16, v4
    v_and_b32 v65, s76, v4
    v_lshlrev_b32 v66, 16, v5
    v_and_b32 v67, s76, v5
    v_lshlrev_b32 v68, 16, v6
    v_and_b32 v69, s76, v6
    v_lshlrev_b32 v70, 16, v7
    v_and_b32 v71, s76, v7
    v_lshlrev_b32 v72, 16, v8
    v_and_b32 v73, s76, v8
    v_lshlrev_b32 v74, 16, v9
    v_and_b32 v75, s76, v9
    v_lshlrev_b32 v76, 16, v10
    v_and_b32 v77, s76, v10
    v_lshlrev_b32 v78, 16, v11
    v_and_b32 v79, s76, v11
    s_lshl_b32 s92, s44, 13
    s_add_u32 s92, s92, 32768
    v_add_u32 v1, s92, v2
    ds_write_b128 v1, a[160:163] offset:0
    ds_write_b128 v1, a[164:167] offset:1024
    buffer_load_dword v120, v62, s[36:39], s62 offen sc1
    ds_write_b128 v1, a[168:171] offset:2048
    ds_write_b128 v1, a[172:175] offset:3072
    ds_write_b128 v1, a[176:179] offset:4096
    ds_write_b128 v1, a[180:183] offset:5120
    buffer_load_dword v252, v62, s[36:39], s62 offen sc1
    s_waitcnt vmcnt(1)
    v_cmp_gt_u32 vcc, 3, v120
    s_cbranch_vccz L_ok_o2
    buffer_load_dword v120, v62, s[36:39], s62 offen sc1
L_again_o2:
    s_waitcnt vmcnt(1)
    v_cmp_gt_u32 vcc, 3, v252
    s_cbranch_vccz L_ok_o2
    buffer_load_dword v252, v62, s[36:39], s62 offen sc1
    s_waitcnt vmcnt(1)
    v_cmp_gt_u32 vcc, 3, v120
    s_cbranch_vccz L_ok_o2
    buffer_load_dword v120, v62, s[36:39], s62 offen sc1
    s_sub_u32 s51, s51, 1
    s_cbranch_scc0 L_again_o2
    s_endpgm
L_ok_o2:
    s_add_u32 s88, s60, 0
    buffer_load_dwordx4 v[128:131], v2, s[36:39], s88 offen offset:0 sc1
    buffer_load_dwordx4 v[132:135], v2, s[36:39], s88 offen offset:2048 sc1
    s_add_u32 s88, s60, 4096
    buffer_load_dwordx4 v[136:139], v2, s[36:39], s88 offen offset:0 sc1
    buffer_load_dwordx4 v[140:143], v2, s[36:39], s88 offen offset:2048 sc1
    s_add_u32 s88, s60, 8192
    buffer_load_dwordx4 v[144:147], v2, s[36:39], s88 offen offset:0 sc1
    buffer_load_dwordx4 v[148:151], v2, s[36:39], s88 offen offset:2048 sc1
    s_lshl_b32 s92, s44, 13
    s_add_u32 s92, s92, 32768
    v_add_u32 v40, s92, v2
    ds_write_b128 v40, a[184:187] offset:6144
    ds_write_b128 v40, a[188:191] offset:7168
    s_waitcnt vmcnt(5) lgkmcnt(12)
    v_mfma_f32_16x16x32_bf16 v[64:67], v[80:83], v[128:131], v[64:67]
    ds_read_b128 v[104:107], v124 offset:5120
    s_add_u32 s88, s60, 12288
    buffer_load_dwordx4 v[152:155], v2, s[36:39], s88 offen offset:0 sc1
    v_mfma_f32_16x16x32_bf16 v[68:71], v[84:87], v[128:131], v[68:71]
    ds_read_b128 v[108:111], v124 offset:5632
    s_waitcnt lgkmcnt(12)
    v_mfma_f32_16x16x32_bf16 v[72:75], v[88:91], v[128:131], v[72:75]
    ds_read_b128 v[112:115], v124 offset:8192
    v_mfma_f32_16x16x32_bf16 v[76:79], v[92:95], v[128:131], v[76:79]
    ds_read_b128 v[116:119], v124 offset:8704
    s_waitcnt vmcnt(5) lgkmcnt(12)
    v_mfma_f32_16x16x32_bf16 v[64:67], v[96:99], v[132:135], v[64:67]
    ds_read_b128 v[80:83], v124 offset:9216
    buffer_load_dwordx4 v[156:159], v2, s[36:39], s88 offen offset:2048 sc1
    v_mfma_f32_16x16x32_bf16 v[68:71], v[100:103], v[132:135], v[68:71]
    ds_read_b128 v[84:87], v124 offset:9728
    s_waitcnt lgkmcnt(4)
    v_mfma_f32_16x16x32_bf16 v[72:75], v[104:107], v[132:135], v[72:75]
    ds_read_b128 v[88:91], v124 offset:12288
    v_or_b32 v121, v128, v132
    v_mfma_f32_16x16x32_bf16 v[76:79], v[108:111], v[132:135], v[76:79]
    ds_read_b128 v[92:95], v124 offset:12800
    s_waitcnt vmcnt(5) lgkmcnt(4)
    v_mfma_f32_16x16x32_bf16 v[64:67], v[112:115], v[136:139], v[64:67]
    ds_read_b128 v[96:99], v124 offset:13312
    s_add_u32 s88, s60, 16384
    buffer_load_dwordx4 v[160:163], v2, s[36:39], s88 offen offset:0 sc1
    v_mfma_f32_16x16x32_bf16 v[68:71], v[116:119], v[136:139], v[68:71]
    ds_read_b128 v[100:103], v124 offset:13824
    s_waitcnt lgkmcnt(4)
    v_mfma_f32_16x16x32_bf16 v[72:75], v[80:83], v[136:139], v[72:75]
    ds_read_b128 v[104:107], v124 offset:16384
    v_mfma_f32_16x16x32_bf16 v[76:79], v[84:87], v[136:139], v[76:79]
    ds_read_b128 v[108:111], v124 offset:16896
    s_waitcnt vmcnt(5) lgkmcnt(4)
    v_mfma_f32_16x16x32_bf16 v[64:67], v[88:91], v[140:143], v[64:67]
    ds_read_b128 v[112:115], v124 offset:17408
    buffer_load_dwordx4 v[164:167], v2, s[36:39], s88 offen offset:2048 sc1
    v_mfma_f32_16x16x32_bf16 v[68:71], v[92:95], v[140:143], v[68:71]
    ds_read_b128 v[116:119], v124 offset:17920
    s_waitcnt lgkmcnt(4)
    v_mfma_f32_16x16x32_bf16 v[72:75], v[96:99], v[140:143], v[72:75]
    ds_read_b128 v[80:83], v124 offset:20480
    v_or3_b32 v121, v121, v136, v140
    v_mfma_f32_16x16x32_bf16 v[76:79], v[100:103], v[140:143], v[76:79]
    ds_read_b128 v[84:87], v124 offset:20992
    s_waitcnt vmcnt(5) lgkmcnt(4)
    v_mfma_f32_16x16x32_bf16 v[64:67], v[104:107], v[144:147], v[64:67]
    ds_read_b128 v[88:91], v124 offset:21504
    s_add_u32 s88, s60, 20480
    buffer_load_dwordx4 v[168:171], v2, s[36:39], s88 offen offset:0 sc1
    v_mfma_f32_16x16x32_bf16 v[68:71], v[108:111], v[144:147], v[68:71]
    ds_read_b128 v[92:95], v124 offset:22016
    s_waitcnt lgkmcnt(4)
    v_mfma_f32_16x16x32_bf16 v[72:75], v[112:115], v[144:147], v[72:75]
    ds_read_b128 v[96:99], v124 offset:24576
    v_mfma_f32_16x16x32_bf16 v[76:79], v[116:119], v[144:147], v[76:79]
    ds_read_b128 v[100:103], v124 offset:25088
    s_waitcnt vmcnt(5) lgkmcnt(4)
    v_mfma_f32_16x16x32_bf16 v[64:67], v[80:83], v[148:151], v[64:67]
    ds_read_b128 v[104:107], v124 offset:25600
    buffer_load_dwordx4 v[172:175], v2, s[36:39], s88 offen offset:2048 sc1
    v_mfma_f32_16x16x32_bf16 v[68:71], v[84:87], v[148:151], v[68:71]
    ds_read_b128 v[108:111], v124 offset:26112
    s_waitcnt lgkmcnt(4)
    v_mfma_f32_16x16x32_bf16 v[72:75], v[88:91], v[148:151], v[72:75]
    ds_read_b128 v[112:115], v124 offset:28672
    v_or3_b32 v121, v121, v144, v148
    v_mfma_f32_16x16x32_bf16 v[76:79], v[92:95], v[148:151], v[76:79]
    ds_read_b128 v[116:119], v124 offset:29184
    s_waitcnt vmcnt(5) lgkmcnt(4)
    v_mfma_f32_16x16x32_bf16 v[64:67], v[96:99], v[152:155], v[64:67]
    ds_read_b128 v[80:83], v124 offset:29696
    s_add_u32 s88, s60, 24576
    buffer_load_dwordx4 v[176:179], v2, s[36:39], s88 offen offset:0 sc1
    v_mfma_f32_16x16x32_bf16 v[68:71], v[100:103], v[152:155], v[68:71]
    ds_read_b128 v[84:87], v124 offset:30208
    s_waitcnt lgkmcnt(4)
    v_mfma_f32_16x16x32_bf16 v[72:75], v[104:107], v[152:155], v[72:75]
    ds_read_b128 v[88:91], v125 offset:0
    v_mfma_f32_16x16x32_bf16 v[76:79], v[108:111], v[152:155], v[76:79]
    ds_read_b128 v[92:95], v125 offset:512
    s_waitcnt vmcnt(5) lgkmcnt(4)
    v_mfma_f32_16x16x32_bf16 v[64:67], v[112:115], v[156:159], v[64:67]
    ds_read_b128 v[96:99], v125 offset:1024
    buffer_load_dwordx4 v[180:183], v2, s[36:39], s88 offen offset:2048 sc1
    v_mfma_f32_16x16x32_bf16 v[68:71], v[116:119], v[156:159], v[68:71]
    ds_read_b128 v[100:103], v125 offset:1536
    s_waitcnt lgkmcnt(4)
    v_mfma_f32_16x16x32_bf16 v[72:75], v[80:83], v[156:159], v[72:75]
    ds_read_b128 v[104:107], v125 offset:4096
    v_or3_b32 v121, v121, v152, v156
    v_mfma_f32_16x16x32_bf16 v[76:79], v[84:87], v[156:159], v[76:79]
    ds_read_b128 v[108:111], v125 offset:4608
    s_waitcnt vmcnt(5) lgkmcnt(4)
    v_mfma_f32_16x16x32_bf16 v[64:67], v[88:91], v[160:163], v[64:67]
    ds_read_b128 v[112:115], v125 offset:5120
    s_add_u32 s88, s60, 28672
    buffer_load_dwordx4 v[184:187], v2, s[36:39], s88 offen offset:0 sc1
    v_mfma_f32_16x16x32_bf16 v[68:71], v[92:95], v[160:163], v[68:71]
    ds_read_b128 v[116:119], v125 offset:5632
    s_waitcnt lgkmcnt(4)
    v_mfma_f32_16x16x32_bf16 v[72:75], v[96:99], v[160:163], v[72:75]
    ds_read_b128 v[80:83], v125 offset:8192
    v_mfma_f32_16x16x32_bf16 v[76:79], v[100:103], v[160:163], v[76:79]
    ds_read_b128 v[84:87], v125 offset:8704
    s_waitcnt vmcnt(5) lgkmcnt(4)
    v_mfma_f32_16x16x32_bf16 v[64:67], v[104:107], v[164:167], v[64:67]
    ds_read_b128 v[88:91], v125 offset:9216
    buffer_load_dwordx4 v[188:191], v2, s[36:39], s88 offen offset:2048 sc1
    v_mfma_f32_16x16x32_bf16 v[68:71], v[108:111], v[164:167], v[68:71]
    ds_read_b128 v[92:95], v125 offset:9728
    s_waitcnt lgkmcnt(4)
    v_mfma_f32_16x16x32_bf16 v[72:75], v[112:115], v[164:167], v[72:75]
    ds_read_b128 v[96:99], v125 offset:12288
    v_or3_b32 v121, v121, v160, v164
    v_mfma_f32_16x16x32_bf16 v[76:79], v[116:119], v[164:167], v[76:79]
    ds_read_b128 v[100:103], v125 offset:12800
    s_waitcnt vmcnt(5) lgkmcnt(4)
    v_mfma_f32_16x16x32_bf16 v[64:67], v[80:83], v[168:171], v[64:67]
    ds_read_b128 v[104:107], v125 offset:13312
    v_mfma_f32_16x16x32_bf16 v[68:71], v[84:87], v[168:171], v[68:71]
    ds_read_b128 v[108:111], v125 offset:13824
    s_waitcnt lgkmcnt(4)
    v_mfma_f32_16x16x32_bf16 v[72:75], v[88:91], v[168:171], v[72:75]
    ds_read_b128 v[112:115], v125 offset:16384
    v_mfma_f32_16x16x32_bf16 v[76:79], v[92:95], v[168:171], v[76:79]
    ds_read_b128 v[116:119], v125 offset:16896
    s_waitcnt vmcnt(4) lgkmcnt(4)
    v_mfma_f32_16x16x32_bf16 v[64:67], v[96:99], v[172:175], v[64:67]
    ds_read_b128 v[80:83], v125 offset:17408
    v_mfma_f32_16x16x32_bf16 v[68:71], v[100:103], v[172:175], v[68:71]
    ds_read_b128 v[84:87], v125 offset:17920
    s_waitcnt lgkmcnt(4)
    v_mfma_f32_16x16x32_bf16 v[72:75], v[104:107], v[172:175], v[72:75]
    ds_read_b128 v[88:91], v125 offset:20480
    v_or3_b32 v121, v121, v168, v172
    v_mfma_f32_16x16x32_bf16 v[76:79], v[108:111], v[172:175], v[76:79]
    ds_read_b128 v[92:95], v125 offset:20992
    s_waitcnt vmcnt(3) lgkmcnt(4)
    v_mfma_f32_16x16x32_bf16 v[64:67], v[112:115], v[176:179], v[64:67]
    ds_read_b128 v[96:99], v125 offset:21504
    v_mfma_f32_16x16x32_bf16 v[68:71], v[116:119], v[176:179], v[68:71]
    ds_read_b128 v[100:103], v125 offset:22016
    s_waitcnt lgkmcnt(4)
    v_mfma_f32_16x16x32_bf16 v[72:75], v[80:83], v[176:179], v[72:75]
    ds_read_b128 v[104:107], v125 offset:24576
    v_mov_b32 v123, 4
    v_mfma_f32_16x16x32_bf16 v[76:79], v[84:87], v[176:179], v[76:79]
    ds_read_b128 v[108:111], v125 offset:25088
    s_waitcnt vmcnt(2) lgkmcnt(4)
    v_mfma_f32_16x16x32_bf16 v[64:67], v[88:91], v[180:183], v[64:67]
L_pad7:
    s_cbranch_execz L_warm_done
    ds_read_b128 v[112:115], v125 offset:25600
    v_mfma_f32_16x16x32_bf16 v[68:71], v[92:95], v[180:183], v[68:71]
    ds_read_b128 v[116:119], v125 offset:26112
    s_waitcnt lgkmcnt(4)
    v_mfma_f32_16x16x32_bf16 v[72:75], v[96:99], v[180:183], v[72:75]
    ds_read_b128 v[80:83], v125 offset:28672
    v_or3_b32 v121, v121, v176, v180
    v_mfma_f32_16x16x32_bf16 v[76:79], v[100:103], v[180:183], v[76:79]
    ds_read_b128 v[84:87], v125 offset:29184
    s_waitcnt vmcnt(1) lgkmcnt(4)
    v_mfma_f32_16x16x32_bf16 v[64:67], v[104:107], v[184:187], v[64:67]
    ds_read_b128 v[88:91], v125 offset:29696
    v_mfma_f32_16x16x32_bf16 v[68:71], v[108:111], v[184:187], v[68:71]
    ds_read_b128 v[92:95], v125 offset:30208
    s_waitcnt lgkmcnt(4)
    v_mfma_f32_16x16x32_bf16 v[72:75], v[112:115], v[184:187], v[72:75]
    v_mfma_f32_16x16x32_bf16 v[76:79], v[116:119], v[184:187], v[76:79]
    s_waitcnt vmcnt(0) lgkmcnt(2)
    v_mfma_f32_16x16x32_bf16 v[64:67], v[80:83], v[188:191], v[64:67]
    v_mfma_f32_16x16x32_bf16 v[68:71], v[84:87], v[188:191], v[68:71]
    s_waitcnt lgkmcnt(0)
    v_mfma_f32_16x16x32_bf16 v[72:75], v[88:91], v[188:191], v[72:75]
    v_or3_b32 v121, v121, v184, v188
    v_and_b32 v120, 1, v121
    v_cmp_ne_u32 vcc, 0, v120
    s_cbranch_vccnz L_redo_o2
    v_mfma_f32_16x16x32_bf16 v[76:79], v[92:95], v[188:191], v[76:79]
    s_add_u32 s56, s56, s52
    s_add_u32 s57, s57, s52
    s_add_u32 s58, s58, s52
    s_add_u32 s59, s59, s52
    s_add_u32 s60, s60, s52
    s_add_u32 s61, s61, s52
    v_cvt_pk_bf16_f32 v4, v64, v65
    v_cvt_pk_bf16_f32 v5, v66, v67
    v_and_b32 v4, -2, v4
    v_cvt_pk_bf16_f32 v6, v68, v69
    v_cvt_pk_bf16_f32 v7, v70, v71
    s_mov_b64 exec, 1
    buffer_store_dword v123, off, s[36:39], s82
    s_mov_b64 exec, -1
    s_cmp_lg_u32 s50, 0
    s_cbranch_scc1 L_px20_safe
    buffer_store_dwordx4 v[4:7], v45, s[36:39], s57 offen offset:0
L_px20_join:
    v_cvt_pk_bf16_f32 v8, v72, v73
    v_cvt_pk_bf16_f32 v9, v74, v75
    v_and_b32 v8, -2, v8
    v_cvt_pk_bf16_f32 v10, v76, v77
    v_cvt_pk_bf16_f32 v11, v78, v79
    s_cmp_lg_u32 s50, 0
    s_cbranch_scc1 L_px21_safe
    buffer_store_dwordx4 v[8:11], v45, s[36:39], s57 offen offset:2048
L_px21_join:
    s_mov_b32 s90, s56
    v_dot2_f32_bf16 v120, v4, s74, 0
    v_dot2_f32_bf16 v121, v4, v4, 0
    v_dot2_f32_bf16 v120, v5, s74, v120
    v_dot2_f32_bf16 v121, v5, v5, v121
    v_dot2_f32_bf16 v120, v6, s74, v120
    v_dot2_f32_bf16 v121, v6, v6, v121
    v_dot2_f32_bf16 v120, v7, s74, v120
    v_dot2_f32_bf16 v121, v7, v7, v121
    v_dot2_f32_bf16 v120, v8, s74, v120
    v_dot2_f32_bf16 v121, v8, v8, v121
    v_dot2_f32_bf16 v120, v9, s74, v120
    v_dot2_f32_bf16 v121, v9, v9, v121
    v_dot2_f32_bf16 v120, v10, s74, v120
    v_dot2_f32_bf16 v121, v10, v10, v121
    v_dot2_f32_bf16 v120, v11, s74, v120
    v_dot2_f32_bf16 v121, v11, v11, v121
    s_nop 2
    v_permlane32_swap_b32 v120, v121
    v_add_f32 v120, v120, v121
    v_mov_b32 v121, v120
    s_nop 1
    v_permlane16_swap_b32 v120, v121
    v_add_f32 v120, v120, v121
    v_and_b32 v120, -2, v120
    s_cmp_lg_u32 s50, 0
    s_cbranch_scc1 L_px2s_safe
    buffer_store_dword v120, v61, s[36:39], s59 offen
L_px2s_join:
    s_lshl_b32 s92, s44, 13
    s_add_u32 s92, s92, 65536
    v_add_u32 v1, s92, v2
    ds_write_b128 v1, a[240:243] offset:4096
    ds_write_b128 v1, a[244:247] offset:5120
    buffer_load_dword v125, v62, s[36:39], s64 offen sc1
    ds_write_b128 v1, a[248:251] offset:6144
    ds_write_b128 v1, a[252:255] offset:7168
    s_waitcnt lgkmcnt(0)
    s_barrier
    ds_read_b128 v[96:99], v44 offset:0
    ds_read_b128 v[100:103], v44 offset:32768
    ds_read_b128 v[104:107], v44 offset:1024
    ds_read_b128 v[108:111], v44 offset:33792
    buffer_load_dword v252, v62, s[36:39], s64 offen sc1
    s_waitcnt vmcnt(1)
    v_cmp_gt_u32 vcc, 4, v125
    s_cbranch_vccz L_ok_x3
    buffer_load_dword v125, v62, s[36:39], s64 offen sc1
L_again_x3:
    s_waitcnt vmcnt(1)
    v_cmp_gt_u32 vcc, 4, v252
    s_cbranch_vccz L_ok_x3
    buffer_load_dword v252, v62, s[36:39], s64 offen sc1
    s_waitcnt vmcnt(1)
    v_cmp_gt_u32 vcc, 4, v125
    s_cbranch_vccz L_ok_x3
    buffer_load_dword v125, v62, s[36:39], s64 offen sc1
    s_sub_u32 s51, s51, 1
    s_cbranch_scc0 L_again_x3
    s_endpgm
L_ok_x3:
    s_xor_b32 s88, s90, 0
    buffer_load_dwordx4 v[128:131], v2, s[36:39], s88 offen offset:0 sc1
    buffer_load_dwordx4 v[132:135], v2, s[36:39], s88 offen offset:1024 sc1
    buffer_load_dwordx4 v[136:139], v2, s[36:39], s88 offen offset:2048 sc1
    buffer_load_dwordx4 v[140:143], v2, s[36:39], s88 offen offset:3072 sc1
    s_xor_b32 s88, s90, 4096
    buffer_load_dwordx4 v[144:147], v2, s[36:39], s88 offen offset:0 sc1
    buffer_load_dwordx4 v[148:151], v2, s[36:39], s88 offen offset:1024 sc1
    buffer_load_dwordx4 v[152:155], v2, s[36:39], s88 offen offset:2048 sc1
    s_waitcnt vmcnt(6) lgkmcnt(2)
    v_mfma_f32_32x32x16_bf16 v[64:79], v[96:99], v[128:131], 0
    buffer_load_dwordx4 v[156:159], v2, s[36:39], s88 offen offset:3072 sc1
    ds_read_b128 v[112:115], v44 offset:2048
    v_mfma_f32_32x32x16_bf16 v[80:95], v[100:103], v[128:131], 0
    ds_read_b128 v[116:119], v44 offset:34816
    s_lshl_b32 s92, s44, 13
    s_add_u32 s92, s92, 0
    v_add_u32 v40, s92, v2
    ds_write_b128 v40, a[192:195] offset:0
    s_waitcnt vmcnt(6) lgkmcnt(3)
    v_mfma_f32_32x32x16_bf16 v[64:79], v[104:107], v[132:135], v[64:79]
    s_xor_b32 s88, s90, 8192
    buffer_load_dwordx4 v[160:163], v2, s[36:39], s88 offen offset:0 sc1
    ds_read_b128 v[96:99], v44 offset:3072
    v_mfma_f32_32x32x16_bf16 v[80:95], v[108:111], v[132:135], v[80:95]
    ds_read_b128 v[100:103], v44 offset:35840
    v_or_b32 v124, v128, v132
    s_waitcnt vmcnt(6) lgkmcnt(3)
    v_mfma_f32_32x32x16_bf16 v[64:79], v[112:115], v[136:139], v[64:79]
    buffer_load_dwordx4 v[164:167], v2, s[36:39], s88 offen offset:1024 sc1
    ds_read_b128 v[104:107], v44 offset:4096
    v_mfma_f32_32x32x16_bf16 v[80:95], v[116:119], v[136:139], v[80:95]
    ds_read_b128 v[108:111], v44 offset:36864
    s_lshl_b32 s92, s44, 11
    s_add_u32 s92, s92, 98304
    v_add_u32 v1, s92, v2
    ds_write_b128 v1, a[0:3] offset:0
    s_waitcnt vmcnt(6) lgkmcnt(3)
    v_mfma_f32_32x32x16_bf16 v[64:79], v[96:99], v[140:143], v[64:79]
    buffer_load_dwordx4 v[168:171], v2, s[36:39], s88 offen offset:2048 sc1
    ds_read_b128 v[112:115], v44 offset:5120
    v_mfma_f32_32x32x16_bf16 v[80:95], v[100:103], v[140:143], v[80:95]
    ds_read_b128 v[116:119], v44 offset:37888
    v_or3_b32 v124, v124, v136, v140
    s_waitcnt vmcnt(6) lgkmcnt(3)
    v_mfma_f32_32x32x16_bf16 v[64:79], v[104:107], v[144:147], v[64:79]
    buffer_load_dwordx4 v[172:175], v2, s[36:39], s88 offen offset:3072 sc1
    ds_read_b128 v[96:99], v44 offset:6144
    v_mfma_f32_32x32x16_bf16 v[80:95], v[108:111], v[144:147], v[80:95]
    buffer_load_dwordx4 v[248:251], v2, s[36:39], s58 offen offset:0 sc1
    ds_read_b128 v[100:103], v44 offset:38912
    ds_write_b128 v40, a[196:199] offset:1024
    s_waitcnt vmcnt(7) lgkmcnt(3)
    v_mfma_f32_32x32x16_bf16 v[64:79], v[112:115], v[148:151], v[64:79]
    s_xor_b32 s88, s90, 12288
    buffer_load_dwordx4 v[176:179], v2, s[36:39], s88 offen offset:0 sc1
    ds_read_b128 v[104:107], v44 offset:7168
    v_mfma_f32_32x32x16_bf16 v[80:95], v[116:119], v[148:151], v[80:95]
    buffer_load_dwordx4 v[252:255], v2, s[36:39], s58 offen offset:1024 sc1
    ds_read_b128 v[108:111], v44 offset:39936
    v_or3_b32 v124, v124, v144, v148
    s_waitcnt vmcnt(8) lgkmcnt(3)
    v_mfma_f32_32x32x16_bf16 v[64:79], v[96:99], v[152:155], v[64:79]
    buffer_load_dwordx4 v[180:183], v2, s[36:39], s88 offen offset:1024 sc1
    ds_read_b128 v[112:115], v44 offset:8192
    v_mfma_f32_32x32x16_bf16 v[80:95], v[100:103], v[152:155], v[80:95]
    ds_read_b128 v[116:119], v44 offset:40960
    ds_write_b128 v1, a[4:7] offset:8192
    s_waitcnt vmcnt(8) lgkmcnt(3)
    v_mfma_f32_32x32x16_bf16 v[64:79], v[104:107], v[156:159], v[64:79]
    buffer_load_dwordx4 v[184:187], v2, s[36:39], s88 offen offset:2048 sc1
    ds_read_b128 v[96:99], v44 offset:9216
    v_mfma_f32_32x32x16_bf16 v[80:95], v[108:111], v[156:159], v[80:95]
    ds_read_b128 v[100:103], v44 offset:41984
    v_or3_b32 v124, v124, v152, v156
    s_waitcnt vmcnt(8) lgkmcnt(3)
    v_mfma_f32_32x32x16_bf16 v[64:79], v[112:115], v[160:163], v[64:79]
    buffer_load_dwordx4 v[188:191], v2, s[36:39], s88 offen offset:3072 sc1
    ds_read_b128 v[104:107], v44 offset:10240
    v_mfma_f32_32x32x16_bf16 v[80:95], v[116:119], v[160:163], v[80:95]
    ds_read_b128 v[108:111], v44 offset:43008
    ds_write_b128 v40, a[200:203] offset:2048
    s_waitcnt vmcnt(8) lgkmcnt(3)
    v_mfma_f32_32x32x16_bf16 v[64:79], v[96:99], v[164:167], v[64:79]
    s_xor_b32 s88, s90, 16384
    buffer_load_dwordx4 v[192:195], v2, s[36:39], s88 offen offset:0 sc1
    ds_read_b128 v[112:115], v44 offset:11264
    v_mfma_f32_32x32x16_bf16 v[80:95], v[100:103], v[164:167], v[80:95]
    ds_read_b128 v[116:119], v44 offset:44032
    v_or3_b32 v124, v124, v160, v164
    s_waitcnt vmcnt(8) lgkmcnt(3)
    v_mfma_f32_32x32x16_bf16 v[64:79], v[104:107], v[168:171], v[64:79]
    buffer_load_dwordx4 v[196:199], v2, s[36:39], s88 offen offset:1024 sc1
    ds_read_b128 v[96:99], v44 offset:12288
    v_mfma_f32_32x32x16_bf16 v[80:95], v[108:111], v[168:171], v[80:95]
    ds_read_b128 v[100:103], v44 offset:45056
    ds_write_b128 v1, a[8:11] offset:16384
    s_waitcnt vmcnt(8) lgkmcnt(3)
    v_mfma_f32_32x32x16_bf16 v[64:79], v[112:115], v[172:175], v[64:79]
    buffer_load_dwordx4 v[200:203], v2, s[36:39], s88 offen offset:2048 sc1
    ds_read_b128 v[104:107], v44 offset:13312
    v_mfma_f32_32x32x16_bf16 v[80:95], v[116:119], v[172:175], v[80:95]
    ds_read_b128 v[108:111], v44 offset:46080
    v_or3_b32 v124, v124, v168, v172
    s_waitcnt vmcnt(7) lgkmcnt(3)
    v_mfma_f32_32x32x16_bf16 v[64:79], v[96:99], v[176:179], v[64:79]
    buffer_load_dwordx4 v[204:207], v2, s[36:39], s88 offen offset:3072 sc1
    ds_read_b128 v[112:115], v44 offset:14336
    v_mfma_f32_32x32x16_bf16 v[80:95], v[100:103], v[176:179], v[80:95]
    ds_read_b128 v[116:119], v44 offset:47104
    ds_write_b128 v40, a[204:207] offset:3072
    s_waitcnt vmcnt(6) lgkmcnt(3)
    v_mfma_f32_32x32x16_bf16 v[64:79], v[104:107], v[180:183], v[64:79]
    s_xor_b32 s88, s90, 20480
    buffer_load_dwordx4 v[208:211], v2, s[36:39], s88 offen offset:0 sc1
    ds_read_b128 v[96:99], v44 offset:15360
    v_or3_b32 v124, v124, v248, v249
    v_or3_b32 v124, v124, v250, v251
    v_mfma_f32_32x32x16_bf16 v[80:95], v[108:111], v[180:183], v[80:95]
    ds_read_b128 v[100:103], v44 offset:48128
    v_or3_b32 v124, v124, v176, v180
    v_add_f32 v248, v248, v250
    v_add_f32 v249, v249, v251
    s_waitcnt vmcnt(6) lgkmcnt(3)
    v_mfma_f32_32x32x16_bf16 v[64:79], v[112:115], v[184:187], v[64:79]
    buffer_load_dwordx4 v[212:215], v2, s[36:39], s88 offen offset:1024 sc1
    ds_read_b128 v[104:107], v44 offset:16384
    v_or3_b32 v124, v124, v252, v253
    v_or3_b32 v124, v124, v254, v255
    v_mfma_f32_32x32x16_bf16 v[80:95], v[116:119], v[184:187], v[80:95]
    ds_read_b128 v[108:111], v44 offset:49152
    ds_write_b128 v1, a[12:15] offset:24576
    v_add_f32 v252, v252, v254
    v_add_f32 v253, v253, v255
    s_waitcnt vmcnt(6) lgkmcnt(3)
    v_mfma_f32_32x32x16_bf16 v[64:79], v[96:99], v[188:191], v[64:79]
    buffer_load_dwordx4 v[216:219], v2, s[36:39], s88 offen offset:2048 sc1
    ds_read_b128 v[112:115], v44 offset:17408
    v_add_f32 v120, v248, v252
    v_add_f32 v121, v249, v253
    v_mfma_f32_32x32x16_bf16 v[80:95], v[100:103], v[188:191], v[80:95]
    ds_read_b128 v[116:119], v44 offset:50176
    v_or3_b32 v124, v124, v184, v188
    v_mov_b32 v122, v120
    v_mov_b32 v123, v121
    s_waitcnt vmcnt(6) lgkmcnt(3)
    v_mfma_f32_32x32x16_bf16 v[64:79], v[104:107], v[192:195], v[64:79]
    buffer_load_dwordx4 v[220:223], v2, s[36:39], s88 offen offset:3072 sc1
    ds_read_b128 v[96:99], v44 offset:18432
    v_permlane32_swap_b32 v120, v122
    v_permlane32_swap_b32 v121, v123
    v_mfma_f32_32x32x16_bf16 v[80:95], v[108:111], v[192:195], v[80:95]
    ds_read_b128 v[100:103], v44 offset:51200
    ds_write_b128 v40, a[208:211] offset:4096
    v_add_f32 v120, v120, v122
    v_add_f32 v121, v121, v123
    s_waitcnt vmcnt(6) lgkmcnt(3)
    v_mfma_f32_32x32x16_bf16 v[64:79], v[112:115], v[196:199], v[64:79]
    s_xor_b32 s88, s90, 24576
    buffer_load_dwordx4 v[224:227], v2, s[36:39], s88 offen offset:0 sc1
    ds_read_b128 v[104:107], v44 offset:19456
    v_mul_f32 v120, 0xbb000000, v120
    v_mul_f32 v121, 0x3b000000, v121
    v_mfma_f32_32x32x16_bf16 v[80:95], v[116:119], v[196:199], v[80:95]
    ds_read_b128 v[108:111], v44 offset:52224
    v_or3_b32 v124, v124, v192, v196
    v_fma_f32 v121, -v120, v120, v121
    v_max_f32 v121, 0, v121
    s_waitcnt vmcnt(6) lgkmcnt(3)
    v_mfma_f32_32x32x16_bf16 v[64:79], v[96:99], v[200:203], v[64:79]
    buffer_load_dwordx4 v[228:231], v2, s[36:39], s88 offen offset:1024 sc1
    ds_read_b128 v[112:115], v44 offset:20480
    v_add_f32 v121, 0x3727c5ac, v121
    v_rsq_f32 v38, v121
    v_mfma_f32_32x32x16_bf16 v[80:95], v[100:103], v[200:203], v[80:95]
    ds_read_b128 v[116:119], v44 offset:53248
    ds_write_b128 v1, a[16:19] offset:1024
    v_and_b32 v122, s76, v120
    v_sub_f32 v122, v120, v122
    s_waitcnt vmcnt(6) lgkmcnt(3)
    v_mfma_f32_32x32x16_bf16 v[64:79], v[104:107], v[204:207], v[64:79]
    buffer_load_dwordx4 v[232:235], v2, s[36:39], s88 offen offset:2048 sc1
    ds_read_b128 v[96:99], v44 offset:21504
    s_mov_b64 vcc, 0xffffffff
    v_mul_f32 v39, s84, v38
    v_mfma_f32_32x32x16_bf16 v[80:95], v[108:111], v[204:207], v[80:95]
    ds_read_b128 v[100:103], v44 offset:54272
    v_or3_b32 v124, v124, v200, v204
    v_cndmask_b32 v120, v122, v120, vcc
    v_perm_b32 v36, v120, v120, s75
    s_waitcnt vmcnt(6) lgkmcnt(3)
    v_mfma_f32_32x32x16_bf16 v[64:79], v[112:115], v[208:211], v[64:79]
    buffer_load_dwordx4 v[236:239], v2, s[36:39], s88 offen offset:3072 sc1
    ds_read_b128 v[104:107], v44 offset:22528
    v_lshrrev_b32 v37, 16, v120
    v_mfma_f32_32x32x16_bf16 v[80:95], v[116:119], v[208:211], v[80:95]
    ds_read_b128 v[108:111], v44 offset:55296
    ds_write_b128 v40, a[212:215] offset:5120
    v_mfma_f32_32x32x8_bf16 v[64:79], v[32:33], v[36:37], v[64:79]
    v_mfma_f32_32x32x8_bf16 v[80:95], v[34:35], v[36:37], v[80:95]
    s_waitcnt vmcnt(6) lgkmcnt(3)
    v_mfma_f32_32x32x16_bf16 v[64:79], v[96:99], v[212:215], v[64:79]
    s_xor_b32 s88, s90, 28672
    buffer_load_dwordx4 v[240:243], v2, s[36:39], s88 offen offset:0 sc1
    ds_read_b128 v[112:115], v44 offset:23552
    v_mfma_f32_32x32x16_bf16 v[80:95], v[100:103], v[212:215], v[80:95]
    ds_read_b128 v[116:119], v44 offset:56320
    v_or3_b32 v124, v124, v208, v212
    s_waitcnt vmcnt(6) lgkmcnt(3)
    v_mfma_f32_32x32x16_bf16 v[64:79], v[104:107], v[216:219], v[64:79]
    buffer_load_dwordx4 v[244:247], v2, s[36:39], s88 offen offset:1024 sc1
    ds_read_b128 v[96:99], v44 offset:24576
    v_mfma_f32_32x32x16_bf16 v[80:95], v[108:111], v[216:219], v[80:95]
    ds_read_b128 v[100:103], v44 offset:57344
    ds_write_b128 v1, a[20:23] offset:9216
    s_waitcnt vmcnt(6) lgkmcnt(3)
    v_mfma_f32_32x32x16_bf16 v[64:79], v[112:115], v[220:223], v[64:79]
    buffer_load_dwordx4 v[248:251], v2, s[36:39], s88 offen offset:2048 sc1
    ds_read_b128 v[104:107], v44 offset:25600
    v_mfma_f32_32x32x16_bf16 v[80:95], v[116:119], v[220:223], v[80:95]
    ds_read_b128 v[108:111], v44 offset:58368
    v_or3_b32 v124, v124, v216, v220
    s_waitcnt vmcnt(6) lgkmcnt(3)
    v_mfma_f32_32x32x16_bf16 v[64:79], v[96:99], v[224:227], v[64:79]
    buffer_load_dwordx4 v[252:255], v2, s[36:39], s88 offen offset:3072 sc1
    ds_read_b128 v[112:115], v44 offset:26624
    v_mfma_f32_32x32x16_bf16 v[80:95], v[100:103], v[224:227], v[80:95]
    ds_read_b128 v[116:119], v44 offset:59392
    ds_write_b128 v40, a[216:219] offset:6144
    s_waitcnt vmcnt(6) lgkmcnt(3)
    v_mfma_f32_32x32x16_bf16 v[64:79], v[104:107], v[228:231], v[64:79]
    ds_read_b128 v[96:99], v44 offset:27648
    v_mfma_f32_32x32x16_bf16 v[80:95], v[108:111], v[228:231], v[80:95]
    ds_read_b128 v[100:103], v44 offset:60416
    v_or3_b32 v124, v124, v224, v228
    s_waitcnt vmcnt(5) lgkmcnt(3)
    v_mfma_f32_32x32x16_bf16 v[64:79], v[112:115], v[232:235], v[64:79]
    ds_read_b128 v[104:107], v44 offset:28672
    v_mfma_f32_32x32x16_bf16 v[80:95], v[116:119], v[232:235], v[80:95]
    ds_read_b128 v[108:111], v44 offset:61440
    ds_write_b128 v1, a[24:27] offset:17408
    s_waitcnt vmcnt(4) lgkmcnt(3)
    v_mfma_f32_32x32x16_bf16 v[64:79], v[96:99], v[236:239], v[64:79]
    ds_read_b128 v[112:115], v44 offset:29696
    v_mfma_f32_32x32x16_bf16 v[80:95], v[100:103], v[236:239], v[80:95]
    ds_read_b128 v[116:119], v44 offset:62464
    v_or3_b32 v124, v124, v232, v236
    s_waitcnt vmcnt(3) lgkmcnt(3)
    v_mfma_f32_32x32x16_bf16 v[64:79], v[104:107], v[240:243], v[64:79]
    ds_read_b128 v[96:99], v44 offset:30720
    v_mfma_f32_32x32x16_bf16 v[80:95], v[108:111], v[240:243], v[80:95]
    ds_read_b128 v[100:103], v44 offset:63488
    ds_write_b128 v40, a[220:223] offset:7168
    s_waitcnt vmcnt(2) lgkmcnt(3)
    v_mfma_f32_32x32x16_bf16 v[64:79], v[112:115], v[244:247], v[64:79]
    ds_read_b128 v[104:107], v44 offset:31744
    v_mfma_f32_32x32x16_bf16 v[80:95], v[116:119], v[244:247], v[80:95]
    ds_read_b128 v[108:111], v44 offset:64512
    v_or3_b32 v124, v124, v240, v244
    s_waitcnt vmcnt(1) lgkmcnt(3)
    v_mfma_f32_32x32x16_bf16 v[64:79], v[96:99], v[248:251], v[64:79]
    v_mfma_f32_32x32x16_bf16 v[80:95], v[100:103], v[248:251], v[80:95]
    ds_write_b128 v1, a[28:31] offset:25600
    s_waitcnt vmcnt(0) lgkmcnt(1)
    v_mfma_f32_32x32x16_bf16 v[64:79], v[104:107], v[252:255], v[64:79]
    v_mfma_f32_32x32x16_bf16 v[80:95], v[108:111], v[252:255], v[80:95]
    v_or3_b32 v124, v124, v248, v252
    v_and_b32 v124, 1, v124
    v_cmp_ne_u32 vcc, 0, v124
    s_cbranch_vccnz L_redo_x3
    v_add_u32 v44, 0, v2
    s_add_u32 s88, s68, 1572864
    s_add_u32 s89, s71, 196608
    s_nop 3
    v_cvt_pk_bf16_f32 v120, v64, v65
    v_cvt_pk_bf16_f32 v121, v66, v67
    v_cvt_pk_bf16_f32 v122, v68, v69
    v_cvt_pk_bf16_f32 v123, v70, v71
    v_cvt_pk_bf16_f32 v124, v72, v73
    v_cvt_pk_bf16_f32 v125, v74, v75
    v_mfma_f32_32x32x16_bf16 v[96:111], v[12:15], v[120:123], 0
    v_cvt_pk_bf16_f32 v126, v76, v77
    v_cvt_pk_bf16_f32 v127, v78, v79
    v_mul_f32 v80, v38, v80
    v_mul_f32 v81, v38, v81
    v_mul_f32 v82, v38, v82
    v_mul_f32 v83, v38, v83
    v_mfma_f32_32x32x16_bf16 v[64:79], v[16:19], v[124:127], 0
    v_mul_f32 v84, v38, v84
    v_mul_f32 v85, v38, v85
    v_mul_f32 v86, v38, v86
    v_mul_f32 v87, v38, v87
    v_mul_f32 v88, v38, v88
    v_mul_f32 v89, v38, v89
    v_mul_f32 v90, v38, v90
    v_mul_f32 v91, v38, v91
    v_mul_f32 v92, v38, v92
    v_mul_f32 v93, v38, v93
    v_mul_f32 v94, v38, v94
    v_mul_f32_e64 v95, v38, v95
    v_cvt_pk_bf16_f32 v80, v80, v81
    v_cvt_pk_bf16_f32 v81, v82, v83
    v_cvt_pk_bf16_f32 v82, v84, v85
    v_cvt_pk_bf16_f32 v83, v86, v87
    v_cvt_pk_bf16_f32 v84, v88, v89
    v_cvt_pk_bf16_f32 v85, v90, v91
    v_cvt_pk_bf16_f32 v86, v92, v93
    v_cvt_pk_bf16_f32 v87, v94, v95
    ds_write_b128 v50, v[80:83] offset:17408
    ds_write_b128 v50, v[84:87] offset:21760
    v_max3_f32 v120, v96, v97, v98
    v_max3_f32 v121, v99, v100, v101
    v_max3_f32 v120, v120, v102, v103
    v_max3_f32 v121, v121, v104, v105
    v_max3_f32 v120, v120, v106, v107
    v_max3_f32 v121, v121, v108, v109
    v_max3_f32 v120, v120, v110, v111
    v_max_f32 v120, v120, v121
    v_mul_f32 v120, v39, v120
    v_pk_fma_f32 v[96:97], v[96:97], v[38:39], v[120:121] op_sel:[0,1,0] op_sel_hi:[1,1,0] neg_lo:[0,0,1] neg_hi:[0,0,1]
    v_pk_fma_f32 v[98:99], v[98:99], v[38:39], v[120:121] op_sel:[0,1,0] op_sel_hi:[1,1,0] neg_lo:[0,0,1] neg_hi:[0,0,1]
    v_pk_fma_f32 v[100:101], v[100:101], v[38:39], v[120:121] op_sel:[0,1,0] op_sel_hi:[1,1,0] neg_lo:[0,0,1] neg_hi:[0,0,1]
    v_pk_fma_f32 v[102:103], v[102:103], v[38:39], v[120:121] op_sel:[0,1,0] op_sel_hi:[1,1,0] neg_lo:[0,0,1] neg_hi:[0,0,1]
    v_pk_fma_f32 v[104:105], v[104:105], v[38:39], v[120:121] op_sel:[0,1,0] op_sel_hi:[1,1,0] neg_lo:[0,0,1] neg_hi:[0,0,1]
    v_pk_fma_f32 v[106:107], v[106:107], v[38:39], v[120:121] op_sel:[0,1,0] op_sel_hi:[1,1,0] neg_lo:[0,0,1] neg_hi:[0,0,1]
    v_pk_fma_f32 v[108:109], v[108:109], v[38:39], v[120:121] op_sel:[0,1,0] op_sel_hi:[1,1,0] neg_lo:[0,0,1] neg_hi:[0,0,1]
    v_pk_fma_f32 v[110:111], v[110:111], v[38:39], v[120:121] op_sel:[0,1,0] op_sel_hi:[1,1,0] neg_lo:[0,0,1] neg_hi:[0,0,1]
    v_exp_f32 v96, v96
    v_exp_f32 v97, v97
    v_exp_f32 v98, v98
    v_exp_f32 v99, v99
    v_exp_f32 v100, v100
    v_exp_f32 v101, v101
    v_exp_f32 v102, v102
    v_exp_f32 v103, v103
    v_exp_f32 v104, v104
    v_exp_f32 v105, v105
    v_exp_f32 v106, v106
    v_exp_f32 v107, v107
    v_exp_f32 v108, v108
    v_exp_f32 v109, v109
    v_exp_f32 v110, v110
    v_exp_f32 v111, v111
    v_pk_add_f32 v[120:121], v[96:97], v[98:99]
    v_pk_add_f32 v[122:123], v[100:101], v[102:103]
    v_pk_add_f32 v[124:125], v[104:105], v[106:107]
    v_pk_add_f32 v[126:127], v[108:109], v[110:111]
    v_pk_add_f32 v[120:121], v[120:121], v[122:123]
    v_pk_add_f32 v[124:125], v[124:125], v[126:127]
    v_pk_add_f32 v[120:121], v[120:121], v[124:125]
    v_add_f32 v120, v120, v121
    v_rcp_f32 v120, v120
    s_nop 0
    v_pk_mul_f32 v[96:97], v[96:97], v[120:121] op_sel_hi:[1,0]
    v_pk_mul_f32 v[98:99], v[98:99], v[120:121] op_sel_hi:[1,0]
    v_pk_mul_f32 v[100:101], v[100:101], v[120:121] op_sel_hi:[1,0]
    v_pk_mul_f32 v[102:103], v[102:103], v[120:121] op_sel_hi:[1,0]
    v_pk_mul_f32 v[104:105], v[104:105], v[120:121] op_sel_hi:[1,0]
    v_pk_mul_f32 v[106:107], v[106:107], v[120:121] op_sel_hi:[1,0]
    v_pk_mul_f32 v[108:109], v[108:109], v[120:121] op_sel_hi:[1,0]
    v_pk_mul_f32 v[110:111], v[110:111], v[120:121] op_sel_hi:[1,0]
    v_cvt_pk_bf16_f32 v96, v96, v97
    v_cvt_pk_bf16_f32 v97, v98, v99
    v_cvt_pk_bf16_f32 v98, v100, v101
    v_cvt_pk_bf16_f32 v99, v102, v103
    v_cvt_pk_bf16_f32 v100, v104, v105
    v_cvt_pk_bf16_f32 v101, v106, v107
    v_cvt_pk_bf16_f32 v102, v108, v109
    v_cvt_pk_bf16_f32 v103, v110, v111
    ds_write_b128 v51, v[96:99] offset:0
    ds_write_b128 v51, v[100:103] offset:2176
    v_max3_f32 v120, v64, v65, v66
    v_max3_f32 v121, v67, v68, v69
    v_max3_f32 v120, v120, v70, v71
    v_max3_f32 v121, v121, v72, v73
    v_max3_f32 v120, v120, v74, v75
    v_max3_f32 v121, v121, v76, v77
    v_max3_f32 v120, v120, v78, v79
    v_max_f32 v120, v120, v121
    v_mul_f32_e64 v120, v39, v120
    v_pk_fma_f32 v[64:65], v[64:65], v[38:39], v[120:121] op_sel:[0,1,0] op_sel_hi:[1,1,0] neg_lo:[0,0,1] neg_hi:[0,0,1]
    v_pk_fma_f32 v[66:67], v[66:67], v[38:39], v[120:121] op_sel:[0,1,0] op_sel_hi:[1,1,0] neg_lo:[0,0,1] neg_hi:[0,0,1]
    v_pk_fma_f32 v[68:69], v[68:69], v[38:39], v[120:121] op_sel:[0,1,0] op_sel_hi:[1,1,0] neg_lo:[0,0,1] neg_hi:[0,0,1]
    v_pk_fma_f32 v[70:71], v[70:71], v[38:39], v[120:121] op_sel:[0,1,0] op_sel_hi:[1,1,0] neg_lo:[0,0,1] neg_hi:[0,0,1]
    v_pk_fma_f32 v[72:73], v[72:73], v[38:39], v[120:121] op_sel:[0,1,0] op_sel_hi:[1,1,0] neg_lo:[0,0,1] neg_hi:[0,0,1]
    v_pk_fma_f32 v[74:75], v[74:75], v[38:39], v[120:121] op_sel:[0,1,0] op_sel_hi:[1,1,0] neg_lo:[0,0,1] neg_hi:[0,0,1]
    v_pk_fma_f32 v[76:77], v[76:77], v[38:39], v[120:121] op_sel:[0,1,0] op_sel_hi:[1,1,0] neg_lo:[0,0,1] neg_hi:[0,0,1]
    v_pk_fma_f32 v[78:79], v[78:79], v[38:39], v[120:121] op_sel:[0,1,0] op_sel_hi:[1,1,0] neg_lo:[0,0,1] neg_hi:[0,0,1]
    v_exp_f32 v64, v64
    v_exp_f32 v65, v65
    v_exp_f32 v66, v66
    v_exp_f32 v67, v67
    v_exp_f32 v68, v68
    v_exp_f32 v69, v69
    v_exp_f32 v70, v70
    v_exp_f32 v71, v71
    v_exp_f32 v72, v72
    v_exp_f32 v73, v73
    v_exp_f32 v74, v74
    v_exp_f32 v75, v75
    v_exp_f32 v76, v76
    v_exp_f32 v77, v77
    v_exp_f32 v78, v78
    v_exp_f32 v79, v79
    v_pk_add_f32 v[120:121], v[64:65], v[66:67]
    v_pk_add_f32 v[122:123], v[68:69], v[70:71]
    v_pk_add_f32 v[124:125], v[72:73], v[74:75]
    v_pk_add_f32 v[126:127], v[76:77], v[78:79]
    v_pk_add_f32 v[120:121], v[120:121], v[122:123]
    v_pk_add_f32 v[124:125], v[124:125], v[126:127]
    v_pk_add_f32 v[120:121], v[120:121], v[124:125]
    v_add_f32 v120, v120, v121
    v_rcp_f32 v120, v120
    s_nop 0
    v_pk_mul_f32 v[64:65], v[64:65], v[120:121] op_sel_hi:[1,0]
    v_pk_mul_f32 v[66:67], v[66:67], v[120:121] op_sel_hi:[1,0]
    v_pk_mul_f32 v[68:69], v[68:69], v[120:121] op_sel_hi:[1,0]
    v_pk_mul_f32 v[70:71], v[70:71], v[120:121] op_sel_hi:[1,0]
    v_pk_mul_f32 v[72:73], v[72:73], v[120:121] op_sel_hi:[1,0]
    v_pk_mul_f32 v[74:75], v[74:75], v[120:121] op_sel_hi:[1,0]
    v_pk_mul_f32 v[76:77], v[76:77], v[120:121] op_sel_hi:[1,0]
    v_pk_mul_f32 v[78:79], v[78:79], v[120:121] op_sel_hi:[1,0]
    v_cvt_pk_bf16_f32 v64, v64, v65
    v_cvt_pk_bf16_f32 v65, v66, v67
    v_cvt_pk_bf16_f32 v66, v68, v69
    v_cvt_pk_bf16_f32 v67, v70, v71
    v_cvt_pk_bf16_f32 v68, v72, v73
    v_cvt_pk_bf16_f32 v69, v74, v75
    v_cvt_pk_bf16_f32 v70, v76, v77
    v_cvt_pk_bf16_f32 v71, v78, v79
    ds_write_b128 v51, v[64:67] offset:4352
    ds_write_b128 v51, v[68:71] offset:6528
    v_mov_b32 v124, s74
    v_mov_b32 v125, s74
    v_mov_b32 v126, s74
    v_mov_b32 v127, s74
    s_waitcnt lgkmcnt(0)
    s_barrier
    ds_read_b64_tr_b16 v[64:65], v53 offset:0
    ds_read_b64_tr_b16 v[66:67], v53 offset:256
    ds_read_b64_tr_b16 v[80:81], v52 offset:17408
    ds_read_b64_tr_b16 v[82:83], v52 offset:17664
    ds_read_b64_tr_b16 v[68:69], v53 offset:512
    ds_read_b64_tr_b16 v[70:71], v53 offset:768
    ds_read_b64_tr_b16 v[84:85], v52 offset:17920
    ds_read_b64_tr_b16 v[86:87], v52 offset:18176
    ds_read_b64_tr_b16 v[72:73], v53 offset:1024
    ds_read_b64_tr_b16 v[74:75], v53 offset:1280
    ds_read_b64_tr_b16 v[88:89], v52 offset:18432
    ds_read_b64_tr_b16 v[90:91], v52 offset:18688
    ds_read_b64_tr_b16 v[76:77], v53 offset:1536
    ds_read_b64_tr_b16 v[78:79], v53 offset:1792
    ds_read_b64_tr_b16 v[92:93], v52 offset:18944
    ds_read_b64_tr_b16 v[94:95], v52 offset:19200
    s_waitcnt lgkmcnt(12)
    v_mfma_f32_16x16x32_bf16 v[112:115], v[64:67], v[80:83], 0
    v_mfma_f32_16x16x32_bf16 v[116:119], v[124:127], v[64:67], 0
    ds_read_b128 v[96:99], v44 offset:0
    s_waitcnt lgkmcnt(9)
    v_mfma_f32_16x16x32_bf16 v[112:115], v[68:71], v[84:87], v[112:115]
    v_mfma_f32_16x16x32_bf16 v[116:119], v[124:127], v[68:71], v[116:119]
    ds_read_b128 v[100:103], v44 offset:1024
    s_waitcnt lgkmcnt(6)
    v_mfma_f32_16x16x32_bf16 v[112:115], v[72:75], v[88:91], v[112:115]
    v_mfma_f32_16x16x32_bf16 v[116:119], v[124:127], v[72:75], v[116:119]
    ds_read_b128 v[104:107], v44 offset:2048
    s_waitcnt lgkmcnt(3)
    v_mfma_f32_16x16x32_bf16 v[112:115], v[76:79], v[92:95], v[112:115]
    v_mfma_f32_16x16x32_bf16 v[116:119], v[124:127], v[76:79], v[116:119]
    ds_read_b128 v[108:111], v44 offset:3072
    v_mfma_f32_32x32x8_bf16 v[64:79], v[30:31], v[36:37], 0
    s_nop 4
    v_cvt_pk_bf16_f32 v120, v112, v113
    v_cvt_pk_bf16_f32 v121, v114, v115
    v_min_u32 v120, -2, v120
    v_min_u32 v121, -2, v121
    buffer_store_dwordx2 v[120:121], v59, s[36:39], s88 offen sc1
    v_min_u32 v124, -2, v116
    buffer_store_dword v124, v60, s[36:39], s89 offen sc1
    s_waitcnt lgkmcnt(3)
    v_mfma_f32_32x32x16_bf16 v[64:79], v[96:99], v[128:131], v[64:79]
    ds_read_b128 v[112:115], v44 offset:4096
    s_waitcnt lgkmcnt(3)
    v_mfma_f32_32x32x16_bf16 v[64:79], v[100:103], v[132:135], v[64:79]
    ds_read_b128 v[116:119], v44 offset:5120
    s_lshl_b32 s92, s44, 11
    s_add_u32 s92, s92, 32768
    v_add_u32 v40, s92, v2
    ds_write_b128 v40, a[32:35] offset:0
    s_waitcnt lgkmcnt(3)
    v_mfma_f32_32x32x16_bf16 v[64:79], v[104:107], v[136:139], v[64:79]
    ds_read_b128 v[96:99], v44 offset:6144
    v_mfma_f32_32x32x16_bf16 v[64:79], v[108:111], v[140:143], v[64:79]
    ds_read_b128 v[100:103], v44 offset:7168
    s_waitcnt lgkmcnt(3)
    v_mfma_f32_32x32x16_bf16 v[64:79], v[112:115], v[144:147], v[64:79]
L_pad8:
    s_cbranch_execz L_warm_done
    ds_read_b128 v[104:107], v44 offset:8192
    v_mfma_f32_32x32x16_bf16 v[64:79], v[116:119], v[148:151], v[64:79]
    ds_read_b128 v[108:111], v44 offset:9216
    ds_write_b128 v40, a[36:39] offset:8192
    s_waitcnt lgkmcnt(3)
    v_mfma_f32_32x32x16_bf16 v[64:79], v[96:99], v[152:155], v[64:79]
    ds_read_b128 v[112:115], v44 offset:10240
    v_mfma_f32_32x32x16_bf16 v[64:79], v[100:103], v[156:159], v[64:79]
    ds_read_b128 v[116:119], v44 offset:11264
    s_waitcnt lgkmcnt(3)
    v_mfma_f32_32x32x16_bf16 v[64:79], v[104:107], v[160:163], v[64:79]
    ds_read_b128 v[96:99], v44 offset:12288
    v_mfma_f32_32x32x16_bf16 v[64:79], v[108:111], v[164:167], v[64:79]
    ds_read_b128 v[100:103], v44 offset:13312
    ds_write_b128 v40, a[40:43] offset:16384
    s_waitcnt lgkmcnt(3)
    v_mfma_f32_32x32x16_bf16 v[64:79], v[112:115], v[168:171], v[64:79]
    ds_read_b128 v[104:107], v44 offset:14336
    v_mfma_f32_32x32x16_bf16 v[64:79], v[116:119], v[172:175], v[64:79]
    ds_read_b128 v[108:111], v44 offset:15360
    s_waitcnt lgkmcnt(3)
    v_mfma_f32_32x32x16_bf16 v[64:79], v[96:99], v[176:179], v[64:79]
    ds_read_b128 v[112:115], v44 offset:16384
    v_mfma_f32_32x32x16_bf16 v[64:79], v[100:103], v[180:183], v[64:79]
    ds_read_b128 v[116:119], v44 offset:17408
    ds_write_b128 v40, a[44:47] offset:24576
    s_waitcnt lgkmcnt(3)
    v_mfma_f32_32x32x16_bf16 v[64:79], v[104:107], v[184:187], v[64:79]
    ds_read_b128 v[96:99], v44 offset:18432
    v_mfma_f32_32x32x16_bf16 v[64:79], v[108:111], v[188:191], v[64:79]
    ds_read_b128 v[100:103], v44 offset:19456
    s_waitcnt lgkmcnt(3)
    v_mfma_f32_32x32x16_bf16 v[64:79], v[112:115], v[192:195], v[64:79]
    ds_read_b128 v[104:107], v44 offset:20480
    v_mfma_f32_32x32x16_bf16 v[64:79], v[116:119], v[196:199], v[64:79]
    ds_read_b128 v[108:111], v44 offset:21504
    ds_write_b128 v40, a[48:51] offset:1024
    s_waitcnt lgkmcnt(3)
    v_mfma_f32_32x32x16_bf16 v[64:79], v[96:99], v[200:203], v[64:79]
    ds_read_b128 v[112:115], v44 offset:22528
    v_mfma_f32_32x32x16_bf16 v[64:79], v[100:103], v[204:207], v[64:79]
    ds_read_b128 v[116:119], v44 offset:23552
    s_waitcnt lgkmcnt(3)
    v_mfma_f32_32x32x16_bf16 v[64:79], v[104:107], v[208:211], v[64:79]
    ds_read_b128 v[96:99], v44 offset:24576
    s_add_u32 s89, s70, 196608
    buffer_load_dword v160, v3, s[36:39], s89 offen offset:0 sc1
    v_mfma_f32_32x32x16_bf16 v[64:79], v[108:111], v[212:215], v[64:79]
    ds_read_b128 v[100:103], v44 offset:25600
    buffer_load_dword v161, v3, s[36:39], s89 offen offset:256 sc1
    ds_write_b128 v40, a[52:55] offset:9216
    s_waitcnt lgkmcnt(3)
    v_mfma_f32_32x32x16_bf16 v[64:79], v[112:115], v[216:219], v[64:79]
    ds_read_b128 v[104:107], v44 offset:26624
    buffer_load_dword v162, v3, s[36:39], s89 offen offset:512 sc1
    v_mfma_f32_32x32x16_bf16 v[64:79], v[116:119], v[220:223], v[64:79]
    ds_read_b128 v[108:111], v44 offset:27648
    buffer_load_dword v163, v3, s[36:39], s89 offen offset:768 sc1
    s_waitcnt lgkmcnt(3)
    v_mfma_f32_32x32x16_bf16 v[64:79], v[96:99], v[224:227], v[64:79]
    ds_read_b128 v[112:115], v44 offset:28672
    s_add_u32 s88, s67, 1572864
    buffer_load_dwordx4 v[128:131], v2, s[36:39], s88 offen offset:0 sc1
    v_mfma_f32_32x32x16_bf16 v[64:79], v[100:103], v[228:231], v[64:79]
    ds_read_b128 v[116:119], v44 offset:29696
    buffer_load_dwordx4 v[132:135], v2, s[36:39], s88 offen offset:1024 sc1
    ds_write_b128 v40, a[56:59] offset:17408
    s_waitcnt lgkmcnt(3)
    v_mfma_f32_32x32x16_bf16 v[64:79], v[104:107], v[232:235], v[64:79]
    ds_read_b128 v[96:99], v44 offset:30720
    buffer_load_dwordx4 v[136:139], v2, s[36:39], s88 offen offset:2048 sc1
    v_mfma_f32_32x32x16_bf16 v[64:79], v[108:111], v[236:239], v[64:79]
    ds_read_b128 v[100:103], v44 offset:31744
    buffer_load_dwordx4 v[140:143], v2, s[36:39], s88 offen offset:3072 sc1
    s_waitcnt lgkmcnt(3)
    v_mfma_f32_32x32x16_bf16 v[64:79], v[112:115], v[240:243], v[64:79]
    s_add_u32 s88, s67, 1576960
    buffer_load_dwordx4 v[144:147], v2, s[36:39], s88 offen offset:0 sc1
    v_mfma_f32_32x32x16_bf16 v[64:79], v[116:119], v[244:247], v[64:79]
    buffer_load_dwordx4 v[148:151], v2, s[36:39], s88 offen offset:1024 sc1
    ds_write_b128 v40, a[60:63] offset:25600
    s_waitcnt lgkmcnt(1)
    v_mfma_f32_32x32x16_bf16 v[64:79], v[96:99], v[248:251], v[64:79]
    buffer_load_dwordx4 v[152:155], v2, s[36:39], s88 offen offset:2048 sc1
    v_mfma_f32_32x32x16_bf16 v[64:79], v[100:103], v[252:255], v[64:79]
    buffer_load_dwordx4 v[156:159], v2, s[36:39], s88 offen offset:3072 sc1
    s_nop 10
    v_cvt_pk_bf16_f32 v120, v64, v65
    v_cvt_pk_bf16_f32 v121, v66, v67
    v_cvt_pk_bf16_f32 v122, v68, v69
    v_cvt_pk_bf16_f32 v123, v70, v71
    v_cvt_pk_bf16_f32 v124, v72, v73
    v_cvt_pk_bf16_f32 v125, v74, v75
    v_mfma_f32_32x32x16_bf16 v[80:95], v[12:15], v[120:123], 0
    v_cvt_pk_bf16_f32 v126, v76, v77
    v_cvt_pk_bf16_f32 v127, v78, v79
    s_nop 3
    v_mfma_f32_32x32x16_bf16 v[64:79], v[16:19], v[124:127], 0
    s_nop 4
    v_max3_f32 v96, v80, v81, v82
    v_max3_f32 v97, v83, v84, v85
    v_max3_f32 v96, v96, v86, v87
    v_max3_f32 v97, v97, v88, v89
    v_max3_f32 v96, v96, v90, v91
    v_max3_f32 v97, v97, v92, v93
    v_max3_f32 v96, v96, v94, v95
    v_max_f32 v96, v96, v97
    v_mul_f32 v96, v39, v96
    v_pk_fma_f32 v[80:81], v[80:81], v[38:39], v[96:97] op_sel:[0,1,0] op_sel_hi:[1,1,0] neg_lo:[0,0,1] neg_hi:[0,0,1]
    v_pk_fma_f32 v[82:83], v[82:83], v[38:39], v[96:97] op_sel:[0,1,0] op_sel_hi:[1,1,0] neg_lo:[0,0,1] neg_hi:[0,0,1]
    v_pk_fma_f32 v[84:85], v[84:85], v[38:39], v[96:97] op_sel:[0,1,0] op_sel_hi:[1,1,0] neg_lo:[0,0,1] neg_hi:[0,0,1]
    v_pk_fma_f32 v[86:87], v[86:87], v[38:39], v[96:97] op_sel:[0,1,0] op_sel_hi:[1,1,0] neg_lo:[0,0,1] neg_hi:[0,0,1]
    v_pk_fma_f32 v[88:89], v[88:89], v[38:39], v[96:97] op_sel:[0,1,0] op_sel_hi:[1,1,0] neg_lo:[0,0,1] neg_hi:[0,0,1]
    v_pk_fma_f32 v[90:91], v[90:91], v[38:39], v[96:97] op_sel:[0,1,0] op_sel_hi:[1,1,0] neg_lo:[0,0,1] neg_hi:[0,0,1]
    v_pk_fma_f32 v[92:93], v[92:93], v[38:39], v[96:97] op_sel:[0,1,0] op_sel_hi:[1,1,0] neg_lo:[0,0,1] neg_hi:[0,0,1]
    v_pk_fma_f32 v[94:95], v[94:95], v[38:39], v[96:97] op_sel:[0,1,0] op_sel_hi:[1,1,0] neg_lo:[0,0,1] neg_hi:[0,0,1]
    v_exp_f32 v80, v80
    v_exp_f32 v81, v81
    v_exp_f32 v82, v82
    v_exp_f32 v83, v83
    v_exp_f32 v84, v84
    v_exp_f32 v85, v85
    v_exp_f32 v86, v86
    v_exp_f32 v87, v87
    v_exp_f32 v88, v88
    v_exp_f32 v89, v89
    v_exp_f32 v90, v90
    v_exp_f32 v91, v91
    v_exp_f32 v92, v92
    v_exp_f32 v93, v93
    v_exp_f32 v94, v94
    v_exp_f32 v95, v95
    v_pk_add_f32 v[96:97], v[80:81], v[82:83]
    v_pk_add_f32 v[98:99], v[84:85], v[86:87]
    v_pk_add_f32 v[100:101], v[88:89], v[90:91]
    v_pk_add_f32 v[102:103], v[92:93], v[94:95]
    v_pk_add_f32 v[96:97], v[96:97], v[98:99]
    v_pk_add_f32 v[100:101], v[100:101], v[102:103]
    v_pk_add_f32 v[96:97], v[96:97], v[100:101]
    v_add_f32 v96, v96, v97
    v_rcp_f32 v96, v96
    s_waitcnt vmcnt(8)
    s_mov_b32 s3, 0
    v_max3_u32 v165, v160, v161, v162
    v_max_u32 v165, v165, v163
    v_cmp_eq_u32 vcc, -1, v165
    s_cbranch_vccnz L_e1k3
L_e1kj3:
    v_pk_mul_f32 v[80:81], v[80:81], v[96:97] op_sel_hi:[1,0]
    v_pk_mul_f32 v[82:83], v[82:83], v[96:97] op_sel_hi:[1,0]
    v_pk_mul_f32 v[84:85], v[84:85], v[96:97] op_sel_hi:[1,0]
    v_pk_mul_f32 v[86:87], v[86:87], v[96:97] op_sel_hi:[1,0]
    v_pk_mul_f32 v[88:89], v[88:89], v[96:97] op_sel_hi:[1,0]
    v_pk_mul_f32 v[90:91], v[90:91], v[96:97] op_sel_hi:[1,0]
    v_pk_mul_f32 v[92:93], v[92:93], v[96:97] op_sel_hi:[1,0]
    v_pk_mul_f32 v[94:95], v[94:95], v[96:97] op_sel_hi:[1,0]
    v_cvt_pk_bf16_f32 v192, v80, v81
    v_cvt_pk_bf16_f32 v193, v82, v83
    v_cvt_pk_bf16_f32 v194, v84, v85
    v_cvt_pk_bf16_f32 v195, v86, v87
    v_cvt_pk_bf16_f32 v196, v88, v89
    v_cvt_pk_bf16_f32 v197, v90, v91
    v_cvt_pk_bf16_f32 v198, v92, v93
    v_cvt_pk_bf16_f32 v199, v94, v95
    v_max3_f32 v96, v64, v65, v66
    v_max3_f32 v97, v67, v68, v69
    v_max3_f32 v96, v96, v70, v71
    v_max3_f32 v97, v97, v72, v73
    v_max3_f32 v96, v96, v74, v75
    v_max3_f32 v97, v97, v76, v77
    v_max3_f32 v96, v96, v78, v79
    v_max_f32 v96, v96, v97
    v_mul_f32_e64 v96, v39, v96
    v_pk_fma_f32 v[64:65], v[64:65], v[38:39], v[96:97] op_sel:[0,1,0] op_sel_hi:[1,1,0] neg_lo:[0,0,1] neg_hi:[0,0,1]
    v_pk_fma_f32 v[66:67], v[66:67], v[38:39], v[96:97] op_sel:[0,1,0] op_sel_hi:[1,1,0] neg_lo:[0,0,1] neg_hi:[0,0,1]
    v_pk_fma_f32 v[68:69], v[68:69], v[38:39], v[96:97] op_sel:[0,1,0] op_sel_hi:[1,1,0] neg_lo:[0,0,1] neg_hi:[0,0,1]
    v_pk_fma_f32 v[70:71], v[70:71], v[38:39], v[96:97] op_sel:[0,1,0] op_sel_hi:[1,1,0] neg_lo:[0,0,1] neg_hi:[0,0,1]
    v_pk_fma_f32 v[72:73], v[72:73], v[38:39], v[96:97] op_sel:[0,1,0] op_sel_hi:[1,1,0] neg_lo:[0,0,1] neg_hi:[0,0,1]
    v_pk_fma_f32 v[74:75], v[74:75], v[38:39], v[96:97] op_sel:[0,1,0] op_sel_hi:[1,1,0] neg_lo:[0,0,1] neg_hi:[0,0,1]
    v_pk_fma_f32 v[76:77], v[76:77], v[38:39], v[96:97] op_sel:[0,1,0] op_sel_hi:[1,1,0] neg_lo:[0,0,1] neg_hi:[0,0,1]
    v_pk_fma_f32 v[78:79], v[78:79], v[38:39], v[96:97] op_sel:[0,1,0] op_sel_hi:[1,1,0] neg_lo:[0,0,1] neg_hi:[0,0,1]
    v_exp_f32 v64, v64
    v_exp_f32 v65, v65
    v_exp_f32 v66, v66
    v_exp_f32 v67, v67
    v_exp_f32 v68, v68
    v_exp_f32 v69, v69
    v_exp_f32 v70, v70
    v_exp_f32 v71, v71
    v_exp_f32 v72, v72
    v_exp_f32 v73, v73
    v_exp_f32 v74, v74
    v_exp_f32 v75, v75
    v_exp_f32 v76, v76
    v_exp_f32 v77, v77
    v_exp_f32 v78, v78
    v_exp_f32 v79, v79
    v_pk_add_f32 v[96:97], v[64:65], v[66:67]
    v_pk_add_f32 v[98:99], v[68:69], v[70:71]
    v_pk_add_f32 v[100:101], v[72:73], v[74:75]
    v_pk_add_f32 v[102:103], v[76:77], v[78:79]
    v_pk_add_f32 v[96:97], v[96:97], v[98:99]
    v_pk_add_f32 v[100:101], v[100:101], v[102:103]
    v_pk_add_f32 v[96:97], v[96:97], v[100:101]
    v_add_f32 v96, v96, v97
    v_rcp_f32 v96, v96
    s_nop 0
    v_pk_mul_f32 v[64:65], v[64:65], v[96:97] op_sel_hi:[1,0]
    v_pk_mul_f32 v[66:67], v[66:67], v[96:97] op_sel_hi:[1,0]
    v_pk_mul_f32 v[68:69], v[68:69], v[96:97] op_sel_hi:[1,0]
    v_pk_mul_f32 v[70:71], v[70:71], v[96:97] op_sel_hi:[1,0]
    v_pk_mul_f32 v[72:73], v[72:73], v[96:97] op_sel_hi:[1,0]
    v_pk_mul_f32 v[74:75], v[74:75], v[96:97] op_sel_hi:[1,0]
    v_pk_mul_f32 v[76:77], v[76:77], v[96:97] op_sel_hi:[1,0]
    v_pk_mul_f32 v[78:79], v[78:79], v[96:97] op_sel_hi:[1,0]
    v_cvt_pk_bf16_f32 v200, v64, v65
    v_cvt_pk_bf16_f32 v201, v66, v67
    v_cvt_pk_bf16_f32 v202, v68, v69
    v_cvt_pk_bf16_f32 v203, v70, v71
    v_cvt_pk_bf16_f32 v204, v72, v73
    v_cvt_pk_bf16_f32 v205, v74, v75
    v_cvt_pk_bf16_f32 v206, v76, v77
    v_cvt_pk_bf16_f32 v207, v78, v79
    s_cmp_lg_u32 s3, 0
    s_cbranch_scc1 L_e1w3
L_e1c3:
    v_max3_u32 v120, v160, v161, v162
    v_max_u32 v120, v120, v163
    v_pk_add_f32 v[160:161], v[160:161], v[162:163]
    v_add_f32 v160, v160, v161
    v_mov_b32 v161, v160
    s_waitcnt vmcnt(7)
    v_mfma_f32_16x16x32_bf16 v[96:99], v[20:23], v[128:131], 0
    v_max3_u32 v120, v120, v128, v129
    v_max3_u32 v120, v120, v130, v131
    v_permlane16_swap_b32 v160, v161
    v_add_f32 v160, v160, v161
    v_mov_b32 v161, v160
    s_waitcnt vmcnt(6)
    v_mfma_f32_16x16x32_bf16 v[96:99], v[20:23], v[132:135], v[96:99]
    v_max3_u32 v120, v120, v132, v133
    v_max3_u32 v120, v120, v134, v135
    s_waitcnt vmcnt(5)
    v_mfma_f32_16x16x32_bf16 v[96:99], v[20:23], v[136:139], v[96:99]
    v_max3_u32 v120, v120, v136, v137
    v_max3_u32 v120, v120, v138, v139
    s_waitcnt vmcnt(4)
    v_mfma_f32_16x16x32_bf16 v[96:99], v[20:23], v[140:143], v[96:99]
    v_max3_u32 v120, v120, v140, v141
    v_max3_u32 v120, v120, v142, v143
    s_waitcnt vmcnt(3)
    v_mfma_f32_16x16x32_bf16 v[96:99], v[20:23], v[144:147], v[96:99]
    v_max3_u32 v120, v120, v144, v145
    v_max3_u32 v120, v120, v146, v147
    s_waitcnt vmcnt(2)
    v_mfma_f32_16x16x32_bf16 v[96:99], v[20:23], v[148:151], v[96:99]
    v_max3_u32 v120, v120, v148, v149
    v_max3_u32 v120, v120, v150, v151
    s_waitcnt vmcnt(1)
    v_mfma_f32_16x16x32_bf16 v[96:99], v[20:23], v[152:155], v[96:99]
    v_max3_u32 v120, v120, v152, v153
    v_max3_u32 v120, v120, v154, v155
    s_waitcnt vmcnt(0)
    v_mfma_f32_16x16x32_bf16 v[96:99], v[20:23], v[156:159], v[96:99]
    v_max3_u32 v120, v120, v156, v157
    v_max3_u32 v120, v120, v158, v159
    v_cmp_eq_u32 vcc, -1, v120
    s_cbranch_vccnz L_e1r3
    v_permlane32_swap_b32 v160, v161
    v_add_f32 v160, v160, v161
    v_cvt_pk_bf16_f32 v160, v160, v160
    ds_write_b16 v55, v160 offset:512
    v_cvt_pk_bf16_f32 v120, v96, v97
    v_cvt_pk_bf16_f32 v121, v98, v99
    ds_write_b64 v54, v[120:121]
    s_waitcnt lgkmcnt(2)
    s_waitcnt lgkmcnt(0)
    s_barrier
    ds_read_b128 v[104:107], v57 offset:0
    ds_read_b128 v[108:111], v57 offset:16
    ds_read_b128 v[112:115], v57 offset:544
    ds_read_b128 v[116:119], v57 offset:560
    s_waitcnt lgkmcnt(3)
    v_mfma_f32_32x32x16_bf16 v[64:79], v[104:107], v[192:195], 0
    s_waitcnt lgkmcnt(2)
    v_mfma_f32_32x32x16_bf16 v[64:79], v[108:111], v[196:199], v[64:79]
    v_mov_b32 v96, 4
    v_add_u32 v124, 98304, v63
    v_add_u32 v125, 32768, v63
    s_nop 0
    s_waitcnt lgkmcnt(0)
    v_mfma_f32_32x32x16_bf16 v[80:95], v[112:115], v[200:203], 0
    s_nop 0
    s_nop 0
    s_nop 0
    s_nop 0
    s_nop 0
    v_mfma_f32_32x32x16_bf16 v[80:95], v[116:119], v[204:207], v[80:95]
    v_add_f32 v72, s86, v72
    v_rcp_f32 v72, v72
    s_nop 0
    v_mul_f32 v64, v72, v64
    v_mul_f32 v65, v72, v65
    v_mul_f32 v66, v72, v66
    v_mul_f32 v67, v72, v67
    v_mul_f32 v68, v72, v68
    v_mul_f32 v69, v72, v69
    v_mul_f32 v70, v72, v70
    v_mul_f32 v71, v72, v71
    v_cvt_pk_bf16_f32 v224, v64, v65
    v_cvt_pk_bf16_f32 v225, v66, v67
    v_or_b32 v224, 1, v224
    v_cvt_pk_bf16_f32 v226, v68, v69
    v_cvt_pk_bf16_f32 v227, v70, v71
    s_cmp_lg_u32 s50, 0
    s_cbranch_scc1 L_po30_safe
    buffer_store_dwordx4 v[224:227], v46, s[36:39], s61 offen offset:0
L_po30_join:
    v_add_f32 v88, s86, v88
    v_rcp_f32 v88, v88
    s_nop 0
    v_pk_mul_f32 v[80:81], v[80:81], v[88:89] op_sel_hi:[1,0]
    v_pk_mul_f32 v[82:83], v[82:83], v[88:89] op_sel_hi:[1,0]
    v_pk_mul_f32 v[84:85], v[84:85], v[88:89] op_sel_hi:[1,0]
    v_pk_mul_f32 v[86:87], v[86:87], v[88:89] op_sel_hi:[1,0]
    v_cvt_pk_bf16_f32 v228, v80, v81
    v_cvt_pk_bf16_f32 v229, v82, v83
    v_or_b32 v228, 1, v228
    v_cvt_pk_bf16_f32 v230, v84, v85
    v_cvt_pk_bf16_f32 v231, v86, v87
    s_mov_b64 exec, 1
    buffer_store_dword v96, off, s[36:39], s81
    s_mov_b64 exec, -1
    s_cmp_lg_u32 s50, 0
    s_cbranch_scc1 L_po31_safe
    buffer_store_dwordx4 v[228:231], v46, s[36:39], s61 offen offset:512
L_po31_join:
    ds_read_b128 v[80:83], v124 offset:0
    ds_read_b128 v[84:87], v124 offset:512
    ds_read_b128 v[88:91], v124 offset:1024
    ds_read_b128 v[92:95], v124 offset:1536
    ds_read_b128 v[96:99], v124 offset:4096
    ds_read_b128 v[100:103], v124 offset:4608
    v_lshlrev_b32 v64, 16, v4
    v_and_b32 v65, s76, v4
    v_lshlrev_b32 v66, 16, v5
    v_and_b32 v67, s76, v5
    v_lshlrev_b32 v68, 16, v6
    v_and_b32 v69, s76, v6
    v_lshlrev_b32 v70, 16, v7
    v_and_b32 v71, s76, v7
    v_lshlrev_b32 v72, 16, v8
    v_and_b32 v73, s76, v8
    v_lshlrev_b32 v74, 16, v9
    v_and_b32 v75, s76, v9
    v_lshlrev_b32 v76, 16, v10
    v_and_b32 v77, s76, v10
    v_lshlrev_b32 v78, 16, v11
    v_and_b32 v79, s76, v11
    buffer_load_dword v120, v62, s[36:39], s62 offen sc1
    buffer_load_dword v252, v62, s[36:39], s62 offen sc1
    s_waitcnt vmcnt(1)
    v_cmp_gt_u32 vcc, 4, v120
    s_cbranch_vccz L_ok_o3
    buffer_load_dword v120, v62, s[36:39], s62 offen sc1
L_again_o3:
    s_waitcnt vmcnt(1)
    v_cmp_gt_u32 vcc, 4, v252
    s_cbranch_vccz L_ok_o3
    buffer_load_dword v252, v62, s[36:39], s62 offen sc1
    s_waitcnt vmcnt(1)
    v_cmp_gt_u32 vcc, 4, v120
    s_cbranch_vccz L_ok_o3
    buffer_load_dword v120, v62, s[36:39], s62 offen sc1
    s_sub_u32 s51, s51, 1
    s_cbranch_scc0 L_again_o3
    s_endpgm
L_ok_o3:
    s_add_u32 s88, s60, 0
    buffer_load_dwordx4 v[128:131], v2, s[36:39], s88 offen offset:0 sc1
    buffer_load_dwordx4 v[132:135], v2, s[36:39], s88 offen offset:2048 sc1
    s_add_u32 s88, s60, 4096
    buffer_load_dwordx4 v[136:139], v2, s[36:39], s88 offen offset:0 sc1
    buffer_load_dwordx4 v[140:143], v2, s[36:39], s88 offen offset:2048 sc1
    s_add_u32 s88, s60, 8192
    buffer_load_dwordx4 v[144:147], v2, s[36:39], s88 offen offset:0 sc1
    buffer_load_dwordx4 v[148:151], v2, s[36:39], s88 offen offset:2048 sc1
    s_waitcnt vmcnt(5) lgkmcnt(4)
    v_mfma_f32_16x16x32_bf16 v[64:67], v[80:83], v[128:131], v[64:67]
    ds_read_b128 v[104:107], v124 offset:5120
    s_add_u32 s88, s60, 12288
    buffer_load_dwordx4 v[152:155], v2, s[36:39], s88 offen offset:0 sc1
    v_mfma_f32_16x16x32_bf16 v[68:71], v[84:87], v[128:131], v[68:71]
    ds_read_b128 v[108:111], v124 offset:5632
    s_waitcnt lgkmcnt(4)
    v_mfma_f32_16x16x32_bf16 v[72:75], v[88:91], v[128:131], v[72:75]
    ds_read_b128 v[112:115], v124 offset:8192
    v_mfma_f32_16x16x32_bf16 v[76:79], v[92:95], v[128:131], v[76:79]
    ds_read_b128 v[116:119], v124 offset:8704
    s_waitcnt vmcnt(5) lgkmcnt(4)
    v_mfma_f32_16x16x32_bf16 v[64:67], v[96:99], v[132:135], v[64:67]
    ds_read_b128 v[80:83], v124 offset:9216
    buffer_load_dwordx4 v[156:159], v2, s[36:39], s88 offen offset:2048 sc1
    v_mfma_f32_16x16x32_bf16 v[68:71], v[100:103], v[132:135], v[68:71]
    ds_read_b128 v[84:87], v124 offset:9728
    s_waitcnt lgkmcnt(4)
    v_mfma_f32_16x16x32_bf16 v[72:75], v[104:107], v[132:135], v[72:75]
    ds_read_b128 v[88:91], v124 offset:12288
    v_and_b32 v121, v128, v132
    v_mfma_f32_16x16x32_bf16 v[76:79], v[108:111], v[132:135], v[76:79]
    ds_read_b128 v[92:95], v124 offset:12800
    s_waitcnt vmcnt(5) lgkmcnt(4)
    v_mfma_f32_16x16x32_bf16 v[64:67], v[112:115], v[136:139], v[64:67]
    ds_read_b128 v[96:99], v124 offset:13312
    s_add_u32 s88, s60, 16384
    buffer_load_dwordx4 v[160:163], v2, s[36:39], s88 offen offset:0 sc1
    v_mfma_f32_16x16x32_bf16 v[68:71], v[116:119], v[136:139], v[68:71]
    ds_read_b128 v[100:103], v124 offset:13824
    s_waitcnt lgkmcnt(4)
    v_mfma_f32_16x16x32_bf16 v[72:75], v[80:83], v[136:139], v[72:75]
    ds_read_b128 v[104:107], v124 offset:16384
    v_mfma_f32_16x16x32_bf16 v[76:79], v[84:87], v[136:139], v[76:79]
    ds_read_b128 v[108:111], v124 offset:16896
    s_waitcnt vmcnt(5) lgkmcnt(4)
    v_mfma_f32_16x16x32_bf16 v[64:67], v[88:91], v[140:143], v[64:67]
    ds_read_b128 v[112:115], v124 offset:17408
    buffer_load_dwordx4 v[164:167], v2, s[36:39], s88 offen offset:2048 sc1
    v_mfma_f32_16x16x32_bf16 v[68:71], v[92:95], v[140:143], v[68:71]
    ds_read_b128 v[116:119], v124 offset:17920
    s_waitcnt lgkmcnt(4)
    v_mfma_f32_16x16x32_bf16 v[72:75], v[96:99], v[140:143], v[72:75]
    ds_read_b128 v[80:83], v124 offset:20480
    v_bitop3_b32 v121, v121, v136, v140 bitop3:0x80
    v_mfma_f32_16x16x32_bf16 v[76:79], v[100:103], v[140:143], v[76:79]
    ds_read_b128 v[84:87], v124 offset:20992
    s_waitcnt vmcnt(5) lgkmcnt(4)
    v_mfma_f32_16x16x32_bf16 v[64:67], v[104:107], v[144:147], v[64:67]
    ds_read_b128 v[88:91], v124 offset:21504
    s_add_u32 s88, s60, 20480
    buffer_load_dwordx4 v[168:171], v2, s[36:39], s88 offen offset:0 sc1
    v_mfma_f32_16x16x32_bf16 v[68:71], v[108:111], v[144:147], v[68:71]
    ds_read_b128 v[92:95], v124 offset:22016
    s_waitcnt lgkmcnt(4)
    v_mfma_f32_16x16x32_bf16 v[72:75], v[112:115], v[144:147], v[72:75]
    ds_read_b128 v[96:99], v124 offset:24576
    v_mfma_f32_16x16x32_bf16 v[76:79], v[116:119], v[144:147], v[76:79]
    ds_read_b128 v[100:103], v124 offset:25088
    s_waitcnt vmcnt(5) lgkmcnt(4)
    v_mfma_f32_16x16x32_bf16 v[64:67], v[80:83], v[148:151], v[64:67]
    ds_read_b128 v[104:107], v124 offset:25600
    buffer_load_dwordx4 v[172:175], v2, s[36:39], s88 offen offset:2048 sc1
    v_mfma_f32_16x16x32_bf16 v[68:71], v[84:87], v[148:151], v[68:71]
    ds_read_b128 v[108:111], v124 offset:26112
    s_waitcnt lgkmcnt(4)
    v_mfma_f32_16x16x32_bf16 v[72:75], v[88:91], v[148:151], v[72:75]
    ds_read_b128 v[112:115], v124 offset:28672
    v_bitop3_b32 v121, v121, v144, v148 bitop3:0x80
    v_mfma_f32_16x16x32_bf16 v[76:79], v[92:95], v[148:151], v[76:79]
    ds_read_b128 v[116:119], v124 offset:29184
    s_waitcnt vmcnt(5) lgkmcnt(4)
    v_mfma_f32_16x16x32_bf16 v[64:67], v[96:99], v[152:155], v[64:67]
    ds_read_b128 v[80:83], v124 offset:29696
    s_add_u32 s88, s60, 24576
    buffer_load_dwordx4 v[176:179], v2, s[36:39], s88 offen offset:0 sc1
    v_mfma_f32_16x16x32_bf16 v[68:71], v[100:103], v[152:155], v[68:71]
    ds_read_b128 v[84:87], v124 offset:30208
    s_waitcnt lgkmcnt(4)
    v_mfma_f32_16x16x32_bf16 v[72:75], v[104:107], v[152:155], v[72:75]
    ds_read_b128 v[88:91], v125 offset:0
    v_mfma_f32_16x16x32_bf16 v[76:79], v[108:111], v[152:155], v[76:79]
    ds_read_b128 v[92:95], v125 offset:512
    s_waitcnt vmcnt(5) lgkmcnt(4)
    v_mfma_f32_16x16x32_bf16 v[64:67], v[112:115], v[156:159], v[64:67]
    ds_read_b128 v[96:99], v125 offset:1024
    buffer_load_dwordx4 v[180:183], v2, s[36:39], s88 offen offset:2048 sc1
    v_mfma_f32_16x16x32_bf16 v[68:71], v[116:119], v[156:159], v[68:71]
    ds_read_b128 v[100:103], v125 offset:1536
    s_waitcnt lgkmcnt(4)
    v_mfma_f32_16x16x32_bf16 v[72:75], v[80:83], v[156:159], v[72:75]
    ds_read_b128 v[104:107], v125 offset:4096
    v_bitop3_b32 v121, v121, v152, v156 bitop3:0x80
    v_mfma_f32_16x16x32_bf16 v[76:79], v[84:87], v[156:159], v[76:79]
    ds_read_b128 v[108:111], v125 offset:4608
    s_waitcnt vmcnt(5) lgkmcnt(4)
    v_mfma_f32_16x16x32_bf16 v[64:67], v[88:91], v[160:163], v[64:67]
    ds_read_b128 v[112:115], v125 offset:5120
    s_add_u32 s88, s60, 28672
    buffer_load_dwordx4 v[184:187], v2, s[36:39], s88 offen offset:0 sc1
    v_mfma_f32_16x16x32_bf16 v[68:71], v[92:95], v[160:163], v[68:71]
    ds_read_b128 v[116:119], v125 offset:5632
    s_waitcnt lgkmcnt(4)
    v_mfma_f32_16x16x32_bf16 v[72:75], v[96:99], v[160:163], v[72:75]
    ds_read_b128 v[80:83], v125 offset:8192
    v_mfma_f32_16x16x32_bf16 v[76:79], v[100:103], v[160:163], v[76:79]
    ds_read_b128 v[84:87], v125 offset:8704
    s_waitcnt vmcnt(5) lgkmcnt(4)
    v_mfma_f32_16x16x32_bf16 v[64:67], v[104:107], v[164:167], v[64:67]
    ds_read_b128 v[88:91], v125 offset:9216
    buffer_load_dwordx4 v[188:191], v2, s[36:39], s88 offen offset:2048 sc1
    v_mfma_f32_16x16x32_bf16 v[68:71], v[108:111], v[164:167], v[68:71]
    ds_read_b128 v[92:95], v125 offset:9728
    s_waitcnt lgkmcnt(4)
    v_mfma_f32_16x16x32_bf16 v[72:75], v[112:115], v[164:167], v[72:75]
    ds_read_b128 v[96:99], v125 offset:12288
    v_bitop3_b32 v121, v121, v160, v164 bitop3:0x80
    v_mfma_f32_16x16x32_bf16 v[76:79], v[116:119], v[164:167], v[76:79]
    ds_read_b128 v[100:103], v125 offset:12800
    s_waitcnt vmcnt(5) lgkmcnt(4)
    v_mfma_f32_16x16x32_bf16 v[64:67], v[80:83], v[168:171], v[64:67]
    ds_read_b128 v[104:107], v125 offset:13312
    v_mfma_f32_16x16x32_bf16 v[68:71], v[84:87], v[168:171], v[68:71]
    ds_read_b128 v[108:111], v125 offset:13824
    s_waitcnt lgkmcnt(4)
    v_mfma_f32_16x16x32_bf16 v[72:75], v[88:91], v[168:171], v[72:75]
    ds_read_b128 v[112:115], v125 offset:16384
    v_mfma_f32_16x16x32_bf16 v[76:79], v[92:95], v[168:171], v[76:79]
    ds_read_b128 v[116:119], v125 offset:16896
    s_waitcnt vmcnt(4) lgkmcnt(4)
    v_mfma_f32_16x16x32_bf16 v[64:67], v[96:99], v[172:175], v[64:67]
    ds_read_b128 v[80:83], v125 offset:17408
    v_mfma_f32_16x16x32_bf16 v[68:71], v[100:103], v[172:175], v[68:71]
    ds_read_b128 v[84:87], v125 offset:17920
    s_waitcnt lgkmcnt(4)
    v_mfma_f32_16x16x32_bf16 v[72:75], v[104:107], v[172:175], v[72:75]
    ds_read_b128 v[88:91], v125 offset:20480
    v_bitop3_b32 v121, v121, v168, v172 bitop3:0x80
    v_mfma_f32_16x16x32_bf16 v[76:79], v[108:111], v[172:175], v[76:79]
    ds_read_b128 v[92:95], v125 offset:20992
    s_waitcnt vmcnt(3) lgkmcnt(4)
    v_mfma_f32_16x16x32_bf16 v[64:67], v[112:115], v[176:179], v[64:67]
    ds_read_b128 v[96:99], v125 offset:21504
    v_mfma_f32_16x16x32_bf16 v[68:71], v[116:119], v[176:179], v[68:71]
    ds_read_b128 v[100:103], v125 offset:22016
    s_waitcnt lgkmcnt(4)
    v_mfma_f32_16x16x32_bf16 v[72:75], v[80:83], v[176:179], v[72:75]
    ds_read_b128 v[104:107], v125 offset:24576
    v_bfe_u32 v122, v3, 6, 1
    v_lshrrev_b32 v123, 7, v3
    v_lshl_add_u32 v122, v122, 1, v123
    v_lshlrev_b32 v123, 8, v62
    v_lshl_add_u32 v122, v122, 4, v123
    v_mfma_f32_16x16x32_bf16 v[76:79], v[84:87], v[176:179], v[76:79]
    ds_read_b128 v[108:111], v125 offset:25088
    s_waitcnt vmcnt(2) lgkmcnt(4)
    v_mfma_f32_16x16x32_bf16 v[64:67], v[88:91], v[180:183], v[64:67]
    ds_read_b128 v[112:115], v125 offset:25600
    v_mfma_f32_16x16x32_bf16 v[68:71], v[92:95], v[180:183], v[68:71]
    ds_read_b128 v[116:119], v125 offset:26112
    s_waitcnt lgkmcnt(4)
    v_mfma_f32_16x16x32_bf16 v[72:75], v[96:99], v[180:183], v[72:75]
    ds_read_b128 v[80:83], v125 offset:28672
    v_bitop3_b32 v121, v121, v176, v180 bitop3:0x80
    v_mfma_f32_16x16x32_bf16 v[76:79], v[100:103], v[180:183], v[76:79]
    ds_read_b128 v[84:87], v125 offset:29184
    s_waitcnt vmcnt(1) lgkmcnt(4)
    v_mfma_f32_16x16x32_bf16 v[64:67], v[104:107], v[184:187], v[64:67]
    ds_read_b128 v[88:91], v125 offset:29696
    v_mfma_f32_16x16x32_bf16 v[68:71], v[108:111], v[184:187], v[68:71]
    ds_read_b128 v[92:95], v125 offset:30208
    s_waitcnt lgkmcnt(4)
    v_mfma_f32_16x16x32_bf16 v[72:75], v[112:115], v[184:187], v[72:75]
    v_mfma_f32_16x16x32_bf16 v[76:79], v[116:119], v[184:187], v[76:79]
    s_waitcnt vmcnt(0) lgkmcnt(2)
    v_mfma_f32_16x16x32_bf16 v[64:67], v[80:83], v[188:191], v[64:67]
    v_mfma_f32_16x16x32_bf16 v[68:71], v[84:87], v[188:191], v[68:71]
    s_waitcnt lgkmcnt(0)
    v_mfma_f32_16x16x32_bf16 v[72:75], v[88:91], v[188:191], v[72:75]
    v_bitop3_b32 v121, v121, v184, v188 bitop3:0x80
    v_and_b32 v120, 1, v121
    v_cmp_ne_u32 vcc, 1, v120
    s_cbranch_vccnz L_redo_o3
    v_mfma_f32_16x16x32_bf16 v[76:79], v[92:95], v[188:191], v[76:79]
    v_cvt_pk_bf16_f32 v4, v64, v65
    v_cvt_pk_bf16_f32 v5, v66, v67
    v_cvt_pk_bf16_f32 v6, v68, v69
    v_cvt_pk_bf16_f32 v7, v70, v71
    v_cvt_pk_bf16_f32 v8, v72, v73
    v_cvt_pk_bf16_f32 v9, v74, v75
    s_nop 1
    v_cvt_pk_bf16_f32 v10, v76, v77
    v_cvt_pk_bf16_f32 v11, v78, v79
    v_permlane16_swap_b32 v4, v6
    v_permlane16_swap_b32 v5, v7
    buffer_store_dwordx4 v[4:7], v122, s[28:31], s73 offen offset:0 sc1 nt
    v_permlane16_swap_b32 v8, v10
    v_permlane16_swap_b32 v9, v11
    buffer_store_dwordx4 v[8:11], v122, s[28:31], s73 offen offset:64 sc1 nt
L_fail:
    s_endpgm
L_all_retry:
    buffer_load_dword v122, v123, s[32:35], 0 offen sc1
    s_sub_u32 s51, s51, 1
    s_cbranch_scc1 L_fail
    s_waitcnt vmcnt(0)
    s_branch L_all_chk
L_e1r0:
    s_add_u32 s89, s69, 0
    buffer_load_dword v160, v3, s[36:39], s89 offen offset:0 sc1
    s_add_u32 s89, s69, 0
    buffer_load_dword v161, v3, s[36:39], s89 offen offset:256 sc1
    v_max3_u32 v120, v128, v129, v130
    v_max_u32 v120, v120, v131
    v_cmp_eq_u32 vcc, -1, v120
    s_cbranch_vccz L_e1s0_0
    s_add_u32 s88, s66, 0
    buffer_load_dwordx4 v[128:131], v2, s[36:39], s88 offen offset:0 sc1
L_e1s0_0:
    v_max3_u32 v120, v132, v133, v134
    v_max_u32 v120, v120, v135
    v_cmp_eq_u32 vcc, -1, v120
    s_cbranch_vccz L_e1s0_1
    s_add_u32 s88, s66, 0
    buffer_load_dwordx4 v[132:135], v2, s[36:39], s88 offen offset:1024 sc1
L_e1s0_1:
    v_max3_u32 v120, v136, v137, v138
    v_max_u32 v120, v120, v139
    v_cmp_eq_u32 vcc, -1, v120
    s_cbranch_vccz L_e1s0_2
    s_add_u32 s88, s66, 0
    buffer_load_dwordx4 v[136:139], v2, s[36:39], s88 offen offset:2048 sc1
L_e1s0_2:
    v_max3_u32 v120, v140, v141, v142
    v_max_u32 v120, v120, v143
    v_cmp_eq_u32 vcc, -1, v120
    s_cbranch_vccz L_e1s0_3
    s_add_u32 s88, s66, 0
    buffer_load_dwordx4 v[140:143], v2, s[36:39], s88 offen offset:3072 sc1
L_e1s0_3:
    s_sub_u32 s51, s51, 1
    s_cbranch_scc1 L_fail
L_e1w0:
    s_waitcnt vmcnt(0)
L_pad9:
    s_cbranch_execz L_warm_done
    s_branch L_e1c0
L_po00_safe:
    s_nop 4
    buffer_store_dwordx4 v[224:227], v46, s[36:39], s61 offen offset:0 sc1
    s_nop 1
    s_branch L_po00_join
L_po01_safe:
    s_nop 4
    buffer_store_dwordx4 v[228:231], v46, s[36:39], s61 offen offset:512 sc1
    s_waitcnt vmcnt(0)
    s_mov_b64 exec, 1
    buffer_store_dword v96, off, s[36:39], s63 sc1
    s_mov_b64 exec, -1
    s_nop 1
    s_branch L_po01_join
L_redo_o0:
    s_waitcnt vmcnt(0) lgkmcnt(0)
    s_nop 15
    ds_read_b64_tr_b16 v[80:81], v124 offset:0
    ds_read_b64_tr_b16 v[82:83], v124 offset:1024
    ds_read_b64_tr_b16 v[84:85], v125 offset:0
    ds_read_b64_tr_b16 v[86:87], v125 offset:1024
    ds_read_b64_tr_b16 v[88:89], v126 offset:0
    ds_read_b64_tr_b16 v[90:91], v126 offset:1024
    ds_read_b64_tr_b16 v[92:93], v127 offset:0
    ds_read_b64_tr_b16 v[94:95], v127 offset:1024
    ds_read_b64_tr_b16 v[96:97], v124 offset:4096
    ds_read_b64_tr_b16 v[98:99], v124 offset:5120
    ds_read_b64_tr_b16 v[100:101], v125 offset:4096
    ds_read_b64_tr_b16 v[102:103], v125 offset:5120
    v_lshlrev_b32 v64, 16, v4
    v_and_b32 v65, s76, v4
    v_lshlrev_b32 v66, 16, v5
    v_and_b32 v67, s76, v5
    v_lshlrev_b32 v68, 16, v6
    v_and_b32 v69, s76, v6
    v_lshlrev_b32 v70, 16, v7
    v_and_b32 v71, s76, v7
    v_lshlrev_b32 v72, 16, v8
    v_and_b32 v73, s76, v8
    v_lshlrev_b32 v74, 16, v9
    v_and_b32 v75, s76, v9
    v_lshlrev_b32 v76, 16, v10
    v_and_b32 v77, s76, v10
    v_lshlrev_b32 v78, 16, v11
    v_and_b32 v79, s76, v11
    s_waitcnt lgkmcnt(0)
L_slow_o0:
    buffer_load_dword v120, v62, s[36:39], s62 offen sc1
    s_sub_u32 s51, s51, 1
    s_cbranch_scc1 L_fail
    s_waitcnt vmcnt(0)
    v_cmp_gt_u32 vcc, 1, v120
    s_cbranch_vccnz L_slow_o0
    s_branch L_ok_o0
L_px00_safe:
    s_nop 4
    buffer_store_dwordx4 v[4:7], v45, s[36:39], s57 offen offset:0 sc1
    s_nop 1
    s_branch L_px00_join
L_px01_safe:
    s_nop 4
    buffer_store_dwordx4 v[8:11], v45, s[36:39], s57 offen offset:2048 sc1
    s_nop 1
    s_branch L_px01_join
L_px0s_safe:
    s_nop 4
    buffer_store_dword v120, v61, s[36:39], s59 offen sc1
    s_waitcnt vmcnt(0)
    s_mov_b64 exec, 1
    buffer_store_dword v123, off, s[36:39], s65 sc1
    s_mov_b64 exec, -1
    s_nop 1
    s_branch L_px0s_join
L_redo_x1:
    s_waitcnt vmcnt(0) lgkmcnt(0)
    s_nop 15
    ds_read_b64_tr_b16 a[160:161], v44 offset:0
    ds_read_b64_tr_b16 a[162:163], v44 offset:1024
    ds_read_b64_tr_b16 a[224:225], v44 offset:32768
    ds_read_b64_tr_b16 a[226:227], v44 offset:33792
    ds_read_b64_tr_b16 a[164:165], v44 offset:512
    ds_read_b64_tr_b16 a[166:167], v44 offset:1536
    ds_read_b64_tr_b16 a[228:229], v44 offset:33280
    ds_read_b64_tr_b16 a[230:231], v44 offset:34304
    s_waitcnt lgkmcnt(0)
L_slow_x1:
    buffer_load_dword v125, v62, s[36:39], s64 offen sc1
    s_sub_u32 s51, s51, 1
    s_cbranch_scc1 L_fail
    s_waitcnt vmcnt(0)
    v_cmp_gt_u32 vcc, 2, v125
    s_cbranch_vccnz L_slow_x1
    s_branch L_ok_x1
L_e1k1:
    s_mov_b32 s3, 1
    v_cmp_eq_u32 vcc, -1, v160
    s_cbranch_vccz L_e1k1_0
    s_add_u32 s89, s70, 65536
    buffer_load_dword v160, v3, s[36:39], s89 offen offset:0 sc1
    s_add_u32 s88, s67, 524288
    buffer_load_dwordx4 v[128:131], v2, s[36:39], s88 offen offset:0 sc1
    s_add_u32 s88, s67, 524288
    buffer_load_dwordx4 v[132:135], v2, s[36:39], s88 offen offset:1024 sc1
L_e1k1_0:
    v_cmp_eq_u32 vcc, -1, v161
    s_cbranch_vccz L_e1k1_1
    s_add_u32 s89, s70, 65536
    buffer_load_dword v161, v3, s[36:39], s89 offen offset:256 sc1
    s_add_u32 s88, s67, 524288
    buffer_load_dwordx4 v[136:139], v2, s[36:39], s88 offen offset:2048 sc1
    s_add_u32 s88, s67, 524288
    buffer_load_dwordx4 v[140:143], v2, s[36:39], s88 offen offset:3072 sc1
L_e1k1_1:
    v_cmp_eq_u32 vcc, -1, v162
    s_cbranch_vccz L_e1k1_2
    s_add_u32 s89, s70, 65536
    buffer_load_dword v162, v3, s[36:39], s89 offen offset:512 sc1
    s_add_u32 s88, s67, 528384
    buffer_load_dwordx4 v[144:147], v2, s[36:39], s88 offen offset:0 sc1
    s_add_u32 s88, s67, 528384
    buffer_load_dwordx4 v[148:151], v2, s[36:39], s88 offen offset:1024 sc1
L_e1k1_2:
    v_cmp_eq_u32 vcc, -1, v163
    s_cbranch_vccz L_e1k1_3
    s_add_u32 s89, s70, 65536
    buffer_load_dword v163, v3, s[36:39], s89 offen offset:768 sc1
    s_add_u32 s88, s67, 528384
    buffer_load_dwordx4 v[152:155], v2, s[36:39], s88 offen offset:2048 sc1
    s_add_u32 s88, s67, 528384
    buffer_load_dwordx4 v[156:159], v2, s[36:39], s88 offen offset:3072 sc1
L_e1k1_3:
    s_branch L_e1kj1
L_e1r1:
    s_add_u32 s89, s70, 65536
    buffer_load_dword v160, v3, s[36:39], s89 offen offset:0 sc1
    s_add_u32 s89, s70, 65536
    buffer_load_dword v161, v3, s[36:39], s89 offen offset:256 sc1
    s_add_u32 s89, s70, 65536
    buffer_load_dword v162, v3, s[36:39], s89 offen offset:512 sc1
    s_add_u32 s89, s70, 65536
    buffer_load_dword v163, v3, s[36:39], s89 offen offset:768 sc1
    v_max3_u32 v120, v128, v129, v130
    v_max_u32 v120, v120, v131
    v_cmp_eq_u32 vcc, -1, v120
    s_cbranch_vccz L_e1s1_0
    s_add_u32 s88, s67, 524288
    buffer_load_dwordx4 v[128:131], v2, s[36:39], s88 offen offset:0 sc1
L_e1s1_0:
    v_max3_u32 v120, v132, v133, v134
    v_max_u32 v120, v120, v135
    v_cmp_eq_u32 vcc, -1, v120
    s_cbranch_vccz L_e1s1_1
    s_add_u32 s88, s67, 524288
    buffer_load_dwordx4 v[132:135], v2, s[36:39], s88 offen offset:1024 sc1
L_e1s1_1:
    v_max3_u32 v120, v136, v137, v138
    v_max_u32 v120, v120, v139
    v_cmp_eq_u32 vcc, -1, v120
    s_cbranch_vccz L_e1s1_2
    s_add_u32 s88, s67, 524288
    buffer_load_dwordx4 v[136:139], v2, s[36:39], s88 offen offset:2048 sc1
L_e1s1_2:
    v_max3_u32 v120, v140, v141, v142
    v_max_u32 v120, v120, v143
    v_cmp_eq_u32 vcc, -1, v120
    s_cbranch_vccz L_e1s1_3
    s_add_u32 s88, s67, 524288
    buffer_load_dwordx4 v[140:143], v2, s[36:39], s88 offen offset:3072 sc1
L_e1s1_3:
    v_max3_u32 v120, v144, v145, v146
    v_max_u32 v120, v120, v147
    v_cmp_eq_u32 vcc, -1, v120
    s_cbranch_vccz L_e1s1_4
    s_add_u32 s88, s67, 528384
    buffer_load_dwordx4 v[144:147], v2, s[36:39], s88 offen offset:0 sc1
L_e1s1_4:
    v_max3_u32 v120, v148, v149, v150
    v_max_u32 v120, v120, v151
    v_cmp_eq_u32 vcc, -1, v120
    s_cbranch_vccz L_e1s1_5
    s_add_u32 s88, s67, 528384
    buffer_load_dwordx4 v[148:151], v2, s[36:39], s88 offen offset:1024 sc1
L_e1s1_5:
    v_max3_u32 v120, v152, v153, v154
    v_max_u32 v120, v120, v155
    v_cmp_eq_u32 vcc, -1, v120
    s_cbranch_vccz L_e1s1_6
    s_add_u32 s88, s67, 528384
    buffer_load_dwordx4 v[152:155], v2, s[36:39], s88 offen offset:2048 sc1
L_e1s1_6:
    v_max3_u32 v120, v156, v157, v158
    v_max_u32 v120, v120, v159
    v_cmp_eq_u32 vcc, -1, v120
    s_cbranch_vccz L_e1s1_7
    s_add_u32 s88, s67, 528384
    buffer_load_dwordx4 v[156:159], v2, s[36:39], s88 offen offset:3072 sc1
L_e1s1_7:
    s_sub_u32 s51, s51, 1
    s_cbranch_scc1 L_fail
L_e1w1:
    s_waitcnt vmcnt(0)
    s_branch L_e1c1
L_po10_safe:
    s_nop 4
    buffer_store_dwordx4 v[224:227], v46, s[36:39], s61 offen offset:0 sc1
    s_nop 1
    s_branch L_po10_join
L_po11_safe:
    s_nop 4
    buffer_store_dwordx4 v[228:231], v46, s[36:39], s61 offen offset:512 sc1
    s_waitcnt vmcnt(0)
    s_mov_b64 exec, 1
    buffer_store_dword v96, off, s[36:39], s63 sc1
    s_mov_b64 exec, -1
    s_nop 1
    s_branch L_po11_join
L_redo_o1:
    s_waitcnt vmcnt(0) lgkmcnt(0)
    s_nop 15
    ds_read_b64_tr_b16 v[80:81], v124 offset:0
    ds_read_b64_tr_b16 v[82:83], v124 offset:1024
    ds_read_b64_tr_b16 v[84:85], v125 offset:0
    ds_read_b64_tr_b16 v[86:87], v125 offset:1024
    ds_read_b64_tr_b16 v[88:89], v126 offset:0
    ds_read_b64_tr_b16 v[90:91], v126 offset:1024
    ds_read_b64_tr_b16 v[92:93], v127 offset:0
    ds_read_b64_tr_b16 v[94:95], v127 offset:1024
    ds_read_b64_tr_b16 v[96:97], v124 offset:4096
    ds_read_b64_tr_b16 v[98:99], v124 offset:5120
    ds_read_b64_tr_b16 v[100:101], v125 offset:4096
    ds_read_b64_tr_b16 v[102:103], v125 offset:5120
    v_lshlrev_b32 v64, 16, v4
    v_and_b32 v65, s76, v4
    v_lshlrev_b32 v66, 16, v5
    v_and_b32 v67, s76, v5
    v_lshlrev_b32 v68, 16, v6
    v_and_b32 v69, s76, v6
    v_lshlrev_b32 v70, 16, v7
    v_and_b32 v71, s76, v7
    v_lshlrev_b32 v72, 16, v8
    v_and_b32 v73, s76, v8
    v_lshlrev_b32 v74, 16, v9
    v_and_b32 v75, s76, v9
    v_lshlrev_b32 v76, 16, v10
    v_and_b32 v77, s76, v10
    v_lshlrev_b32 v78, 16, v11
    v_and_b32 v79, s76, v11
    s_waitcnt lgkmcnt(0)
L_slow_o1:
    buffer_load_dword v120, v62, s[36:39], s62 offen sc1
    s_sub_u32 s51, s51, 1
    s_cbranch_scc1 L_fail
    s_waitcnt vmcnt(0)
    v_cmp_gt_u32 vcc, 2, v120
    s_cbranch_vccnz L_slow_o1
    s_branch L_ok_o1
L_px10_safe:
    s_nop 4
    buffer_store_dwordx4 v[4:7], v45, s[36:39], s57 offen offset:0 sc1
    s_nop 1
    s_branch L_px10_join
L_px11_safe:
    s_nop 4
    buffer_store_dwordx4 v[8:11], v45, s[36:39], s57 offen offset:2048 sc1
    s_nop 1
    s_branch L_px11_join
L_px1s_safe:
    s_nop 4
    buffer_store_dword v120, v61, s[36:39], s59 offen sc1
    s_waitcnt vmcnt(0)
    s_mov_b64 exec, 1
    buffer_store_dword v123, off, s[36:39], s65 sc1
    s_mov_b64 exec, -1
    s_nop 1
    s_branch L_px1s_join
L_redo_x2:
    s_waitcnt vmcnt(0) lgkmcnt(0)
    s_nop 15
    ds_read_b128 v[96:99], v44 offset:0
    ds_read_b128 v[100:103], v44 offset:32768
    ds_read_b128 v[104:107], v44 offset:1024
    ds_read_b128 v[108:111], v44 offset:33792
    s_waitcnt lgkmcnt(0)
L_slow_x2:
    buffer_load_dword v125, v62, s[36:39], s64 offen sc1
    s_sub_u32 s51, s51, 1
    s_cbranch_scc1 L_fail
    s_waitcnt vmcnt(0)
    v_cmp_gt_u32 vcc, 3, v125
    s_cbranch_vccnz L_slow_x2
    s_branch L_ok_x2
L_e1k2:
    s_mov_b32 s3, 1
    v_cmp_eq_u32 vcc, -1, v160
    s_cbranch_vccz L_e1k2_0
    s_add_u32 s89, s69, 131072
    buffer_load_dword v160, v3, s[36:39], s89 offen offset:0 sc1
    s_add_u32 s88, s66, 1048576
    buffer_load_dwordx4 v[128:131], v2, s[36:39], s88 offen offset:0 sc1
    s_add_u32 s88, s66, 1048576
    buffer_load_dwordx4 v[132:135], v2, s[36:39], s88 offen offset:1024 sc1
L_e1k2_0:
    v_cmp_eq_u32 vcc, -1, v161
    s_cbranch_vccz L_e1k2_1
    s_add_u32 s89, s69, 131072
    buffer_load_dword v161, v3, s[36:39], s89 offen offset:256 sc1
    s_add_u32 s88, s66, 1048576
    buffer_load_dwordx4 v[136:139], v2, s[36:39], s88 offen offset:2048 sc1
    s_add_u32 s88, s66, 1048576
    buffer_load_dwordx4 v[140:143], v2, s[36:39], s88 offen offset:3072 sc1
L_e1k2_1:
    s_branch L_e1kj2
L_e1r2:
    s_add_u32 s89, s69, 131072
    buffer_load_dword v160, v3, s[36:39], s89 offen offset:0 sc1
    s_add_u32 s89, s69, 131072
    buffer_load_dword v161, v3, s[36:39], s89 offen offset:256 sc1
    v_max3_u32 v120, v128, v129, v130
    v_max_u32 v120, v120, v131
    v_cmp_eq_u32 vcc, -1, v120
    s_cbranch_vccz L_e1s2_0
    s_add_u32 s88, s66, 1048576
    buffer_load_dwordx4 v[128:131], v2, s[36:39], s88 offen offset:0 sc1
L_e1s2_0:
    v_max3_u32 v120, v132, v133, v134
    v_max_u32 v120, v120, v135
    v_cmp_eq_u32 vcc, -1, v120
    s_cbranch_vccz L_e1s2_1
    s_add_u32 s88, s66, 1048576
    buffer_load_dwordx4 v[132:135], v2, s[36:39], s88 offen offset:1024 sc1
L_e1s2_1:
    v_max3_u32 v120, v136, v137, v138
    v_max_u32 v120, v120, v139
    v_cmp_eq_u32 vcc, -1, v120
    s_cbranch_vccz L_e1s2_2
    s_add_u32 s88, s66, 1048576
    buffer_load_dwordx4 v[136:139], v2, s[36:39], s88 offen offset:2048 sc1
L_e1s2_2:
    v_max3_u32 v120, v140, v141, v142
    v_max_u32 v120, v120, v143
    v_cmp_eq_u32 vcc, -1, v120
    s_cbranch_vccz L_e1s2_3
    s_add_u32 s88, s66, 1048576
    buffer_load_dwordx4 v[140:143], v2, s[36:39], s88 offen offset:3072 sc1
L_e1s2_3:
    s_sub_u32 s51, s51, 1
    s_cbranch_scc1 L_fail
L_e1w2:
    s_waitcnt vmcnt(0)
    s_branch L_e1c2
L_po20_safe:
    s_nop 4
    buffer_store_dwordx4 v[224:227], v46, s[36:39], s61 offen offset:0 sc1
    s_nop 1
    s_branch L_po20_join
L_po21_safe:
    s_nop 4
    buffer_store_dwordx4 v[228:231], v46, s[36:39], s61 offen offset:512 sc1
    s_waitcnt vmcnt(0)
    s_mov_b64 exec, 1
    buffer_store_dword v96, off, s[36:39], s63 sc1
    s_mov_b64 exec, -1
    s_nop 1
    s_branch L_po21_join
L_redo_o2:
    s_waitcnt vmcnt(0) lgkmcnt(0)
    s_nop 15
    ds_read_b128 v[80:83], v124 offset:0
    ds_read_b128 v[84:87], v124 offset:512
    ds_read_b128 v[88:91], v124 offset:1024
    ds_read_b128 v[92:95], v124 offset:1536
    ds_read_b128 v[96:99], v124 offset:4096
    ds_read_b128 v[100:103], v124 offset:4608
    v_lshlrev_b32 v64, 16, v4
    v_and_b32 v65, s76, v4
    v_lshlrev_b32 v66, 16, v5
    v_and_b32 v67, s76, v5
    v_lshlrev_b32 v68, 16, v6
    v_and_b32 v69, s76, v6
    v_lshlrev_b32 v70, 16, v7
    v_and_b32 v71, s76, v7
    v_lshlrev_b32 v72, 16, v8
    v_and_b32 v73, s76, v8
    v_lshlrev_b32 v74, 16, v9
    v_and_b32 v75, s76, v9
    v_lshlrev_b32 v76, 16, v10
    v_and_b32 v77, s76, v10
    v_lshlrev_b32 v78, 16, v11
    v_and_b32 v79, s76, v11
    s_waitcnt lgkmcnt(0)
L_slow_o2:
    buffer_load_dword v120, v62, s[36:39], s62 offen sc1
    s_sub_u32 s51, s51, 1
    s_cbranch_scc1 L_fail
    s_waitcnt vmcnt(0)
    v_cmp_gt_u32 vcc, 3, v120
    s_cbranch_vccnz L_slow_o2
    s_branch L_ok_o2
L_px20_safe:
    s_nop 4
    buffer_store_dwordx4 v[4:7], v45, s[36:39], s57 offen offset:0 sc1
    s_nop 1
    s_branch L_px20_join
L_px21_safe:
    s_nop 4
    buffer_store_dwordx4 v[8:11], v45, s[36:39], s57 offen offset:2048 sc1
    s_nop 1
    s_branch L_px21_join
L_px2s_safe:
    s_nop 4
    buffer_store_dword v120, v61, s[36:39], s59 offen sc1
    s_waitcnt vmcnt(0)
    s_mov_b64 exec, 1
    buffer_store_dword v123, off, s[36:39], s65 sc1
    s_mov_b64 exec, -1
    s_nop 1
    s_branch L_px2s_join
L_redo_x3:
    s_waitcnt vmcnt(0) lgkmcnt(0)
    s_nop 15
    ds_read_b128 v[96:99], v44 offset:0
    ds_read_b128 v[100:103], v44 offset:32768
    ds_read_b128 v[104:107], v44 offset:1024
    ds_read_b128 v[108:111], v44 offset:33792
    s_waitcnt lgkmcnt(0)
L_slow_x3:
    buffer_load_dword v125, v62, s[36:39], s64 offen sc1
    s_sub_u32 s51, s51, 1
    s_cbranch_scc1 L_fail
    s_waitcnt vmcnt(0)
    v_cmp_gt_u32 vcc, 4, v125
    s_cbranch_vccnz L_slow_x3
    s_branch L_ok_x3
L_e1k3:
    s_mov_b32 s3, 1
    v_cmp_eq_u32 vcc, -1, v160
    s_cbranch_vccz L_e1k3_0
    s_add_u32 s89, s70, 196608
    buffer_load_dword v160, v3, s[36:39], s89 offen offset:0 sc1
    s_add_u32 s88, s67, 1572864
    buffer_load_dwordx4 v[128:131], v2, s[36:39], s88 offen offset:0 sc1
    s_add_u32 s88, s67, 1572864
    buffer_load_dwordx4 v[132:135], v2, s[36:39], s88 offen offset:1024 sc1
L_e1k3_0:
    v_cmp_eq_u32 vcc, -1, v161
    s_cbranch_vccz L_e1k3_1
    s_add_u32 s89, s70, 196608
    buffer_load_dword v161, v3, s[36:39], s89 offen offset:256 sc1
    s_add_u32 s88, s67, 1572864
    buffer_load_dwordx4 v[136:139], v2, s[36:39], s88 offen offset:2048 sc1
    s_add_u32 s88, s67, 1572864
    buffer_load_dwordx4 v[140:143], v2, s[36:39], s88 offen offset:3072 sc1
L_e1k3_1:
    v_cmp_eq_u32 vcc, -1, v162
    s_cbranch_vccz L_e1k3_2
    s_add_u32 s89, s70, 196608
    buffer_load_dword v162, v3, s[36:39], s89 offen offset:512 sc1
    s_add_u32 s88, s67, 1576960
    buffer_load_dwordx4 v[144:147], v2, s[36:39], s88 offen offset:0 sc1
    s_add_u32 s88, s67, 1576960
    buffer_load_dwordx4 v[148:151], v2, s[36:39], s88 offen offset:1024 sc1
L_e1k3_2:
    v_cmp_eq_u32 vcc, -1, v163
    s_cbranch_vccz L_e1k3_3
    s_add_u32 s89, s70, 196608
    buffer_load_dword v163, v3, s[36:39], s89 offen offset:768 sc1
    s_add_u32 s88, s67, 1576960
    buffer_load_dwordx4 v[152:155], v2, s[36:39], s88 offen offset:2048 sc1
    s_add_u32 s88, s67, 1576960
    buffer_load_dwordx4 v[156:159], v2, s[36:39], s88 offen offset:3072 sc1
L_e1k3_3:
    s_branch L_e1kj3
L_e1r3:
    s_add_u32 s89, s70, 196608
    buffer_load_dword v160, v3, s[36:39], s89 offen offset:0 sc1
    s_add_u32 s89, s70, 196608
    buffer_load_dword v161, v3, s[36:39], s89 offen offset:256 sc1
    s_add_u32 s89, s70, 196608
    buffer_load_dword v162, v3, s[36:39], s89 offen offset:512 sc1
    s_add_u32 s89, s70, 196608
    buffer_load_dword v163, v3, s[36:39], s89 offen offset:768 sc1
    v_max3_u32 v120, v128, v129, v130
    v_max_u32 v120, v120, v131
    v_cmp_eq_u32 vcc, -1, v120
    s_cbranch_vccz L_e1s3_0
    s_add_u32 s88, s67, 1572864
    buffer_load_dwordx4 v[128:131], v2, s[36:39], s88 offen offset:0 sc1
L_e1s3_0:
    v_max3_u32 v120, v132, v133, v134
    v_max_u32 v120, v120, v135
    v_cmp_eq_u32 vcc, -1, v120
    s_cbranch_vccz L_e1s3_1
    s_add_u32 s88, s67, 1572864
    buffer_load_dwordx4 v[132:135], v2, s[36:39], s88 offen offset:1024 sc1
L_e1s3_1:
    v_max3_u32 v120, v136, v137, v138
    v_max_u32 v120, v120, v139
    v_cmp_eq_u32 vcc, -1, v120
    s_cbranch_vccz L_e1s3_2
    s_add_u32 s88, s67, 1572864
    buffer_load_dwordx4 v[136:139], v2, s[36:39], s88 offen offset:2048 sc1
L_e1s3_2:
    v_max3_u32 v120, v140, v141, v142
    v_max_u32 v120, v120, v143
    v_cmp_eq_u32 vcc, -1, v120
    s_cbranch_vccz L_e1s3_3
    s_add_u32 s88, s67, 1572864
    buffer_load_dwordx4 v[140:143], v2, s[36:39], s88 offen offset:3072 sc1
L_e1s3_3:
    v_max3_u32 v120, v144, v145, v146
    v_max_u32 v120, v120, v147
    v_cmp_eq_u32 vcc, -1, v120
    s_cbranch_vccz L_e1s3_4
    s_add_u32 s88, s67, 1576960
    buffer_load_dwordx4 v[144:147], v2, s[36:39], s88 offen offset:0 sc1
L_e1s3_4:
    v_max3_u32 v120, v148, v149, v150
    v_max_u32 v120, v120, v151
    v_cmp_eq_u32 vcc, -1, v120
    s_cbranch_vccz L_e1s3_5
    s_add_u32 s88, s67, 1576960
    buffer_load_dwordx4 v[148:151], v2, s[36:39], s88 offen offset:1024 sc1
L_e1s3_5:
    v_max3_u32 v120, v152, v153, v154
    v_max_u32 v120, v120, v155
    v_cmp_eq_u32 vcc, -1, v120
    s_cbranch_vccz L_e1s3_6
    s_add_u32 s88, s67, 1576960
    buffer_load_dwordx4 v[152:155], v2, s[36:39], s88 offen offset:2048 sc1
L_e1s3_6:
    v_max3_u32 v120, v156, v157, v158
    v_max_u32 v120, v120, v159
    v_cmp_eq_u32 vcc, -1, v120
    s_cbranch_vccz L_e1s3_7
    s_add_u32 s88, s67, 1576960
    buffer_load_dwordx4 v[156:159], v2, s[36:39], s88 offen offset:3072 sc1
L_e1s3_7:
    s_sub_u32 s51, s51, 1
    s_cbranch_scc1 L_fail
L_e1w3:
    s_waitcnt vmcnt(0)
    s_branch L_e1c3
L_po30_safe:
    s_nop 4
    buffer_store_dwordx4 v[224:227], v46, s[36:39], s61 offen offset:0 sc1
    s_nop 1
    s_branch L_po30_join
L_po31_safe:
    s_nop 4
    buffer_store_dwordx4 v[228:231], v46, s[36:39], s61 offen offset:512 sc1
    s_waitcnt vmcnt(0)
    s_mov_b64 exec, 1
    buffer_store_dword v96, off, s[36:39], s63 sc1
    s_mov_b64 exec, -1
    s_nop 1
    s_branch L_po31_join
L_redo_o3:
    s_waitcnt vmcnt(0) lgkmcnt(0)
    s_nop 15
    ds_read_b128 v[80:83], v124 offset:0
    ds_read_b128 v[84:87], v124 offset:512
    ds_read_b128 v[88:91], v124 offset:1024
    ds_read_b128 v[92:95], v124 offset:1536
    ds_read_b128 v[96:99], v124 offset:4096
    ds_read_b128 v[100:103], v124 offset:4608
    v_lshlrev_b32 v64, 16, v4
    v_and_b32 v65, s76, v4
    v_lshlrev_b32 v66, 16, v5
    v_and_b32 v67, s76, v5
    v_lshlrev_b32 v68, 16, v6
    v_and_b32 v69, s76, v6
    v_lshlrev_b32 v70, 16, v7
    v_and_b32 v71, s76, v7
    v_lshlrev_b32 v72, 16, v8
    v_and_b32 v73, s76, v8
    v_lshlrev_b32 v74, 16, v9
    v_and_b32 v75, s76, v9
    v_lshlrev_b32 v76, 16, v10
    v_and_b32 v77, s76, v10
    v_lshlrev_b32 v78, 16, v11
    v_and_b32 v79, s76, v11
    s_waitcnt lgkmcnt(0)
L_slow_o3:
    buffer_load_dword v120, v62, s[36:39], s62 offen sc1
    s_sub_u32 s51, s51, 1
    s_cbranch_scc1 L_fail
    s_waitcnt vmcnt(0)
    v_cmp_gt_u32 vcc, 4, v120
    s_cbranch_vccnz L_slow_o3
    s_branch L_ok_o3
L_code_end:
    s_endpgm
.section .rodata,"a"
.p2align 6
.amdhsa_kernel interleave_layers__linear_attn_block__linear_kernel_hedgehog__prompt_kernel
  .amdhsa_next_free_vgpr 512
  .amdhsa_next_free_sgpr 102
  .amdhsa_accum_offset 256
  .amdhsa_group_segment_fixed_size 0
  .amdhsa_kernarg_size 80
  .amdhsa_user_sgpr_count 2
  .amdhsa_user_sgpr_kernarg_segment_ptr 1
  .amdhsa_system_sgpr_workgroup_id_x 1
  .amdhsa_float_denorm_mode_32 3
.end_amdhsa_kernel
```
